```python
import torch

def _softmax(x, axis=-1):
    return torch.softmax(x, dim=axis)

def _gelu(x):
    return torch.nn.functional.gelu(x, approximate='tanh')

def _silu(x):
    return torch.nn.functional.silu(x)

def _sigmoid(x):
    return torch.sigmoid(x)

def _layernorm(x, axis=-1, eps=1e-05):
    m = x.mean(dim=axis, keepdim=True)
    v = x.var(dim=axis, keepdim=True, unbiased=False)
    return (x - m) / torch.sqrt(v + eps)

def _scatter_add(tgt, idx, src, axis=0):
    return tgt.clone().index_add_(axis, idx, src)

def _segment_sum(src, seg, n):
    out = torch.zeros((n,) + src.shape[1:], dtype=src.dtype)
    return out.index_add_(0, seg, src)

def _pad(x, pw):
    flat = tuple((v for pair in reversed(pw) for v in pair))
    return torch.nn.functional.pad(x, flat)
kernel_name = 'sequential_preLN__memory_aug_recurrent_mem_tr__glu_gated_swiglu__prompt'

def setup_inputs():

    _w = lambda a: (lambda t: t.to(torch.bfloat16) if t.is_floating_point() else t)(torch.as_tensor(a))

    def _A_setup():
        B, S, Dm = (1, 2048, 512)
        H, Dh = (32, 128)
        M, seg = (8, 32)
        seg = min(seg, S)
        S = S // seg * seg
        return {'x': _w((lambda *s: torch.randn(*s, dtype=torch.bfloat16) * 0.05)(B, S, Dm)), 'mem0': _w((lambda *s: torch.randn(*s, dtype=torch.bfloat16) * 0.2)(B, M, Dm)), 'Wq': _w((lambda *s: torch.randn(*s, dtype=torch.bfloat16) * 1.6)(Dm, H, Dh) * Dm ** (-0.5)), 'Wk': _w((lambda *s: torch.randn(*s, dtype=torch.bfloat16) * 1.6)(Dm, H, Dh) * Dm ** (-0.5)), 'Wv': _w((lambda *s: torch.randn(*s, dtype=torch.bfloat16) * 0.2)(Dm, H, Dh) * Dm ** (-0.5)), 'Wo': _w((lambda *s: torch.randn(*s, dtype=torch.bfloat16) * 0.2)(H, Dh, Dm) * (H * Dh) ** (-0.5)), 'seg_len': seg}
    _A_in = _A_setup()

    def _B_setup():
        B, S, D, F = (1, 2048, 512, 1376)
        return {'x': _w((lambda *s: torch.randn(*s, dtype=torch.bfloat16) * 0.05)(B, S, D)), 'w1': _w((lambda *s: torch.randn(*s, dtype=torch.bfloat16) * 0.2)(D, F) * (2.0 / D) ** 0.5), 'w3': _w((lambda *s: torch.randn(*s, dtype=torch.bfloat16) * 0.2)(D, F) * (2.0 / D) ** 0.5), 'w2': _w((lambda *s: torch.randn(*s, dtype=torch.bfloat16) * 0.2)(F, D) * (2.0 / F) ** 0.5)}
    _B_in = _B_setup()
    return {'A_x': _A_in['x'], 'A_mem0': _A_in['mem0'], 'A_Wq': _A_in['Wq'], 'A_Wk': _A_in['Wk'], 'A_Wv': _A_in['Wv'], 'A_Wo': _A_in['Wo'], 'A_seg_len': _A_in['seg_len'], 'B_x': _B_in['x'], 'B_w1': _B_in['w1'], 'B_w3': _B_in['w3'], 'B_w2': _B_in['w2']}

def reference(A_x, A_mem0, A_Wq, A_Wk, A_Wv, A_Wo, A_seg_len, B_x, B_w1, B_w3, B_w2):

    def _A_ref(x, mem0, Wq, Wk, Wv, Wo, seg_len):
        B, S, Dm = x.shape
        H, Dh = (Wq.shape[1], Wq.shape[2])
        M = mem0.shape[1]
        scale = Dh ** (-0.5)
        n_seg = S // seg_len
        L = M + seg_len
        idx = torch.arange(L)
        mask = (idx[:, None] < M) | (idx[:, None] >= idx[None, :])
        mem = mem0
        outs = []
        for s in range(n_seg):
            xs = x[:, s * seg_len:(s + 1) * seg_len, :].clone()
            h = torch.concatenate([mem, xs], axis=1)
            q = torch.einsum('btd,dhe->bhte', h, Wq)
            k = torch.einsum('btd,dhe->bhte', h, Wk)
            v = torch.einsum('btd,dhe->bhte', h, Wv)
            scores = torch.einsum('bhqe,bhke->bhqk', q, k) * scale
            scores = torch.where(mask[None, None], scores, -1000000000.0)
            p = _softmax(scores, axis=-1)
            o = torch.einsum('bhqk,bhke->bhqe', p, v)
            o = torch.einsum('bhte,hed->btd', o, Wo)
            mem = o[:, :M, :].clone()
            outs.append(o[:, M:, :])
        return torch.concatenate(outs, axis=1)

    def _B_ref(x, w1, w3, w2):
        gate = torch.einsum('bsd,df->bsf', x, w1)
        up = torch.einsum('bsd,df->bsf', x, w3)
        h = _silu(gate) * up
        out = torch.einsum('bsf,fd->bsd', h, w2)
        return out
    x = A_x
    h = x + _A_ref(_layernorm(x, axis=-1), A_mem0, A_Wq, A_Wk, A_Wv, A_Wo, A_seg_len)
    h2 = h + _B_ref(_layernorm(h, axis=-1), B_w1, B_w3, B_w2)
    return h2
```

```asm
; @launch grid=(256,1,1) block=(256,1,1) lds=163840
.amdgcn_target "amdgcn-amd-amdhsa--gfx950"
.text
.globl sequential_preLN__memory_aug_recurrent_mem_tr__glu_gated_swiglu__prompt_kernel
.p2align 8
.type sequential_preLN__memory_aug_recurrent_mem_tr__glu_gated_swiglu__prompt_kernel,@function
sequential_preLN__memory_aug_recurrent_mem_tr__glu_gated_swiglu__prompt_kernel:
    s_cmp_ge_u32 s2, 256
    s_cbranch_scc1 L_exit
    s_load_dwordx16 s[64:79], s[0:1], 0
    s_load_dwordx8 s[80:87], s[0:1], 64
    s_load_dwordx4 s[88:91], s[0:1], 96
    v_lshrrev_b32 v6, 6, v0
    v_and_b32 v1, 63, v0
    v_readfirstlane_b32 s3, v6
    v_lshrrev_b32 v2, 4, v1
    v_and_b32 v3, 15, v1
    v_lshlrev_b32 v4, 4, v1
    v_lshlrev_b32 v5, 2, v1
    s_and_b32 s4, s2, 7
    s_lshr_b32 s5, s2, 3
    s_getreg_b32 s6, hwreg(HW_REG_XCC_ID)
    s_and_b32 s6, s6, 15
    s_mov_b32 s7, 1
    s_mov_b32 s8, 400000
    s_waitcnt lgkmcnt(0)
    s_mov_b32 s16, s64
    s_and_b32 s17, s65, 0xffff
    s_mov_b32 s18, 2097152
    s_mov_b32 s19, 0x20000
    s_mov_b32 s20, s66
    s_and_b32 s21, s67, 0xffff
    s_mov_b32 s22, 8192
    s_mov_b32 s23, 0x20000
    s_mov_b32 s24, s68
    s_and_b32 s25, s69, 0xffff
    s_mov_b32 s26, 4194304
    s_mov_b32 s27, 0x20000
    s_mov_b32 s28, s70
    s_and_b32 s29, s71, 0xffff
    s_mov_b32 s30, 4194304
    s_mov_b32 s31, 0x20000
    s_mov_b32 s32, s72
    s_and_b32 s33, s73, 0xffff
    s_mov_b32 s34, 4194304
    s_mov_b32 s35, 0x20000
    s_mov_b32 s36, s74
    s_and_b32 s37, s75, 0xffff
    s_mov_b32 s38, 4194304
    s_mov_b32 s39, 0x20000
    s_mov_b32 s40, s80
    s_and_b32 s41, s81, 0xffff
    s_mov_b32 s42, 1409024
    s_mov_b32 s43, 0x20000
    s_mov_b32 s44, s82
    s_and_b32 s45, s83, 0xffff
    s_mov_b32 s46, 1409024
    s_mov_b32 s47, 0x20000
    s_mov_b32 s48, s84
    s_and_b32 s49, s85, 0xffff
    s_mov_b32 s50, 1409024
    s_mov_b32 s51, 0x20000
    s_mov_b32 s52, s86
    s_and_b32 s53, s87, 0xffff
    s_mov_b32 s54, 2097152
    s_mov_b32 s55, 0x20000
    s_mov_b32 s56, s88
    s_and_b32 s57, s89, 0xffff
    s_mov_b32 s58, 256
    s_mov_b32 s59, 0x20000
    s_mov_b32 s60, s90
    s_and_b32 s61, s91, 0xffff
    s_mov_b32 s62, 268435456
    s_mov_b32 s63, 0x20000
    s_cmp_eq_u32 s4, 0
    s_cbranch_scc1 L_role_R
    s_cmp_le_u32 s4, 2
    s_cbranch_scc1 L_role_KV
    s_cmp_lg_u32 s4, 7
    s_cbranch_scc1 L_ln
    v_mov_b32 v8, -1
    v_mov_b32 v9, -1
    v_mov_b32 v10, -1
    v_mov_b32 v11, -1
    s_lshl_b32 s11, s5, 2
    s_add_u32 s11, s11, s3
    s_lshl_b32 s9, s11, 11
    s_add_u32 s9, s9, 2097152
    s_add_u32 s10, s9, 0x80000
    buffer_store_dwordx4 v[8:11], v4, s[60:63], s9 offen offset:0 sc1
    buffer_store_dwordx4 v[8:11], v4, s[60:63], s9 offen offset:1024 sc1
    buffer_store_dwordx4 v[8:11], v4, s[60:63], s10 offen offset:0 sc1
    buffer_store_dwordx4 v[8:11], v4, s[60:63], s10 offen offset:1024 sc1
    s_lshl_b32 s9, s11, 8
    s_add_u32 s9, s9, 6291456
    s_mov_b64 exec, 0xffff
    buffer_store_dwordx4 v[8:11], v4, s[60:63], s9 offen sc1
    s_mov_b64 exec, -1
    s_branch L_ln_done
L_ln:
    s_sub_u32 s9, s4, 3
    s_lshl_b32 s9, s9, 5
    s_add_u32 s9, s9, s5
    s_lshl_b32 s10, s9, 14
    s_lshl_b32 s11, s3, 12
    s_add_u32 s11, s11, s10
    buffer_load_dwordx4 v[16:19], v4, s[16:19], s11 offen offset:0
    buffer_load_dwordx4 v[20:23], v4, s[16:19], s11 offen offset:1024
    buffer_load_dwordx4 v[24:27], v4, s[16:19], s11 offen offset:2048
    buffer_load_dwordx4 v[28:31], v4, s[16:19], s11 offen offset:3072
    v_lshrrev_b32 v6, 2, v1
    v_lshlrev_b32 v6, 10, v6
    v_and_b32 v7, 3, v1
    v_lshl_add_u32 v6, v7, 8, v6
    s_lshl_b32 s9, s3, 6
    v_add_u32 v6, s9, v6
    s_waitcnt vmcnt(3)
    v_lshlrev_b32 v48, 16, v16
    v_and_b32 v49, 0xffff0000, v16
    v_lshlrev_b32 v50, 16, v17
    v_and_b32 v51, 0xffff0000, v17
    v_lshlrev_b32 v52, 16, v18
    v_and_b32 v53, 0xffff0000, v18
    v_lshlrev_b32 v54, 16, v19
    v_and_b32 v55, 0xffff0000, v19
    v_add_f32 v56, v48, v49
    v_add_f32 v57, v50, v51
    v_add_f32 v58, v52, v53
    v_add_f32 v59, v54, v55
    v_add_f32 v56, v56, v57
    v_add_f32 v58, v58, v59
    v_add_f32 v56, v56, v58
    s_nop 1
    v_add_f32_dpp v56, v56, v56 row_ror:8 row_mask:0xf bank_mask:0xf
    s_nop 1
    v_add_f32_dpp v56, v56, v56 row_ror:4 row_mask:0xf bank_mask:0xf
    s_nop 1
    v_add_f32_dpp v56, v56, v56 row_ror:2 row_mask:0xf bank_mask:0xf
    s_nop 1
    v_add_f32_dpp v56, v56, v56 row_ror:1 row_mask:0xf bank_mask:0xf
    v_mov_b32 v58, v56
    s_nop 1
    v_permlane16_swap_b32 v56, v58
    v_add_f32 v56, v56, v58
    v_mov_b32 v58, v56
    s_nop 1
    v_permlane32_swap_b32 v56, v58
    v_add_f32 v56, v56, v58
    v_mul_f32 v56, 0x3b000000, v56
    v_sub_f32 v58, v48, v56
    v_mul_f32 v57, v58, v58
    v_sub_f32 v58, v49, v56
    v_fmac_f32 v57, v58, v58
    v_sub_f32 v58, v50, v56
    v_fmac_f32 v57, v58, v58
    v_sub_f32 v58, v51, v56
    v_fmac_f32 v57, v58, v58
    v_sub_f32 v58, v52, v56
    v_fmac_f32 v57, v58, v58
    v_sub_f32 v58, v53, v56
    v_fmac_f32 v57, v58, v58
    v_sub_f32 v58, v54, v56
    v_fmac_f32 v57, v58, v58
    v_sub_f32 v58, v55, v56
    v_fmac_f32 v57, v58, v58
    s_nop 1
    v_add_f32_dpp v57, v57, v57 row_ror:8 row_mask:0xf bank_mask:0xf
    s_nop 1
    v_add_f32_dpp v57, v57, v57 row_ror:4 row_mask:0xf bank_mask:0xf
    s_nop 1
    v_add_f32_dpp v57, v57, v57 row_ror:2 row_mask:0xf bank_mask:0xf
    s_nop 1
    v_add_f32_dpp v57, v57, v57 row_ror:1 row_mask:0xf bank_mask:0xf
    v_mov_b32 v58, v57
    s_nop 1
    v_permlane16_swap_b32 v57, v58
    v_add_f32 v57, v57, v58
    v_mov_b32 v58, v57
    s_nop 1
    v_permlane32_swap_b32 v57, v58
    v_add_f32 v57, v57, v58
    v_mul_f32 v57, 0x3b000000, v57
    v_cvt_pk_bf16_f32 v57, v57, v57
    v_lshlrev_b32 v57, 16, v57
    v_add_f32 v57, 0x3727c5ac, v57
    v_cvt_pk_bf16_f32 v57, v57, v57
    v_lshlrev_b32 v57, 16, v57
    v_sqrt_f32 v57, v57
    s_nop 0
    v_cvt_pk_bf16_f32 v57, v57, v57
    v_lshlrev_b32 v57, 16, v57
    v_rcp_f32 v57, v57
    v_cvt_pk_bf16_f32 v56, v56, v56
    v_lshlrev_b32 v56, 16, v56
    v_sub_f32 v48, v48, v56
    v_sub_f32 v49, v49, v56
    v_sub_f32 v50, v50, v56
    v_sub_f32 v51, v51, v56
    v_sub_f32 v52, v52, v56
    v_sub_f32 v53, v53, v56
    v_sub_f32 v54, v54, v56
    v_sub_f32 v55, v55, v56
    v_cvt_pk_bf16_f32 v32, v48, v49
    v_cvt_pk_bf16_f32 v33, v50, v51
    v_cvt_pk_bf16_f32 v34, v52, v53
    v_cvt_pk_bf16_f32 v35, v54, v55
    v_lshlrev_b32 v48, 16, v32
    v_and_b32 v49, 0xffff0000, v32
    v_lshlrev_b32 v50, 16, v33
    v_and_b32 v51, 0xffff0000, v33
    v_lshlrev_b32 v52, 16, v34
    v_and_b32 v53, 0xffff0000, v34
    v_lshlrev_b32 v54, 16, v35
    v_and_b32 v55, 0xffff0000, v35
    v_mul_f32 v48, v48, v57
    v_mul_f32 v49, v49, v57
    v_mul_f32 v50, v50, v57
    v_mul_f32 v51, v51, v57
    v_mul_f32 v52, v52, v57
    v_mul_f32 v53, v53, v57
    v_mul_f32 v54, v54, v57
    v_mul_f32 v55, v55, v57
    v_cvt_pk_bf16_f32 v32, v48, v49
    v_cvt_pk_bf16_f32 v33, v50, v51
    v_cvt_pk_bf16_f32 v34, v52, v53
    v_cvt_pk_bf16_f32 v35, v54, v55
    ds_write_b128 v6, v[32:35] offset:0
    s_waitcnt vmcnt(2)
    v_lshlrev_b32 v48, 16, v20
    v_and_b32 v49, 0xffff0000, v20
    v_lshlrev_b32 v50, 16, v21
    v_and_b32 v51, 0xffff0000, v21
    v_lshlrev_b32 v52, 16, v22
    v_and_b32 v53, 0xffff0000, v22
    v_lshlrev_b32 v54, 16, v23
    v_and_b32 v55, 0xffff0000, v23
    v_add_f32 v56, v48, v49
    v_add_f32 v57, v50, v51
    v_add_f32 v58, v52, v53
    v_add_f32 v59, v54, v55
    v_add_f32 v56, v56, v57
    v_add_f32 v58, v58, v59
    v_add_f32 v56, v56, v58
    s_nop 1
    v_add_f32_dpp v56, v56, v56 row_ror:8 row_mask:0xf bank_mask:0xf
    s_nop 1
    v_add_f32_dpp v56, v56, v56 row_ror:4 row_mask:0xf bank_mask:0xf
    s_nop 1
    v_add_f32_dpp v56, v56, v56 row_ror:2 row_mask:0xf bank_mask:0xf
    s_nop 1
    v_add_f32_dpp v56, v56, v56 row_ror:1 row_mask:0xf bank_mask:0xf
    v_mov_b32 v58, v56
    s_nop 1
    v_permlane16_swap_b32 v56, v58
    v_add_f32 v56, v56, v58
    v_mov_b32 v58, v56
    s_nop 1
    v_permlane32_swap_b32 v56, v58
    v_add_f32 v56, v56, v58
    v_mul_f32 v56, 0x3b000000, v56
    v_sub_f32 v58, v48, v56
    v_mul_f32 v57, v58, v58
    v_sub_f32 v58, v49, v56
    v_fmac_f32 v57, v58, v58
    v_sub_f32 v58, v50, v56
    v_fmac_f32 v57, v58, v58
    v_sub_f32 v58, v51, v56
    v_fmac_f32 v57, v58, v58
    v_sub_f32 v58, v52, v56
    v_fmac_f32 v57, v58, v58
    v_sub_f32 v58, v53, v56
    v_fmac_f32 v57, v58, v58
    v_sub_f32 v58, v54, v56
    v_fmac_f32 v57, v58, v58
    v_sub_f32 v58, v55, v56
    v_fmac_f32 v57, v58, v58
    s_nop 1
    v_add_f32_dpp v57, v57, v57 row_ror:8 row_mask:0xf bank_mask:0xf
    s_nop 1
    v_add_f32_dpp v57, v57, v57 row_ror:4 row_mask:0xf bank_mask:0xf
    s_nop 1
    v_add_f32_dpp v57, v57, v57 row_ror:2 row_mask:0xf bank_mask:0xf
    s_nop 1
    v_add_f32_dpp v57, v57, v57 row_ror:1 row_mask:0xf bank_mask:0xf
    v_mov_b32 v58, v57
    s_nop 1
    v_permlane16_swap_b32 v57, v58
    v_add_f32 v57, v57, v58
    v_mov_b32 v58, v57
    s_nop 1
    v_permlane32_swap_b32 v57, v58
    v_add_f32 v57, v57, v58
    v_mul_f32 v57, 0x3b000000, v57
    v_cvt_pk_bf16_f32 v57, v57, v57
    v_lshlrev_b32 v57, 16, v57
    v_add_f32 v57, 0x3727c5ac, v57
    v_cvt_pk_bf16_f32 v57, v57, v57
    v_lshlrev_b32 v57, 16, v57
    v_sqrt_f32 v57, v57
    s_nop 0
    v_cvt_pk_bf16_f32 v57, v57, v57
    v_lshlrev_b32 v57, 16, v57
    v_rcp_f32 v57, v57
    v_cvt_pk_bf16_f32 v56, v56, v56
    v_lshlrev_b32 v56, 16, v56
    v_sub_f32 v48, v48, v56
    v_sub_f32 v49, v49, v56
    v_sub_f32 v50, v50, v56
    v_sub_f32 v51, v51, v56
    v_sub_f32 v52, v52, v56
    v_sub_f32 v53, v53, v56
    v_sub_f32 v54, v54, v56
    v_sub_f32 v55, v55, v56
    v_cvt_pk_bf16_f32 v36, v48, v49
    v_cvt_pk_bf16_f32 v37, v50, v51
    v_cvt_pk_bf16_f32 v38, v52, v53
    v_cvt_pk_bf16_f32 v39, v54, v55
    v_lshlrev_b32 v48, 16, v36
    v_and_b32 v49, 0xffff0000, v36
    v_lshlrev_b32 v50, 16, v37
    v_and_b32 v51, 0xffff0000, v37
    v_lshlrev_b32 v52, 16, v38
    v_and_b32 v53, 0xffff0000, v38
    v_lshlrev_b32 v54, 16, v39
    v_and_b32 v55, 0xffff0000, v39
    v_mul_f32 v48, v48, v57
    v_mul_f32 v49, v49, v57
    v_mul_f32 v50, v50, v57
    v_mul_f32 v51, v51, v57
    v_mul_f32 v52, v52, v57
    v_mul_f32 v53, v53, v57
    v_mul_f32 v54, v54, v57
    v_mul_f32 v55, v55, v57
    v_cvt_pk_bf16_f32 v36, v48, v49
    v_cvt_pk_bf16_f32 v37, v50, v51
    v_cvt_pk_bf16_f32 v38, v52, v53
    v_cvt_pk_bf16_f32 v39, v54, v55
    ds_write_b128 v6, v[36:39] offset:16
    s_waitcnt vmcnt(1)
    v_lshlrev_b32 v48, 16, v24
    v_and_b32 v49, 0xffff0000, v24
    v_lshlrev_b32 v50, 16, v25
    v_and_b32 v51, 0xffff0000, v25
    v_lshlrev_b32 v52, 16, v26
    v_and_b32 v53, 0xffff0000, v26
    v_lshlrev_b32 v54, 16, v27
    v_and_b32 v55, 0xffff0000, v27
    v_add_f32 v56, v48, v49
    v_add_f32 v57, v50, v51
    v_add_f32 v58, v52, v53
    v_add_f32 v59, v54, v55
    v_add_f32 v56, v56, v57
    v_add_f32 v58, v58, v59
    v_add_f32 v56, v56, v58
    s_nop 1
    v_add_f32_dpp v56, v56, v56 row_ror:8 row_mask:0xf bank_mask:0xf
    s_nop 1
    v_add_f32_dpp v56, v56, v56 row_ror:4 row_mask:0xf bank_mask:0xf
    s_nop 1
    v_add_f32_dpp v56, v56, v56 row_ror:2 row_mask:0xf bank_mask:0xf
    s_nop 1
    v_add_f32_dpp v56, v56, v56 row_ror:1 row_mask:0xf bank_mask:0xf
    v_mov_b32 v58, v56
    s_nop 1
    v_permlane16_swap_b32 v56, v58
    v_add_f32 v56, v56, v58
    v_mov_b32 v58, v56
    s_nop 1
    v_permlane32_swap_b32 v56, v58
    v_add_f32 v56, v56, v58
    v_mul_f32 v56, 0x3b000000, v56
    v_sub_f32 v58, v48, v56
    v_mul_f32 v57, v58, v58
    v_sub_f32 v58, v49, v56
    v_fmac_f32 v57, v58, v58
    v_sub_f32 v58, v50, v56
    v_fmac_f32 v57, v58, v58
    v_sub_f32 v58, v51, v56
    v_fmac_f32 v57, v58, v58
    v_sub_f32 v58, v52, v56
    v_fmac_f32 v57, v58, v58
    v_sub_f32 v58, v53, v56
    v_fmac_f32 v57, v58, v58
    v_sub_f32 v58, v54, v56
    v_fmac_f32 v57, v58, v58
    v_sub_f32 v58, v55, v56
    v_fmac_f32 v57, v58, v58
    s_nop 1
    v_add_f32_dpp v57, v57, v57 row_ror:8 row_mask:0xf bank_mask:0xf
    s_nop 1
    v_add_f32_dpp v57, v57, v57 row_ror:4 row_mask:0xf bank_mask:0xf
    s_nop 1
    v_add_f32_dpp v57, v57, v57 row_ror:2 row_mask:0xf bank_mask:0xf
    s_nop 1
    v_add_f32_dpp v57, v57, v57 row_ror:1 row_mask:0xf bank_mask:0xf
    v_mov_b32 v58, v57
    s_nop 1
    v_permlane16_swap_b32 v57, v58
    v_add_f32 v57, v57, v58
    v_mov_b32 v58, v57
    s_nop 1
    v_permlane32_swap_b32 v57, v58
    v_add_f32 v57, v57, v58
    v_mul_f32 v57, 0x3b000000, v57
    v_cvt_pk_bf16_f32 v57, v57, v57
    v_lshlrev_b32 v57, 16, v57
    v_add_f32 v57, 0x3727c5ac, v57
    v_cvt_pk_bf16_f32 v57, v57, v57
    v_lshlrev_b32 v57, 16, v57
    v_sqrt_f32 v57, v57
    s_nop 0
    v_cvt_pk_bf16_f32 v57, v57, v57
    v_lshlrev_b32 v57, 16, v57
    v_rcp_f32 v57, v57
    v_cvt_pk_bf16_f32 v56, v56, v56
    v_lshlrev_b32 v56, 16, v56
    v_sub_f32 v48, v48, v56
    v_sub_f32 v49, v49, v56
    v_sub_f32 v50, v50, v56
    v_sub_f32 v51, v51, v56
    v_sub_f32 v52, v52, v56
    v_sub_f32 v53, v53, v56
    v_sub_f32 v54, v54, v56
    v_sub_f32 v55, v55, v56
    v_cvt_pk_bf16_f32 v40, v48, v49
    v_cvt_pk_bf16_f32 v41, v50, v51
    v_cvt_pk_bf16_f32 v42, v52, v53
    v_cvt_pk_bf16_f32 v43, v54, v55
    v_lshlrev_b32 v48, 16, v40
    v_and_b32 v49, 0xffff0000, v40
    v_lshlrev_b32 v50, 16, v41
    v_and_b32 v51, 0xffff0000, v41
    v_lshlrev_b32 v52, 16, v42
    v_and_b32 v53, 0xffff0000, v42
    v_lshlrev_b32 v54, 16, v43
    v_and_b32 v55, 0xffff0000, v43
    v_mul_f32 v48, v48, v57
    v_mul_f32 v49, v49, v57
    v_mul_f32 v50, v50, v57
    v_mul_f32 v51, v51, v57
    v_mul_f32 v52, v52, v57
    v_mul_f32 v53, v53, v57
    v_mul_f32 v54, v54, v57
    v_mul_f32 v55, v55, v57
    v_cvt_pk_bf16_f32 v40, v48, v49
    v_cvt_pk_bf16_f32 v41, v50, v51
    v_cvt_pk_bf16_f32 v42, v52, v53
    v_cvt_pk_bf16_f32 v43, v54, v55
    ds_write_b128 v6, v[40:43] offset:32
    s_waitcnt vmcnt(0)
    v_lshlrev_b32 v48, 16, v28
    v_and_b32 v49, 0xffff0000, v28
    v_lshlrev_b32 v50, 16, v29
    v_and_b32 v51, 0xffff0000, v29
    v_lshlrev_b32 v52, 16, v30
    v_and_b32 v53, 0xffff0000, v30
    v_lshlrev_b32 v54, 16, v31
    v_and_b32 v55, 0xffff0000, v31
    v_add_f32 v56, v48, v49
    v_add_f32 v57, v50, v51
    v_add_f32 v58, v52, v53
    v_add_f32 v59, v54, v55
    v_add_f32 v56, v56, v57
    v_add_f32 v58, v58, v59
    v_add_f32 v56, v56, v58
    s_nop 1
    v_add_f32_dpp v56, v56, v56 row_ror:8 row_mask:0xf bank_mask:0xf
    s_nop 1
    v_add_f32_dpp v56, v56, v56 row_ror:4 row_mask:0xf bank_mask:0xf
    s_nop 1
    v_add_f32_dpp v56, v56, v56 row_ror:2 row_mask:0xf bank_mask:0xf
    s_nop 1
    v_add_f32_dpp v56, v56, v56 row_ror:1 row_mask:0xf bank_mask:0xf
    v_mov_b32 v58, v56
    s_nop 1
    v_permlane16_swap_b32 v56, v58
    v_add_f32 v56, v56, v58
    v_mov_b32 v58, v56
    s_nop 1
    v_permlane32_swap_b32 v56, v58
    v_add_f32 v56, v56, v58
    v_mul_f32 v56, 0x3b000000, v56
    v_sub_f32 v58, v48, v56
    v_mul_f32 v57, v58, v58
    v_sub_f32 v58, v49, v56
    v_fmac_f32 v57, v58, v58
    v_sub_f32 v58, v50, v56
    v_fmac_f32 v57, v58, v58
    v_sub_f32 v58, v51, v56
    v_fmac_f32 v57, v58, v58
    v_sub_f32 v58, v52, v56
    v_fmac_f32 v57, v58, v58
    v_sub_f32 v58, v53, v56
    v_fmac_f32 v57, v58, v58
    v_sub_f32 v58, v54, v56
    v_fmac_f32 v57, v58, v58
    v_sub_f32 v58, v55, v56
    v_fmac_f32 v57, v58, v58
    s_nop 1
    v_add_f32_dpp v57, v57, v57 row_ror:8 row_mask:0xf bank_mask:0xf
    s_nop 1
    v_add_f32_dpp v57, v57, v57 row_ror:4 row_mask:0xf bank_mask:0xf
    s_nop 1
    v_add_f32_dpp v57, v57, v57 row_ror:2 row_mask:0xf bank_mask:0xf
    s_nop 1
    v_add_f32_dpp v57, v57, v57 row_ror:1 row_mask:0xf bank_mask:0xf
    v_mov_b32 v58, v57
    s_nop 1
    v_permlane16_swap_b32 v57, v58
    v_add_f32 v57, v57, v58
    v_mov_b32 v58, v57
    s_nop 1
    v_permlane32_swap_b32 v57, v58
    v_add_f32 v57, v57, v58
    v_mul_f32 v57, 0x3b000000, v57
    v_cvt_pk_bf16_f32 v57, v57, v57
    v_lshlrev_b32 v57, 16, v57
    v_add_f32 v57, 0x3727c5ac, v57
    v_cvt_pk_bf16_f32 v57, v57, v57
    v_lshlrev_b32 v57, 16, v57
    v_sqrt_f32 v57, v57
    s_nop 0
    v_cvt_pk_bf16_f32 v57, v57, v57
    v_lshlrev_b32 v57, 16, v57
    v_rcp_f32 v57, v57
    v_cvt_pk_bf16_f32 v56, v56, v56
    v_lshlrev_b32 v56, 16, v56
    v_sub_f32 v48, v48, v56
    v_sub_f32 v49, v49, v56
    v_sub_f32 v50, v50, v56
    v_sub_f32 v51, v51, v56
    v_sub_f32 v52, v52, v56
    v_sub_f32 v53, v53, v56
    v_sub_f32 v54, v54, v56
    v_sub_f32 v55, v55, v56
    v_cvt_pk_bf16_f32 v44, v48, v49
    v_cvt_pk_bf16_f32 v45, v50, v51
    v_cvt_pk_bf16_f32 v46, v52, v53
    v_cvt_pk_bf16_f32 v47, v54, v55
    v_lshlrev_b32 v48, 16, v44
    v_and_b32 v49, 0xffff0000, v44
    v_lshlrev_b32 v50, 16, v45
    v_and_b32 v51, 0xffff0000, v45
    v_lshlrev_b32 v52, 16, v46
    v_and_b32 v53, 0xffff0000, v46
    v_lshlrev_b32 v54, 16, v47
    v_and_b32 v55, 0xffff0000, v47
    v_mul_f32 v48, v48, v57
    v_mul_f32 v49, v49, v57
    v_mul_f32 v50, v50, v57
    v_mul_f32 v51, v51, v57
    v_mul_f32 v52, v52, v57
    v_mul_f32 v53, v53, v57
    v_mul_f32 v54, v54, v57
    v_mul_f32 v55, v55, v57
    v_cvt_pk_bf16_f32 v44, v48, v49
    v_cvt_pk_bf16_f32 v45, v50, v51
    v_cvt_pk_bf16_f32 v46, v52, v53
    v_cvt_pk_bf16_f32 v47, v54, v55
    ds_write_b128 v6, v[44:47] offset:48
    s_lshl_b32 s9, s3, 12
    v_add_u32 v7, s9, v4
    s_waitcnt lgkmcnt(0)
    s_barrier
    ds_read_b128 v[16:19], v7 offset:0
    ds_read_b128 v[20:23], v7 offset:1024
    ds_read_b128 v[24:27], v7 offset:2048
    ds_read_b128 v[28:31], v7 offset:3072
    s_waitcnt lgkmcnt(3)
    buffer_store_dwordx4 v[16:19], v4, s[60:63], s11 offen offset:0 sc1
    s_waitcnt lgkmcnt(2)
    buffer_store_dwordx4 v[20:23], v4, s[60:63], s11 offen offset:1024 sc1
    s_waitcnt lgkmcnt(1)
    buffer_store_dwordx4 v[24:27], v4, s[60:63], s11 offen offset:2048 sc1
    s_waitcnt lgkmcnt(0)
    buffer_store_dwordx4 v[28:31], v4, s[60:63], s11 offen offset:3072 sc1
L_ln_done:
    s_cmp_le_u32 s4, 5
    s_cbranch_scc1 L_role_AT
    s_branch L_role_FF
L_role_KV:
L_pc_KV:
    s_sub_u32 s64, s4, 1
    s_lshl_b32 s65, s5, 7
    s_lshl_b32 s9, s64, 4
    s_add_u32 s65, s65, s9
    s_lshl_b32 s9, s3, 2
    s_add_u32 s65, s65, s9
    s_add_u32 s65, s65, 6881280
    s_cmp_ge_u32 s3, 2
    s_cselect_b32 s68, s32, s28
    s_cselect_b32 s69, s33, s29
    s_mov_b32 s70, 4194304
    s_mov_b32 s71, 0x20000
    s_and_b32 s66, s3, 1
    v_lshrrev_b32 v8, 3, v1
    v_lshlrev_b32 v8, 13, v8
    v_and_b32 v9, 7, v1
    v_lshl_add_u32 v8, v9, 4, v8
    s_lshl_b32 s9, s5, 8
    s_lshl_b32 s10, s66, 7
    s_add_u32 s9, s9, s10
    v_add_u32 v8, s9, v8
    s_lshl_b32 s67, s3, 15
    s_add_u32 m0, s67, 0
    s_mov_b32 s14, 0
    buffer_load_dwordx4 v8, s[68:71], s14 offen lds
    s_add_u32 m0, s67, 1024
    s_mov_b32 s14, 65536
    buffer_load_dwordx4 v8, s[68:71], s14 offen lds
    s_add_u32 m0, s67, 2048
    s_mov_b32 s14, 131072
    buffer_load_dwordx4 v8, s[68:71], s14 offen lds
    s_add_u32 m0, s67, 3072
    s_mov_b32 s14, 196608
    buffer_load_dwordx4 v8, s[68:71], s14 offen lds
    s_add_u32 m0, s67, 4096
    s_mov_b32 s14, 262144
    buffer_load_dwordx4 v8, s[68:71], s14 offen lds
    s_add_u32 m0, s67, 5120
    s_mov_b32 s14, 327680
    buffer_load_dwordx4 v8, s[68:71], s14 offen lds
    s_add_u32 m0, s67, 6144
    s_mov_b32 s14, 393216
    buffer_load_dwordx4 v8, s[68:71], s14 offen lds
    s_add_u32 m0, s67, 7168
    s_mov_b32 s14, 458752
    buffer_load_dwordx4 v8, s[68:71], s14 offen lds
    s_add_u32 m0, s67, 8192
    s_mov_b32 s14, 524288
    buffer_load_dwordx4 v8, s[68:71], s14 offen lds
    s_add_u32 m0, s67, 9216
    s_mov_b32 s14, 589824
    buffer_load_dwordx4 v8, s[68:71], s14 offen lds
    s_add_u32 m0, s67, 10240
    s_mov_b32 s14, 655360
    buffer_load_dwordx4 v8, s[68:71], s14 offen lds
    s_add_u32 m0, s67, 11264
    s_mov_b32 s14, 720896
    buffer_load_dwordx4 v8, s[68:71], s14 offen lds
    s_add_u32 m0, s67, 12288
    s_mov_b32 s14, 786432
    buffer_load_dwordx4 v8, s[68:71], s14 offen lds
    s_add_u32 m0, s67, 13312
    s_mov_b32 s14, 851968
    buffer_load_dwordx4 v8, s[68:71], s14 offen lds
    s_add_u32 m0, s67, 14336
    s_mov_b32 s14, 917504
    buffer_load_dwordx4 v8, s[68:71], s14 offen lds
    s_add_u32 m0, s67, 15360
    s_mov_b32 s14, 983040
    buffer_load_dwordx4 v8, s[68:71], s14 offen lds
    s_add_u32 m0, s67, 16384
    s_mov_b32 s14, 1048576
    buffer_load_dwordx4 v8, s[68:71], s14 offen lds
    s_add_u32 m0, s67, 17408
    s_mov_b32 s14, 1114112
    buffer_load_dwordx4 v8, s[68:71], s14 offen lds
    s_add_u32 m0, s67, 18432
    s_mov_b32 s14, 1179648
    buffer_load_dwordx4 v8, s[68:71], s14 offen lds
    s_add_u32 m0, s67, 19456
    s_mov_b32 s14, 1245184
    buffer_load_dwordx4 v8, s[68:71], s14 offen lds
    s_add_u32 m0, s67, 20480
    s_mov_b32 s14, 1310720
    buffer_load_dwordx4 v8, s[68:71], s14 offen lds
    s_add_u32 m0, s67, 21504
    s_mov_b32 s14, 1376256
    buffer_load_dwordx4 v8, s[68:71], s14 offen lds
    s_add_u32 m0, s67, 22528
    s_mov_b32 s14, 1441792
    buffer_load_dwordx4 v8, s[68:71], s14 offen lds
    s_add_u32 m0, s67, 23552
    s_mov_b32 s14, 1507328
    buffer_load_dwordx4 v8, s[68:71], s14 offen lds
    s_add_u32 m0, s67, 24576
    s_mov_b32 s14, 1572864
    buffer_load_dwordx4 v8, s[68:71], s14 offen lds
    s_add_u32 m0, s67, 25600
    s_mov_b32 s14, 1638400
    buffer_load_dwordx4 v8, s[68:71], s14 offen lds
    s_add_u32 m0, s67, 26624
    s_mov_b32 s14, 1703936
    buffer_load_dwordx4 v8, s[68:71], s14 offen lds
    s_add_u32 m0, s67, 27648
    s_mov_b32 s14, 1769472
    buffer_load_dwordx4 v8, s[68:71], s14 offen lds
    v_mov_b32 v6, 0
    s_mov_b64 exec, 1
    buffer_store_dword v6, off, s[60:63], s65 sc1
    s_mov_b64 exec, -1
    s_add_u32 s10, s64, 2
    s_lshl_b32 s11, s10, 9
    s_lshl_b32 s9, s5, 4
    s_add_u32 s11, s11, s9
    s_lshl_b32 s9, s3, 2
    s_add_u32 s11, s11, s9
    s_add_u32 s11, s11, 6897664
    v_mov_b32 v6, 0
    s_mov_b64 exec, 1
    buffer_store_dword v6, off, s[60:63], s11 sc1
    s_mov_b64 exec, -1
    v_lshlrev_b32 v6, 10, v2
    v_add_u32 v6, s67, v6
    s_cmp_ge_u32 s3, 2
    s_cselect_b32 s9, 2, 3
    s_cselect_b32 s10, 64, 4
    v_lshlrev_b32 v7, s9, v3
    v_add_u32 v6, v6, v7
    v_add_u32 v7, s10, v6
    s_mov_b32 s12, 84148480
    s_mov_b32 s13, 117834498
    s_waitcnt vmcnt(24)
    ds_read_b32 v16, v6 offset:0
    ds_read_b32 v17, v6 offset:128
    ds_read_b32 v18, v6 offset:256
    ds_read_b32 v19, v6 offset:384
    ds_read_b32 v20, v6 offset:512
    ds_read_b32 v21, v6 offset:640
    ds_read_b32 v22, v6 offset:768
    ds_read_b32 v23, v6 offset:896
    s_add_u32 m0, s67, 28672
    s_mov_b32 s14, 1835008
    buffer_load_dwordx4 v8, s[68:71], s14 offen lds
    s_add_u32 m0, s67, 29696
    s_mov_b32 s14, 1900544
    buffer_load_dwordx4 v8, s[68:71], s14 offen lds
    s_add_u32 m0, s67, 30720
    s_mov_b32 s14, 1966080
    buffer_load_dwordx4 v8, s[68:71], s14 offen lds
    s_add_u32 m0, s67, 31744
    s_mov_b32 s14, 2031616
    buffer_load_dwordx4 v8, s[68:71], s14 offen lds
    s_waitcnt lgkmcnt(0)
    v_perm_b32 v32, v17, v16, s12
    v_accvgpr_write_b32 a0, v32
    v_perm_b32 v33, v19, v18, s12
    v_accvgpr_write_b32 a1, v33
    v_perm_b32 v32, v21, v20, s12
    v_accvgpr_write_b32 a2, v32
    v_perm_b32 v33, v23, v22, s12
    v_accvgpr_write_b32 a3, v33
    v_perm_b32 v32, v17, v16, s13
    v_accvgpr_write_b32 a4, v32
    v_perm_b32 v33, v19, v18, s13
    v_accvgpr_write_b32 a5, v33
    v_perm_b32 v32, v21, v20, s13
    v_accvgpr_write_b32 a6, v32
    v_perm_b32 v33, v23, v22, s13
    v_accvgpr_write_b32 a7, v33
    ds_read_b32 v24, v7 offset:0
    ds_read_b32 v25, v7 offset:128
    ds_read_b32 v26, v7 offset:256
    ds_read_b32 v27, v7 offset:384
    ds_read_b32 v28, v7 offset:512
    ds_read_b32 v29, v7 offset:640
    ds_read_b32 v30, v7 offset:768
    ds_read_b32 v31, v7 offset:896
    s_waitcnt lgkmcnt(0)
    v_perm_b32 v32, v25, v24, s12
    v_accvgpr_write_b32 a8, v32
    v_perm_b32 v33, v27, v26, s12
    v_accvgpr_write_b32 a9, v33
    v_perm_b32 v32, v29, v28, s12
    v_accvgpr_write_b32 a10, v32
    v_perm_b32 v33, v31, v30, s12
    v_accvgpr_write_b32 a11, v33
    v_perm_b32 v32, v25, v24, s13
    v_accvgpr_write_b32 a12, v32
    v_perm_b32 v33, v27, v26, s13
    v_accvgpr_write_b32 a13, v33
    v_perm_b32 v32, v29, v28, s13
    v_accvgpr_write_b32 a14, v32
    v_perm_b32 v33, v31, v30, s13
    v_accvgpr_write_b32 a15, v33
    s_waitcnt vmcnt(24)
    ds_read_b32 v16, v6 offset:4096
    ds_read_b32 v17, v6 offset:4224
    ds_read_b32 v18, v6 offset:4352
    ds_read_b32 v19, v6 offset:4480
    ds_read_b32 v20, v6 offset:4608
    ds_read_b32 v21, v6 offset:4736
    ds_read_b32 v22, v6 offset:4864
    ds_read_b32 v23, v6 offset:4992
    s_add_u32 m0, s67, 0
    s_mov_b32 s14, 2097152
    buffer_load_dwordx4 v8, s[68:71], s14 offen lds
    s_add_u32 m0, s67, 1024
    s_mov_b32 s14, 2162688
    buffer_load_dwordx4 v8, s[68:71], s14 offen lds
    s_add_u32 m0, s67, 2048
    s_mov_b32 s14, 2228224
    buffer_load_dwordx4 v8, s[68:71], s14 offen lds
    s_add_u32 m0, s67, 3072
    s_mov_b32 s14, 2293760
    buffer_load_dwordx4 v8, s[68:71], s14 offen lds
    s_waitcnt lgkmcnt(0)
    v_perm_b32 v32, v17, v16, s12
    v_accvgpr_write_b32 a16, v32
    v_perm_b32 v33, v19, v18, s12
    v_accvgpr_write_b32 a17, v33
    v_perm_b32 v32, v21, v20, s12
    v_accvgpr_write_b32 a18, v32
    v_perm_b32 v33, v23, v22, s12
    v_accvgpr_write_b32 a19, v33
    v_perm_b32 v32, v17, v16, s13
    v_accvgpr_write_b32 a20, v32
    v_perm_b32 v33, v19, v18, s13
    v_accvgpr_write_b32 a21, v33
    v_perm_b32 v32, v21, v20, s13
    v_accvgpr_write_b32 a22, v32
    v_perm_b32 v33, v23, v22, s13
    v_accvgpr_write_b32 a23, v33
    ds_read_b32 v24, v7 offset:4096
    ds_read_b32 v25, v7 offset:4224
    ds_read_b32 v26, v7 offset:4352
    ds_read_b32 v27, v7 offset:4480
    ds_read_b32 v28, v7 offset:4608
    ds_read_b32 v29, v7 offset:4736
    ds_read_b32 v30, v7 offset:4864
    ds_read_b32 v31, v7 offset:4992
    s_waitcnt lgkmcnt(0)
    v_perm_b32 v32, v25, v24, s12
    v_accvgpr_write_b32 a24, v32
    v_perm_b32 v33, v27, v26, s12
    v_accvgpr_write_b32 a25, v33
    v_perm_b32 v32, v29, v28, s12
    v_accvgpr_write_b32 a26, v32
    v_perm_b32 v33, v31, v30, s12
    v_accvgpr_write_b32 a27, v33
    v_perm_b32 v32, v25, v24, s13
    v_accvgpr_write_b32 a28, v32
    v_perm_b32 v33, v27, v26, s13
    v_accvgpr_write_b32 a29, v33
    v_perm_b32 v32, v29, v28, s13
    v_accvgpr_write_b32 a30, v32
    v_perm_b32 v33, v31, v30, s13
    v_accvgpr_write_b32 a31, v33
    s_waitcnt vmcnt(24)
    ds_read_b32 v16, v6 offset:8192
    ds_read_b32 v17, v6 offset:8320
    ds_read_b32 v18, v6 offset:8448
    ds_read_b32 v19, v6 offset:8576
    ds_read_b32 v20, v6 offset:8704
    ds_read_b32 v21, v6 offset:8832
    ds_read_b32 v22, v6 offset:8960
    ds_read_b32 v23, v6 offset:9088
    s_add_u32 m0, s67, 4096
    s_mov_b32 s14, 2359296
    buffer_load_dwordx4 v8, s[68:71], s14 offen lds
    s_add_u32 m0, s67, 5120
    s_mov_b32 s14, 2424832
    buffer_load_dwordx4 v8, s[68:71], s14 offen lds
    s_add_u32 m0, s67, 6144
    s_mov_b32 s14, 2490368
    buffer_load_dwordx4 v8, s[68:71], s14 offen lds
    s_add_u32 m0, s67, 7168
    s_mov_b32 s14, 2555904
    buffer_load_dwordx4 v8, s[68:71], s14 offen lds
    s_waitcnt lgkmcnt(0)
    v_perm_b32 v32, v17, v16, s12
    v_accvgpr_write_b32 a32, v32
    v_perm_b32 v33, v19, v18, s12
    v_accvgpr_write_b32 a33, v33
    v_perm_b32 v32, v21, v20, s12
    v_accvgpr_write_b32 a34, v32
    v_perm_b32 v33, v23, v22, s12
    v_accvgpr_write_b32 a35, v33
    v_perm_b32 v32, v17, v16, s13
    v_accvgpr_write_b32 a36, v32
    v_perm_b32 v33, v19, v18, s13
    v_accvgpr_write_b32 a37, v33
    v_perm_b32 v32, v21, v20, s13
    v_accvgpr_write_b32 a38, v32
    v_perm_b32 v33, v23, v22, s13
    v_accvgpr_write_b32 a39, v33
    ds_read_b32 v24, v7 offset:8192
    ds_read_b32 v25, v7 offset:8320
    ds_read_b32 v26, v7 offset:8448
    ds_read_b32 v27, v7 offset:8576
    ds_read_b32 v28, v7 offset:8704
    ds_read_b32 v29, v7 offset:8832
    ds_read_b32 v30, v7 offset:8960
    ds_read_b32 v31, v7 offset:9088
    s_waitcnt lgkmcnt(0)
    v_perm_b32 v32, v25, v24, s12
    v_accvgpr_write_b32 a40, v32
    v_perm_b32 v33, v27, v26, s12
    v_accvgpr_write_b32 a41, v33
    v_perm_b32 v32, v29, v28, s12
    v_accvgpr_write_b32 a42, v32
    v_perm_b32 v33, v31, v30, s12
    v_accvgpr_write_b32 a43, v33
    v_perm_b32 v32, v25, v24, s13
    v_accvgpr_write_b32 a44, v32
    v_perm_b32 v33, v27, v26, s13
    v_accvgpr_write_b32 a45, v33
    v_perm_b32 v32, v29, v28, s13
    v_accvgpr_write_b32 a46, v32
    v_perm_b32 v33, v31, v30, s13
    v_accvgpr_write_b32 a47, v33
    s_waitcnt vmcnt(24)
    ds_read_b32 v16, v6 offset:12288
    ds_read_b32 v17, v6 offset:12416
    ds_read_b32 v18, v6 offset:12544
    ds_read_b32 v19, v6 offset:12672
    ds_read_b32 v20, v6 offset:12800
    ds_read_b32 v21, v6 offset:12928
    ds_read_b32 v22, v6 offset:13056
    ds_read_b32 v23, v6 offset:13184
    s_add_u32 m0, s67, 8192
    s_mov_b32 s14, 2621440
    buffer_load_dwordx4 v8, s[68:71], s14 offen lds
    s_add_u32 m0, s67, 9216
    s_mov_b32 s14, 2686976
    buffer_load_dwordx4 v8, s[68:71], s14 offen lds
    s_add_u32 m0, s67, 10240
    s_mov_b32 s14, 2752512
    buffer_load_dwordx4 v8, s[68:71], s14 offen lds
    s_add_u32 m0, s67, 11264
    s_mov_b32 s14, 2818048
    buffer_load_dwordx4 v8, s[68:71], s14 offen lds
    s_waitcnt lgkmcnt(0)
    v_perm_b32 v32, v17, v16, s12
    v_accvgpr_write_b32 a48, v32
    v_perm_b32 v33, v19, v18, s12
    v_accvgpr_write_b32 a49, v33
    v_perm_b32 v32, v21, v20, s12
    v_accvgpr_write_b32 a50, v32
    v_perm_b32 v33, v23, v22, s12
    v_accvgpr_write_b32 a51, v33
    v_perm_b32 v32, v17, v16, s13
    v_accvgpr_write_b32 a52, v32
    v_perm_b32 v33, v19, v18, s13
    v_accvgpr_write_b32 a53, v33
    v_perm_b32 v32, v21, v20, s13
    v_accvgpr_write_b32 a54, v32
    v_perm_b32 v33, v23, v22, s13
    v_accvgpr_write_b32 a55, v33
    ds_read_b32 v24, v7 offset:12288
    ds_read_b32 v25, v7 offset:12416
    ds_read_b32 v26, v7 offset:12544
    ds_read_b32 v27, v7 offset:12672
    ds_read_b32 v28, v7 offset:12800
    ds_read_b32 v29, v7 offset:12928
    ds_read_b32 v30, v7 offset:13056
    ds_read_b32 v31, v7 offset:13184
    s_waitcnt lgkmcnt(0)
    v_perm_b32 v32, v25, v24, s12
    v_accvgpr_write_b32 a56, v32
    v_perm_b32 v33, v27, v26, s12
    v_accvgpr_write_b32 a57, v33
    v_perm_b32 v32, v29, v28, s12
    v_accvgpr_write_b32 a58, v32
    v_perm_b32 v33, v31, v30, s12
    v_accvgpr_write_b32 a59, v33
    v_perm_b32 v32, v25, v24, s13
    v_accvgpr_write_b32 a60, v32
    v_perm_b32 v33, v27, v26, s13
    v_accvgpr_write_b32 a61, v33
    v_perm_b32 v32, v29, v28, s13
    v_accvgpr_write_b32 a62, v32
    v_perm_b32 v33, v31, v30, s13
    v_accvgpr_write_b32 a63, v33
    s_waitcnt vmcnt(24)
    ds_read_b32 v16, v6 offset:16384
    ds_read_b32 v17, v6 offset:16512
    ds_read_b32 v18, v6 offset:16640
    ds_read_b32 v19, v6 offset:16768
    ds_read_b32 v20, v6 offset:16896
    ds_read_b32 v21, v6 offset:17024
    ds_read_b32 v22, v6 offset:17152
    ds_read_b32 v23, v6 offset:17280
    s_add_u32 m0, s67, 12288
    s_mov_b32 s14, 2883584
    buffer_load_dwordx4 v8, s[68:71], s14 offen lds
    s_add_u32 m0, s67, 13312
    s_mov_b32 s14, 2949120
    buffer_load_dwordx4 v8, s[68:71], s14 offen lds
    s_add_u32 m0, s67, 14336
    s_mov_b32 s14, 3014656
    buffer_load_dwordx4 v8, s[68:71], s14 offen lds
    s_add_u32 m0, s67, 15360
    s_mov_b32 s14, 3080192
    buffer_load_dwordx4 v8, s[68:71], s14 offen lds
    s_waitcnt lgkmcnt(0)
    v_perm_b32 v32, v17, v16, s12
    v_accvgpr_write_b32 a64, v32
    v_perm_b32 v33, v19, v18, s12
    v_accvgpr_write_b32 a65, v33
    v_perm_b32 v32, v21, v20, s12
    v_accvgpr_write_b32 a66, v32
    v_perm_b32 v33, v23, v22, s12
    v_accvgpr_write_b32 a67, v33
    v_perm_b32 v32, v17, v16, s13
    v_accvgpr_write_b32 a68, v32
    v_perm_b32 v33, v19, v18, s13
    v_accvgpr_write_b32 a69, v33
    v_perm_b32 v32, v21, v20, s13
    v_accvgpr_write_b32 a70, v32
    v_perm_b32 v33, v23, v22, s13
    v_accvgpr_write_b32 a71, v33
    ds_read_b32 v24, v7 offset:16384
    ds_read_b32 v25, v7 offset:16512
    ds_read_b32 v26, v7 offset:16640
    ds_read_b32 v27, v7 offset:16768
    ds_read_b32 v28, v7 offset:16896
    ds_read_b32 v29, v7 offset:17024
    ds_read_b32 v30, v7 offset:17152
    ds_read_b32 v31, v7 offset:17280
    s_waitcnt lgkmcnt(0)
    v_perm_b32 v32, v25, v24, s12
    v_accvgpr_write_b32 a72, v32
    v_perm_b32 v33, v27, v26, s12
    v_accvgpr_write_b32 a73, v33
    v_perm_b32 v32, v29, v28, s12
    v_accvgpr_write_b32 a74, v32
    v_perm_b32 v33, v31, v30, s12
    v_accvgpr_write_b32 a75, v33
    v_perm_b32 v32, v25, v24, s13
    v_accvgpr_write_b32 a76, v32
    v_perm_b32 v33, v27, v26, s13
    v_accvgpr_write_b32 a77, v33
    v_perm_b32 v32, v29, v28, s13
    v_accvgpr_write_b32 a78, v32
    v_perm_b32 v33, v31, v30, s13
    v_accvgpr_write_b32 a79, v33
    s_waitcnt vmcnt(24)
    ds_read_b32 v16, v6 offset:20480
    ds_read_b32 v17, v6 offset:20608
    ds_read_b32 v18, v6 offset:20736
    ds_read_b32 v19, v6 offset:20864
    ds_read_b32 v20, v6 offset:20992
    ds_read_b32 v21, v6 offset:21120
    ds_read_b32 v22, v6 offset:21248
    ds_read_b32 v23, v6 offset:21376
    s_add_u32 m0, s67, 16384
    s_mov_b32 s14, 3145728
    buffer_load_dwordx4 v8, s[68:71], s14 offen lds
    s_add_u32 m0, s67, 17408
    s_mov_b32 s14, 3211264
    buffer_load_dwordx4 v8, s[68:71], s14 offen lds
    s_add_u32 m0, s67, 18432
    s_mov_b32 s14, 3276800
    buffer_load_dwordx4 v8, s[68:71], s14 offen lds
    s_add_u32 m0, s67, 19456
    s_mov_b32 s14, 3342336
    buffer_load_dwordx4 v8, s[68:71], s14 offen lds
    s_waitcnt lgkmcnt(0)
    v_perm_b32 v32, v17, v16, s12
    v_accvgpr_write_b32 a80, v32
    v_perm_b32 v33, v19, v18, s12
    v_accvgpr_write_b32 a81, v33
    v_perm_b32 v32, v21, v20, s12
    v_accvgpr_write_b32 a82, v32
    v_perm_b32 v33, v23, v22, s12
    v_accvgpr_write_b32 a83, v33
    v_perm_b32 v32, v17, v16, s13
    v_accvgpr_write_b32 a84, v32
    v_perm_b32 v33, v19, v18, s13
    v_accvgpr_write_b32 a85, v33
    v_perm_b32 v32, v21, v20, s13
    v_accvgpr_write_b32 a86, v32
    v_perm_b32 v33, v23, v22, s13
    v_accvgpr_write_b32 a87, v33
    ds_read_b32 v24, v7 offset:20480
    ds_read_b32 v25, v7 offset:20608
    ds_read_b32 v26, v7 offset:20736
    ds_read_b32 v27, v7 offset:20864
    ds_read_b32 v28, v7 offset:20992
    ds_read_b32 v29, v7 offset:21120
    ds_read_b32 v30, v7 offset:21248
    ds_read_b32 v31, v7 offset:21376
    s_waitcnt lgkmcnt(0)
    v_perm_b32 v32, v25, v24, s12
    v_accvgpr_write_b32 a88, v32
    v_perm_b32 v33, v27, v26, s12
    v_accvgpr_write_b32 a89, v33
    v_perm_b32 v32, v29, v28, s12
    v_accvgpr_write_b32 a90, v32
    v_perm_b32 v33, v31, v30, s12
    v_accvgpr_write_b32 a91, v33
    v_perm_b32 v32, v25, v24, s13
    v_accvgpr_write_b32 a92, v32
    v_perm_b32 v33, v27, v26, s13
    v_accvgpr_write_b32 a93, v33
    v_perm_b32 v32, v29, v28, s13
    v_accvgpr_write_b32 a94, v32
    v_perm_b32 v33, v31, v30, s13
    v_accvgpr_write_b32 a95, v33
    s_waitcnt vmcnt(24)
    ds_read_b32 v16, v6 offset:24576
    ds_read_b32 v17, v6 offset:24704
    ds_read_b32 v18, v6 offset:24832
    ds_read_b32 v19, v6 offset:24960
    ds_read_b32 v20, v6 offset:25088
    ds_read_b32 v21, v6 offset:25216
    ds_read_b32 v22, v6 offset:25344
    ds_read_b32 v23, v6 offset:25472
    s_add_u32 m0, s67, 20480
    s_mov_b32 s14, 3407872
    buffer_load_dwordx4 v8, s[68:71], s14 offen lds
    s_add_u32 m0, s67, 21504
    s_mov_b32 s14, 3473408
    buffer_load_dwordx4 v8, s[68:71], s14 offen lds
    s_add_u32 m0, s67, 22528
    s_mov_b32 s14, 3538944
    buffer_load_dwordx4 v8, s[68:71], s14 offen lds
    s_add_u32 m0, s67, 23552
    s_mov_b32 s14, 3604480
    buffer_load_dwordx4 v8, s[68:71], s14 offen lds
    s_waitcnt lgkmcnt(0)
    v_perm_b32 v32, v17, v16, s12
    v_accvgpr_write_b32 a96, v32
    v_perm_b32 v33, v19, v18, s12
    v_accvgpr_write_b32 a97, v33
    v_perm_b32 v32, v21, v20, s12
    v_accvgpr_write_b32 a98, v32
    v_perm_b32 v33, v23, v22, s12
    v_accvgpr_write_b32 a99, v33
    v_perm_b32 v32, v17, v16, s13
    v_accvgpr_write_b32 a100, v32
    v_perm_b32 v33, v19, v18, s13
    v_accvgpr_write_b32 a101, v33
    v_perm_b32 v32, v21, v20, s13
    v_accvgpr_write_b32 a102, v32
    v_perm_b32 v33, v23, v22, s13
    v_accvgpr_write_b32 a103, v33
    ds_read_b32 v24, v7 offset:24576
    ds_read_b32 v25, v7 offset:24704
    ds_read_b32 v26, v7 offset:24832
    ds_read_b32 v27, v7 offset:24960
    ds_read_b32 v28, v7 offset:25088
    ds_read_b32 v29, v7 offset:25216
    ds_read_b32 v30, v7 offset:25344
    ds_read_b32 v31, v7 offset:25472
    s_waitcnt lgkmcnt(0)
    v_perm_b32 v32, v25, v24, s12
    v_accvgpr_write_b32 a104, v32
    v_perm_b32 v33, v27, v26, s12
    v_accvgpr_write_b32 a105, v33
    v_perm_b32 v32, v29, v28, s12
    v_accvgpr_write_b32 a106, v32
    v_perm_b32 v33, v31, v30, s12
    v_accvgpr_write_b32 a107, v33
    v_perm_b32 v32, v25, v24, s13
    v_accvgpr_write_b32 a108, v32
    v_perm_b32 v33, v27, v26, s13
    v_accvgpr_write_b32 a109, v33
    v_perm_b32 v32, v29, v28, s13
    v_accvgpr_write_b32 a110, v32
    v_perm_b32 v33, v31, v30, s13
    v_accvgpr_write_b32 a111, v33
    s_waitcnt vmcnt(24)
    s_waitcnt vmcnt(63)
    s_barrier
    s_cmp_lg_u32 s3, 0
    s_cbranch_scc1 pt_1
    s_or_b32 s9, s6, 192
    s_and_b32 s10, s5, 3
    s_lshl_b32 s10, s10, 3
    s_lshl_b32 s9, s9, s10
    v_mov_b32 v10, s9
    s_lshl_b32 s10, s4, 5
    s_and_b32 s11, s5, 0x1c
    s_add_u32 s10, s10, s11
    s_mov_b64 exec, 1
    buffer_atomic_or v10, off, s[56:59], s10 sc1
    s_mov_b64 exec, -1
pt_1:
    ds_read_b32 v16, v6 offset:28672
    ds_read_b32 v17, v6 offset:28800
    ds_read_b32 v18, v6 offset:28928
    ds_read_b32 v19, v6 offset:29056
    ds_read_b32 v20, v6 offset:29184
    ds_read_b32 v21, v6 offset:29312
    ds_read_b32 v22, v6 offset:29440
    ds_read_b32 v23, v6 offset:29568
    s_add_u32 m0, s67, 24576
    s_mov_b32 s14, 3670016
    buffer_load_dwordx4 v8, s[68:71], s14 offen lds
    s_add_u32 m0, s67, 25600
    s_mov_b32 s14, 3735552
    buffer_load_dwordx4 v8, s[68:71], s14 offen lds
    s_add_u32 m0, s67, 26624
    s_mov_b32 s14, 3801088
    buffer_load_dwordx4 v8, s[68:71], s14 offen lds
    s_add_u32 m0, s67, 27648
    s_mov_b32 s14, 3866624
    buffer_load_dwordx4 v8, s[68:71], s14 offen lds
    s_waitcnt lgkmcnt(0)
    v_perm_b32 v32, v17, v16, s12
    v_accvgpr_write_b32 a112, v32
    v_perm_b32 v33, v19, v18, s12
    v_accvgpr_write_b32 a113, v33
    v_perm_b32 v32, v21, v20, s12
    v_accvgpr_write_b32 a114, v32
    v_perm_b32 v33, v23, v22, s12
    v_accvgpr_write_b32 a115, v33
    v_perm_b32 v32, v17, v16, s13
    v_accvgpr_write_b32 a116, v32
    v_perm_b32 v33, v19, v18, s13
    v_accvgpr_write_b32 a117, v33
    v_perm_b32 v32, v21, v20, s13
    v_accvgpr_write_b32 a118, v32
    v_perm_b32 v33, v23, v22, s13
    v_accvgpr_write_b32 a119, v33
    ds_read_b32 v24, v7 offset:28672
    ds_read_b32 v25, v7 offset:28800
    ds_read_b32 v26, v7 offset:28928
    ds_read_b32 v27, v7 offset:29056
    ds_read_b32 v28, v7 offset:29184
    ds_read_b32 v29, v7 offset:29312
    ds_read_b32 v30, v7 offset:29440
    ds_read_b32 v31, v7 offset:29568
    s_waitcnt lgkmcnt(0)
    v_perm_b32 v32, v25, v24, s12
    v_accvgpr_write_b32 a120, v32
    v_perm_b32 v33, v27, v26, s12
    v_accvgpr_write_b32 a121, v33
    v_perm_b32 v32, v29, v28, s12
    v_accvgpr_write_b32 a122, v32
    v_perm_b32 v33, v31, v30, s12
    v_accvgpr_write_b32 a123, v33
    v_perm_b32 v32, v25, v24, s13
    v_accvgpr_write_b32 a124, v32
    v_perm_b32 v33, v27, v26, s13
    v_accvgpr_write_b32 a125, v33
    v_perm_b32 v32, v29, v28, s13
    v_accvgpr_write_b32 a126, v32
    v_perm_b32 v33, v31, v30, s13
    v_accvgpr_write_b32 a127, v33
    s_waitcnt vmcnt(24)
    ds_read_b32 v16, v6 offset:0
    ds_read_b32 v17, v6 offset:128
    ds_read_b32 v18, v6 offset:256
    ds_read_b32 v19, v6 offset:384
    ds_read_b32 v20, v6 offset:512
    ds_read_b32 v21, v6 offset:640
    ds_read_b32 v22, v6 offset:768
    ds_read_b32 v23, v6 offset:896
    s_add_u32 m0, s67, 28672
    s_mov_b32 s14, 3932160
    buffer_load_dwordx4 v8, s[68:71], s14 offen lds
    s_add_u32 m0, s67, 29696
    s_mov_b32 s14, 3997696
    buffer_load_dwordx4 v8, s[68:71], s14 offen lds
    s_add_u32 m0, s67, 30720
    s_mov_b32 s14, 4063232
    buffer_load_dwordx4 v8, s[68:71], s14 offen lds
    s_add_u32 m0, s67, 31744
    s_mov_b32 s14, 4128768
    buffer_load_dwordx4 v8, s[68:71], s14 offen lds
    s_waitcnt lgkmcnt(0)
    v_perm_b32 v32, v17, v16, s12
    v_accvgpr_write_b32 a128, v32
    v_perm_b32 v33, v19, v18, s12
    v_accvgpr_write_b32 a129, v33
    v_perm_b32 v32, v21, v20, s12
    v_accvgpr_write_b32 a130, v32
    v_perm_b32 v33, v23, v22, s12
    v_accvgpr_write_b32 a131, v33
    v_perm_b32 v32, v17, v16, s13
    v_accvgpr_write_b32 a132, v32
    v_perm_b32 v33, v19, v18, s13
    v_accvgpr_write_b32 a133, v33
    v_perm_b32 v32, v21, v20, s13
    v_accvgpr_write_b32 a134, v32
    v_perm_b32 v33, v23, v22, s13
    v_accvgpr_write_b32 a135, v33
    ds_read_b32 v24, v7 offset:0
    ds_read_b32 v25, v7 offset:128
    ds_read_b32 v26, v7 offset:256
    ds_read_b32 v27, v7 offset:384
    ds_read_b32 v28, v7 offset:512
    ds_read_b32 v29, v7 offset:640
    ds_read_b32 v30, v7 offset:768
    ds_read_b32 v31, v7 offset:896
    s_waitcnt lgkmcnt(0)
    v_perm_b32 v32, v25, v24, s12
    v_accvgpr_write_b32 a136, v32
    v_perm_b32 v33, v27, v26, s12
    v_accvgpr_write_b32 a137, v33
    v_perm_b32 v32, v29, v28, s12
    v_accvgpr_write_b32 a138, v32
    v_perm_b32 v33, v31, v30, s12
    v_accvgpr_write_b32 a139, v33
    v_perm_b32 v32, v25, v24, s13
    v_accvgpr_write_b32 a140, v32
    v_perm_b32 v33, v27, v26, s13
    v_accvgpr_write_b32 a141, v33
    v_perm_b32 v32, v29, v28, s13
    v_accvgpr_write_b32 a142, v32
    v_perm_b32 v33, v31, v30, s13
    v_accvgpr_write_b32 a143, v33
    s_waitcnt vmcnt(24)
    ds_read_b32 v16, v6 offset:4096
    ds_read_b32 v17, v6 offset:4224
    ds_read_b32 v18, v6 offset:4352
    ds_read_b32 v19, v6 offset:4480
    ds_read_b32 v20, v6 offset:4608
    ds_read_b32 v21, v6 offset:4736
    ds_read_b32 v22, v6 offset:4864
    ds_read_b32 v23, v6 offset:4992
    s_waitcnt lgkmcnt(0)
    v_perm_b32 v32, v17, v16, s12
    v_accvgpr_write_b32 a144, v32
    v_perm_b32 v33, v19, v18, s12
    v_accvgpr_write_b32 a145, v33
    v_perm_b32 v32, v21, v20, s12
    v_accvgpr_write_b32 a146, v32
    v_perm_b32 v33, v23, v22, s12
    v_accvgpr_write_b32 a147, v33
    v_perm_b32 v32, v17, v16, s13
    v_accvgpr_write_b32 a148, v32
    v_perm_b32 v33, v19, v18, s13
    v_accvgpr_write_b32 a149, v33
    v_perm_b32 v32, v21, v20, s13
    v_accvgpr_write_b32 a150, v32
    v_perm_b32 v33, v23, v22, s13
    v_accvgpr_write_b32 a151, v33
    ds_read_b32 v24, v7 offset:4096
    ds_read_b32 v25, v7 offset:4224
    ds_read_b32 v26, v7 offset:4352
    ds_read_b32 v27, v7 offset:4480
    ds_read_b32 v28, v7 offset:4608
    ds_read_b32 v29, v7 offset:4736
    ds_read_b32 v30, v7 offset:4864
    ds_read_b32 v31, v7 offset:4992
    s_waitcnt lgkmcnt(0)
    v_perm_b32 v32, v25, v24, s12
    v_accvgpr_write_b32 a152, v32
    v_perm_b32 v33, v27, v26, s12
    v_accvgpr_write_b32 a153, v33
    v_perm_b32 v32, v29, v28, s12
    v_accvgpr_write_b32 a154, v32
    v_perm_b32 v33, v31, v30, s12
    v_accvgpr_write_b32 a155, v33
    v_perm_b32 v32, v25, v24, s13
    v_accvgpr_write_b32 a156, v32
    v_perm_b32 v33, v27, v26, s13
    v_accvgpr_write_b32 a157, v33
    v_perm_b32 v32, v29, v28, s13
    v_accvgpr_write_b32 a158, v32
    v_perm_b32 v33, v31, v30, s13
    v_accvgpr_write_b32 a159, v33
    s_waitcnt vmcnt(20)
    ds_read_b32 v16, v6 offset:8192
    ds_read_b32 v17, v6 offset:8320
    ds_read_b32 v18, v6 offset:8448
    ds_read_b32 v19, v6 offset:8576
    ds_read_b32 v20, v6 offset:8704
    ds_read_b32 v21, v6 offset:8832
    ds_read_b32 v22, v6 offset:8960
    ds_read_b32 v23, v6 offset:9088
    s_waitcnt lgkmcnt(0)
    v_perm_b32 v32, v17, v16, s12
    v_accvgpr_write_b32 a160, v32
    v_perm_b32 v33, v19, v18, s12
    v_accvgpr_write_b32 a161, v33
    v_perm_b32 v32, v21, v20, s12
    v_accvgpr_write_b32 a162, v32
    v_perm_b32 v33, v23, v22, s12
    v_accvgpr_write_b32 a163, v33
    v_perm_b32 v32, v17, v16, s13
    v_accvgpr_write_b32 a164, v32
    v_perm_b32 v33, v19, v18, s13
    v_accvgpr_write_b32 a165, v33
    v_perm_b32 v32, v21, v20, s13
    v_accvgpr_write_b32 a166, v32
    v_perm_b32 v33, v23, v22, s13
    v_accvgpr_write_b32 a167, v33
    ds_read_b32 v24, v7 offset:8192
    ds_read_b32 v25, v7 offset:8320
    ds_read_b32 v26, v7 offset:8448
    ds_read_b32 v27, v7 offset:8576
    ds_read_b32 v28, v7 offset:8704
    ds_read_b32 v29, v7 offset:8832
    ds_read_b32 v30, v7 offset:8960
    ds_read_b32 v31, v7 offset:9088
    s_waitcnt lgkmcnt(0)
    v_perm_b32 v32, v25, v24, s12
    v_accvgpr_write_b32 a168, v32
    v_perm_b32 v33, v27, v26, s12
    v_accvgpr_write_b32 a169, v33
    v_perm_b32 v32, v29, v28, s12
    v_accvgpr_write_b32 a170, v32
    v_perm_b32 v33, v31, v30, s12
    v_accvgpr_write_b32 a171, v33
    v_perm_b32 v32, v25, v24, s13
    v_accvgpr_write_b32 a172, v32
    v_perm_b32 v33, v27, v26, s13
    v_accvgpr_write_b32 a173, v33
    v_perm_b32 v32, v29, v28, s13
    v_accvgpr_write_b32 a174, v32
    v_perm_b32 v33, v31, v30, s13
    v_accvgpr_write_b32 a175, v33
    s_waitcnt vmcnt(16)
    ds_read_b32 v16, v6 offset:12288
    ds_read_b32 v17, v6 offset:12416
    ds_read_b32 v18, v6 offset:12544
    ds_read_b32 v19, v6 offset:12672
    ds_read_b32 v20, v6 offset:12800
    ds_read_b32 v21, v6 offset:12928
    ds_read_b32 v22, v6 offset:13056
    ds_read_b32 v23, v6 offset:13184
    s_waitcnt lgkmcnt(0)
    v_perm_b32 v32, v17, v16, s12
    v_accvgpr_write_b32 a176, v32
    v_perm_b32 v33, v19, v18, s12
    v_accvgpr_write_b32 a177, v33
    v_perm_b32 v32, v21, v20, s12
    v_accvgpr_write_b32 a178, v32
    v_perm_b32 v33, v23, v22, s12
    v_accvgpr_write_b32 a179, v33
    v_perm_b32 v32, v17, v16, s13
    v_accvgpr_write_b32 a180, v32
    v_perm_b32 v33, v19, v18, s13
    v_accvgpr_write_b32 a181, v33
    v_perm_b32 v32, v21, v20, s13
    v_accvgpr_write_b32 a182, v32
    v_perm_b32 v33, v23, v22, s13
    v_accvgpr_write_b32 a183, v33
    ds_read_b32 v24, v7 offset:12288
    ds_read_b32 v25, v7 offset:12416
    ds_read_b32 v26, v7 offset:12544
    ds_read_b32 v27, v7 offset:12672
    ds_read_b32 v28, v7 offset:12800
    ds_read_b32 v29, v7 offset:12928
    ds_read_b32 v30, v7 offset:13056
    ds_read_b32 v31, v7 offset:13184
    s_waitcnt lgkmcnt(0)
    v_perm_b32 v32, v25, v24, s12
    v_accvgpr_write_b32 a184, v32
    v_perm_b32 v33, v27, v26, s12
    v_accvgpr_write_b32 a185, v33
    v_perm_b32 v32, v29, v28, s12
    v_accvgpr_write_b32 a186, v32
    v_perm_b32 v33, v31, v30, s12
    v_accvgpr_write_b32 a187, v33
    v_perm_b32 v32, v25, v24, s13
    v_accvgpr_write_b32 a188, v32
    v_perm_b32 v33, v27, v26, s13
    v_accvgpr_write_b32 a189, v33
    v_perm_b32 v32, v29, v28, s13
    v_accvgpr_write_b32 a190, v32
    v_perm_b32 v33, v31, v30, s13
    v_accvgpr_write_b32 a191, v33
    s_waitcnt vmcnt(12)
    ds_read_b32 v16, v6 offset:16384
    ds_read_b32 v17, v6 offset:16512
    ds_read_b32 v18, v6 offset:16640
    ds_read_b32 v19, v6 offset:16768
    ds_read_b32 v20, v6 offset:16896
    ds_read_b32 v21, v6 offset:17024
    ds_read_b32 v22, v6 offset:17152
    ds_read_b32 v23, v6 offset:17280
    s_waitcnt lgkmcnt(0)
    v_perm_b32 v32, v17, v16, s12
    v_accvgpr_write_b32 a192, v32
    v_perm_b32 v33, v19, v18, s12
    v_accvgpr_write_b32 a193, v33
    v_perm_b32 v32, v21, v20, s12
    v_accvgpr_write_b32 a194, v32
    v_perm_b32 v33, v23, v22, s12
    v_accvgpr_write_b32 a195, v33
    v_perm_b32 v32, v17, v16, s13
    v_accvgpr_write_b32 a196, v32
    v_perm_b32 v33, v19, v18, s13
    v_accvgpr_write_b32 a197, v33
    v_perm_b32 v32, v21, v20, s13
    v_accvgpr_write_b32 a198, v32
    v_perm_b32 v33, v23, v22, s13
    v_accvgpr_write_b32 a199, v33
    ds_read_b32 v24, v7 offset:16384
    ds_read_b32 v25, v7 offset:16512
    ds_read_b32 v26, v7 offset:16640
    ds_read_b32 v27, v7 offset:16768
    ds_read_b32 v28, v7 offset:16896
    ds_read_b32 v29, v7 offset:17024
    ds_read_b32 v30, v7 offset:17152
    ds_read_b32 v31, v7 offset:17280
    s_waitcnt lgkmcnt(0)
    v_perm_b32 v32, v25, v24, s12
    v_accvgpr_write_b32 a200, v32
    v_perm_b32 v33, v27, v26, s12
    v_accvgpr_write_b32 a201, v33
    v_perm_b32 v32, v29, v28, s12
    v_accvgpr_write_b32 a202, v32
    v_perm_b32 v33, v31, v30, s12
    v_accvgpr_write_b32 a203, v33
    v_perm_b32 v32, v25, v24, s13
    v_accvgpr_write_b32 a204, v32
    v_perm_b32 v33, v27, v26, s13
    v_accvgpr_write_b32 a205, v33
    v_perm_b32 v32, v29, v28, s13
    v_accvgpr_write_b32 a206, v32
    v_perm_b32 v33, v31, v30, s13
    v_accvgpr_write_b32 a207, v33
    s_waitcnt vmcnt(8)
    ds_read_b32 v16, v6 offset:20480
    ds_read_b32 v17, v6 offset:20608
    ds_read_b32 v18, v6 offset:20736
    ds_read_b32 v19, v6 offset:20864
    ds_read_b32 v20, v6 offset:20992
    ds_read_b32 v21, v6 offset:21120
    ds_read_b32 v22, v6 offset:21248
    ds_read_b32 v23, v6 offset:21376
    s_waitcnt lgkmcnt(0)
    v_perm_b32 v32, v17, v16, s12
    v_accvgpr_write_b32 a208, v32
    v_perm_b32 v33, v19, v18, s12
    v_accvgpr_write_b32 a209, v33
    v_perm_b32 v32, v21, v20, s12
    v_accvgpr_write_b32 a210, v32
    v_perm_b32 v33, v23, v22, s12
    v_accvgpr_write_b32 a211, v33
    v_perm_b32 v32, v17, v16, s13
    v_accvgpr_write_b32 a212, v32
    v_perm_b32 v33, v19, v18, s13
    v_accvgpr_write_b32 a213, v33
    v_perm_b32 v32, v21, v20, s13
    v_accvgpr_write_b32 a214, v32
    v_perm_b32 v33, v23, v22, s13
    v_accvgpr_write_b32 a215, v33
    ds_read_b32 v24, v7 offset:20480
    ds_read_b32 v25, v7 offset:20608
    ds_read_b32 v26, v7 offset:20736
    ds_read_b32 v27, v7 offset:20864
    ds_read_b32 v28, v7 offset:20992
    ds_read_b32 v29, v7 offset:21120
    ds_read_b32 v30, v7 offset:21248
    ds_read_b32 v31, v7 offset:21376
    s_waitcnt lgkmcnt(0)
    v_perm_b32 v32, v25, v24, s12
    v_accvgpr_write_b32 a216, v32
    v_perm_b32 v33, v27, v26, s12
    v_accvgpr_write_b32 a217, v33
    v_perm_b32 v32, v29, v28, s12
    v_accvgpr_write_b32 a218, v32
    v_perm_b32 v33, v31, v30, s12
    v_accvgpr_write_b32 a219, v33
    v_perm_b32 v32, v25, v24, s13
    v_accvgpr_write_b32 a220, v32
    v_perm_b32 v33, v27, v26, s13
    v_accvgpr_write_b32 a221, v33
    v_perm_b32 v32, v29, v28, s13
    v_accvgpr_write_b32 a222, v32
    v_perm_b32 v33, v31, v30, s13
    v_accvgpr_write_b32 a223, v33
    s_waitcnt vmcnt(4)
    ds_read_b32 v16, v6 offset:24576
    ds_read_b32 v17, v6 offset:24704
    ds_read_b32 v18, v6 offset:24832
    ds_read_b32 v19, v6 offset:24960
    ds_read_b32 v20, v6 offset:25088
    ds_read_b32 v21, v6 offset:25216
    ds_read_b32 v22, v6 offset:25344
    ds_read_b32 v23, v6 offset:25472
    s_waitcnt lgkmcnt(0)
    v_perm_b32 v32, v17, v16, s12
    v_accvgpr_write_b32 a224, v32
    v_perm_b32 v33, v19, v18, s12
    v_accvgpr_write_b32 a225, v33
    v_perm_b32 v32, v21, v20, s12
    v_accvgpr_write_b32 a226, v32
    v_perm_b32 v33, v23, v22, s12
    v_accvgpr_write_b32 a227, v33
    v_perm_b32 v32, v17, v16, s13
    v_accvgpr_write_b32 a228, v32
    v_perm_b32 v33, v19, v18, s13
    v_accvgpr_write_b32 a229, v33
    v_perm_b32 v32, v21, v20, s13
    v_accvgpr_write_b32 a230, v32
    v_perm_b32 v33, v23, v22, s13
    v_accvgpr_write_b32 a231, v33
    ds_read_b32 v24, v7 offset:24576
    ds_read_b32 v25, v7 offset:24704
    ds_read_b32 v26, v7 offset:24832
    ds_read_b32 v27, v7 offset:24960
    ds_read_b32 v28, v7 offset:25088
    ds_read_b32 v29, v7 offset:25216
    ds_read_b32 v30, v7 offset:25344
    ds_read_b32 v31, v7 offset:25472
    s_waitcnt lgkmcnt(0)
    v_perm_b32 v32, v25, v24, s12
    v_accvgpr_write_b32 a232, v32
    v_perm_b32 v33, v27, v26, s12
    v_accvgpr_write_b32 a233, v33
    v_perm_b32 v32, v29, v28, s12
    v_accvgpr_write_b32 a234, v32
    v_perm_b32 v33, v31, v30, s12
    v_accvgpr_write_b32 a235, v33
    v_perm_b32 v32, v25, v24, s13
    v_accvgpr_write_b32 a236, v32
    v_perm_b32 v33, v27, v26, s13
    v_accvgpr_write_b32 a237, v33
    v_perm_b32 v32, v29, v28, s13
    v_accvgpr_write_b32 a238, v32
    v_perm_b32 v33, v31, v30, s13
    v_accvgpr_write_b32 a239, v33
    s_waitcnt vmcnt(0)
    ds_read_b32 v16, v6 offset:28672
    ds_read_b32 v17, v6 offset:28800
    ds_read_b32 v18, v6 offset:28928
    ds_read_b32 v19, v6 offset:29056
    ds_read_b32 v20, v6 offset:29184
    ds_read_b32 v21, v6 offset:29312
    ds_read_b32 v22, v6 offset:29440
    ds_read_b32 v23, v6 offset:29568
    s_waitcnt lgkmcnt(0)
    v_perm_b32 v32, v17, v16, s12
    v_accvgpr_write_b32 a240, v32
    v_perm_b32 v33, v19, v18, s12
    v_accvgpr_write_b32 a241, v33
    v_perm_b32 v32, v21, v20, s12
    v_accvgpr_write_b32 a242, v32
    v_perm_b32 v33, v23, v22, s12
    v_accvgpr_write_b32 a243, v33
    v_perm_b32 v32, v17, v16, s13
    v_accvgpr_write_b32 a244, v32
    v_perm_b32 v33, v19, v18, s13
    v_accvgpr_write_b32 a245, v33
    v_perm_b32 v32, v21, v20, s13
    v_accvgpr_write_b32 a246, v32
    v_perm_b32 v33, v23, v22, s13
    v_accvgpr_write_b32 a247, v33
    ds_read_b32 v24, v7 offset:28672
    ds_read_b32 v25, v7 offset:28800
    ds_read_b32 v26, v7 offset:28928
    ds_read_b32 v27, v7 offset:29056
    ds_read_b32 v28, v7 offset:29184
    ds_read_b32 v29, v7 offset:29312
    ds_read_b32 v30, v7 offset:29440
    ds_read_b32 v31, v7 offset:29568
    s_waitcnt lgkmcnt(0)
    v_perm_b32 v32, v25, v24, s12
    v_accvgpr_write_b32 a248, v32
    v_perm_b32 v33, v27, v26, s12
    v_accvgpr_write_b32 a249, v33
    v_perm_b32 v32, v29, v28, s12
    v_accvgpr_write_b32 a250, v32
    v_perm_b32 v33, v31, v30, s12
    v_accvgpr_write_b32 a251, v33
    v_perm_b32 v32, v25, v24, s13
    v_accvgpr_write_b32 a252, v32
    v_perm_b32 v33, v27, v26, s13
    v_accvgpr_write_b32 a253, v33
    v_perm_b32 v32, v29, v28, s13
    v_accvgpr_write_b32 a254, v32
    v_perm_b32 v33, v31, v30, s13
    v_accvgpr_write_b32 a255, v33
    s_barrier
wt_2:
    buffer_load_dword v8, v5, s[56:59], 0 offen sc1
    s_waitcnt vmcnt(0)
    s_mov_b32 s9, 2155905152
    v_and_b32 v9, s9, v8
    v_cmp_ne_u32 vcc, s9, v9
    s_and_b32 vcc_lo, vcc_lo, 4278190080
    s_and_b32 vcc_hi, vcc_hi, 16777215
    s_cmp_eq_u64 vcc, 0
    s_cbranch_scc1 wtd_3
    s_sleep 4
    s_sub_u32 s8, s8, 1
    s_cbranch_scc0 wt_2
    s_mov_b32 s8, 0
wtd_3:
    s_mul_i32 s9, s6, 0x01010101
    v_and_b32 v8, 0x0f0f0f0f, v8
    v_cmp_ne_u32 vcc, s9, v8
    s_lshl_b32 s10, s4, 3
    s_lshr_b64 s[10:11], vcc, s10
    s_and_b32 s10, s10, 0xff
    s_cmp_lg_u32 s10, 0
    s_cselect_b32 s7, 1, 0
    s_lshl_b32 s67, s3, 13
    v_add_u32 v8, s67, v4
    v_add_u32 v9, 4096, v8
    s_lshl_b32 s72, s64, 15
    s_mul_i32 s73, s64, 524288
    s_mul_i32 s9, s5, 16384
    s_add_u32 s73, s73, s9
    s_add_u32 s73, s73, 8388608
    s_cmp_ge_u32 s3, 2
    s_cselect_b32 s10, 8192, 0
    s_lshl_b32 s9, s66, 11
    s_add_u32 s9, s9, s10
    v_add_u32 v10, s9, v4
    v_add_u32 v11, 4096, v10
    s_mov_b32 s74, 0
    s_mov_b32 s75, 0
    s_add_u32 s9, s75, s67
    s_mov_b32 m0, s9
    s_nop 0
    buffer_load_dwordx4 v8, s[60:63], s72 offen offset:0 sc1 lds
    buffer_load_dwordx4 v8, s[60:63], s72 offen offset:1024 sc1 lds
    buffer_load_dwordx4 v8, s[60:63], s72 offen offset:2048 sc1 lds
    buffer_load_dwordx4 v8, s[60:63], s72 offen offset:3072 sc1 lds
    s_add_u32 s9, s9, 4096
    s_mov_b32 m0, s9
    s_nop 0
    buffer_load_dwordx4 v9, s[60:63], s72 offen offset:0 sc1 lds
    buffer_load_dwordx4 v9, s[60:63], s72 offen offset:1024 sc1 lds
    buffer_load_dwordx4 v9, s[60:63], s72 offen offset:2048 sc1 lds
    buffer_load_dwordx4 v9, s[60:63], s72 offen offset:3072 sc1 lds
    s_add_u32 s72, s72, 0x10000
    s_xor_b32 s75, s75, 0x8000
    s_waitcnt vmcnt(0)
    s_cmp_ge_u32 s3, 2
    s_cbranch_scc1 L_kv_V
L_kv_K:
    s_waitcnt vmcnt(4)
    s_barrier
    s_max_u32 s9, s74, 2
    s_sub_u32 s9, s9, 1
    s_min_u32 s9, s9, s74
    s_lshl_b32 s9, s9, 1
    s_add_u32 s9, s9, s64
    v_mov_b32 v12, s9
    s_mov_b64 exec, 1
    buffer_store_dword v12, off, s[60:63], s65 sc1
    s_mov_b64 exec, -1
    s_xor_b32 s9, s75, 0x8000
    v_add_u32 v13, s9, v4
    s_add_u32 s9, s75, s67
    s_mov_b32 m0, s9
    s_nop 0
    buffer_load_dwordx4 v8, s[60:63], s72 offen offset:0 sc1 lds
    buffer_load_dwordx4 v8, s[60:63], s72 offen offset:1024 sc1 lds
    buffer_load_dwordx4 v8, s[60:63], s72 offen offset:2048 sc1 lds
    buffer_load_dwordx4 v8, s[60:63], s72 offen offset:3072 sc1 lds
    s_add_u32 s9, s9, 4096
    s_mov_b32 m0, s9
    s_nop 0
    buffer_load_dwordx4 v9, s[60:63], s72 offen offset:0 sc1 lds
    buffer_load_dwordx4 v9, s[60:63], s72 offen offset:1024 sc1 lds
    buffer_load_dwordx4 v9, s[60:63], s72 offen offset:2048 sc1 lds
    buffer_load_dwordx4 v9, s[60:63], s72 offen offset:3072 sc1 lds
    s_add_u32 s72, s72, 0x10000
    s_xor_b32 s75, s75, 0x8000
    ds_read_b128 v[16:19], v13 offset:0
    ds_read_b128 v[20:23], v13 offset:16384
    ds_read_b128 v[24:27], v13 offset:1024
    ds_read_b128 v[28:31], v13 offset:17408
    ds_read_b128 v[32:35], v13 offset:2048
    ds_read_b128 v[36:39], v13 offset:18432
    ds_read_b128 v[40:43], v13 offset:3072
    ds_read_b128 v[44:47], v13 offset:19456
    s_waitcnt lgkmcnt(6)
    v_mfma_f32_16x16x32_bf16 v[64:67], a[0:3], v[16:19], 0
    v_mfma_f32_16x16x32_bf16 v[68:71], a[0:3], v[20:23], 0
    v_mfma_f32_16x16x32_bf16 v[72:75], a[4:7], v[16:19], 0
    v_mfma_f32_16x16x32_bf16 v[76:79], a[4:7], v[20:23], 0
    v_mfma_f32_16x16x32_bf16 v[80:83], a[8:11], v[16:19], 0
    v_mfma_f32_16x16x32_bf16 v[84:87], a[8:11], v[20:23], 0
    v_mfma_f32_16x16x32_bf16 v[88:91], a[12:15], v[16:19], 0
    v_mfma_f32_16x16x32_bf16 v[92:95], a[12:15], v[20:23], 0
    ds_read_b128 v[16:19], v13 offset:4096
    ds_read_b128 v[20:23], v13 offset:20480
    s_waitcnt lgkmcnt(6)
    v_mfma_f32_16x16x32_bf16 v[64:67], a[16:19], v[24:27], v[64:67]
    v_mfma_f32_16x16x32_bf16 v[68:71], a[16:19], v[28:31], v[68:71]
    v_mfma_f32_16x16x32_bf16 v[72:75], a[20:23], v[24:27], v[72:75]
    v_mfma_f32_16x16x32_bf16 v[76:79], a[20:23], v[28:31], v[76:79]
    v_mfma_f32_16x16x32_bf16 v[80:83], a[24:27], v[24:27], v[80:83]
    v_mfma_f32_16x16x32_bf16 v[84:87], a[24:27], v[28:31], v[84:87]
    v_mfma_f32_16x16x32_bf16 v[88:91], a[28:31], v[24:27], v[88:91]
    v_mfma_f32_16x16x32_bf16 v[92:95], a[28:31], v[28:31], v[92:95]
    ds_read_b128 v[24:27], v13 offset:5120
    ds_read_b128 v[28:31], v13 offset:21504
    s_waitcnt lgkmcnt(6)
    v_mfma_f32_16x16x32_bf16 v[64:67], a[32:35], v[32:35], v[64:67]
    v_mfma_f32_16x16x32_bf16 v[68:71], a[32:35], v[36:39], v[68:71]
    v_mfma_f32_16x16x32_bf16 v[72:75], a[36:39], v[32:35], v[72:75]
    v_mfma_f32_16x16x32_bf16 v[76:79], a[36:39], v[36:39], v[76:79]
    v_mfma_f32_16x16x32_bf16 v[80:83], a[40:43], v[32:35], v[80:83]
    v_mfma_f32_16x16x32_bf16 v[84:87], a[40:43], v[36:39], v[84:87]
    v_mfma_f32_16x16x32_bf16 v[88:91], a[44:47], v[32:35], v[88:91]
    v_mfma_f32_16x16x32_bf16 v[92:95], a[44:47], v[36:39], v[92:95]
    ds_read_b128 v[32:35], v13 offset:6144
    ds_read_b128 v[36:39], v13 offset:22528
    s_waitcnt lgkmcnt(6)
    v_mfma_f32_16x16x32_bf16 v[64:67], a[48:51], v[40:43], v[64:67]
    v_mfma_f32_16x16x32_bf16 v[68:71], a[48:51], v[44:47], v[68:71]
    v_mfma_f32_16x16x32_bf16 v[72:75], a[52:55], v[40:43], v[72:75]
    v_mfma_f32_16x16x32_bf16 v[76:79], a[52:55], v[44:47], v[76:79]
    v_mfma_f32_16x16x32_bf16 v[80:83], a[56:59], v[40:43], v[80:83]
    v_mfma_f32_16x16x32_bf16 v[84:87], a[56:59], v[44:47], v[84:87]
    v_mfma_f32_16x16x32_bf16 v[88:91], a[60:63], v[40:43], v[88:91]
    v_mfma_f32_16x16x32_bf16 v[92:95], a[60:63], v[44:47], v[92:95]
    ds_read_b128 v[40:43], v13 offset:7168
    ds_read_b128 v[44:47], v13 offset:23552
    s_waitcnt lgkmcnt(6)
    v_mfma_f32_16x16x32_bf16 v[64:67], a[64:67], v[16:19], v[64:67]
    v_mfma_f32_16x16x32_bf16 v[68:71], a[64:67], v[20:23], v[68:71]
    v_mfma_f32_16x16x32_bf16 v[72:75], a[68:71], v[16:19], v[72:75]
    v_mfma_f32_16x16x32_bf16 v[76:79], a[68:71], v[20:23], v[76:79]
    v_mfma_f32_16x16x32_bf16 v[80:83], a[72:75], v[16:19], v[80:83]
    v_mfma_f32_16x16x32_bf16 v[84:87], a[72:75], v[20:23], v[84:87]
    v_mfma_f32_16x16x32_bf16 v[88:91], a[76:79], v[16:19], v[88:91]
    v_mfma_f32_16x16x32_bf16 v[92:95], a[76:79], v[20:23], v[92:95]
    ds_read_b128 v[16:19], v13 offset:8192
    ds_read_b128 v[20:23], v13 offset:24576
    s_waitcnt lgkmcnt(6)
    v_mfma_f32_16x16x32_bf16 v[64:67], a[80:83], v[24:27], v[64:67]
    v_mfma_f32_16x16x32_bf16 v[68:71], a[80:83], v[28:31], v[68:71]
    v_mfma_f32_16x16x32_bf16 v[72:75], a[84:87], v[24:27], v[72:75]
    v_mfma_f32_16x16x32_bf16 v[76:79], a[84:87], v[28:31], v[76:79]
    v_mfma_f32_16x16x32_bf16 v[80:83], a[88:91], v[24:27], v[80:83]
    v_mfma_f32_16x16x32_bf16 v[84:87], a[88:91], v[28:31], v[84:87]
    v_mfma_f32_16x16x32_bf16 v[88:91], a[92:95], v[24:27], v[88:91]
    v_mfma_f32_16x16x32_bf16 v[92:95], a[92:95], v[28:31], v[92:95]
    ds_read_b128 v[24:27], v13 offset:9216
    ds_read_b128 v[28:31], v13 offset:25600
    s_waitcnt lgkmcnt(6)
    v_mfma_f32_16x16x32_bf16 v[64:67], a[96:99], v[32:35], v[64:67]
    v_mfma_f32_16x16x32_bf16 v[68:71], a[96:99], v[36:39], v[68:71]
    v_mfma_f32_16x16x32_bf16 v[72:75], a[100:103], v[32:35], v[72:75]
    v_mfma_f32_16x16x32_bf16 v[76:79], a[100:103], v[36:39], v[76:79]
    v_mfma_f32_16x16x32_bf16 v[80:83], a[104:107], v[32:35], v[80:83]
    v_mfma_f32_16x16x32_bf16 v[84:87], a[104:107], v[36:39], v[84:87]
    v_mfma_f32_16x16x32_bf16 v[88:91], a[108:111], v[32:35], v[88:91]
    v_mfma_f32_16x16x32_bf16 v[92:95], a[108:111], v[36:39], v[92:95]
    ds_read_b128 v[32:35], v13 offset:10240
    ds_read_b128 v[36:39], v13 offset:26624
    s_waitcnt lgkmcnt(6)
    v_mfma_f32_16x16x32_bf16 v[64:67], a[112:115], v[40:43], v[64:67]
    v_mfma_f32_16x16x32_bf16 v[68:71], a[112:115], v[44:47], v[68:71]
    v_mfma_f32_16x16x32_bf16 v[72:75], a[116:119], v[40:43], v[72:75]
    v_mfma_f32_16x16x32_bf16 v[76:79], a[116:119], v[44:47], v[76:79]
    v_mfma_f32_16x16x32_bf16 v[80:83], a[120:123], v[40:43], v[80:83]
    v_mfma_f32_16x16x32_bf16 v[84:87], a[120:123], v[44:47], v[84:87]
    v_mfma_f32_16x16x32_bf16 v[88:91], a[124:127], v[40:43], v[88:91]
    v_mfma_f32_16x16x32_bf16 v[92:95], a[124:127], v[44:47], v[92:95]
    ds_read_b128 v[40:43], v13 offset:11264
    ds_read_b128 v[44:47], v13 offset:27648
    s_waitcnt lgkmcnt(6)
    v_mfma_f32_16x16x32_bf16 v[64:67], a[128:131], v[16:19], v[64:67]
    v_mfma_f32_16x16x32_bf16 v[68:71], a[128:131], v[20:23], v[68:71]
    v_mfma_f32_16x16x32_bf16 v[72:75], a[132:135], v[16:19], v[72:75]
    v_mfma_f32_16x16x32_bf16 v[76:79], a[132:135], v[20:23], v[76:79]
    v_mfma_f32_16x16x32_bf16 v[80:83], a[136:139], v[16:19], v[80:83]
    v_mfma_f32_16x16x32_bf16 v[84:87], a[136:139], v[20:23], v[84:87]
    v_mfma_f32_16x16x32_bf16 v[88:91], a[140:143], v[16:19], v[88:91]
    v_mfma_f32_16x16x32_bf16 v[92:95], a[140:143], v[20:23], v[92:95]
    ds_read_b128 v[16:19], v13 offset:12288
    ds_read_b128 v[20:23], v13 offset:28672
    s_waitcnt lgkmcnt(6)
    v_mfma_f32_16x16x32_bf16 v[64:67], a[144:147], v[24:27], v[64:67]
    v_mfma_f32_16x16x32_bf16 v[68:71], a[144:147], v[28:31], v[68:71]
    v_mfma_f32_16x16x32_bf16 v[72:75], a[148:151], v[24:27], v[72:75]
    v_mfma_f32_16x16x32_bf16 v[76:79], a[148:151], v[28:31], v[76:79]
    v_mfma_f32_16x16x32_bf16 v[80:83], a[152:155], v[24:27], v[80:83]
    v_mfma_f32_16x16x32_bf16 v[84:87], a[152:155], v[28:31], v[84:87]
    v_mfma_f32_16x16x32_bf16 v[88:91], a[156:159], v[24:27], v[88:91]
    v_mfma_f32_16x16x32_bf16 v[92:95], a[156:159], v[28:31], v[92:95]
    ds_read_b128 v[24:27], v13 offset:13312
    ds_read_b128 v[28:31], v13 offset:29696
    s_waitcnt lgkmcnt(6)
    v_mfma_f32_16x16x32_bf16 v[64:67], a[160:163], v[32:35], v[64:67]
    v_mfma_f32_16x16x32_bf16 v[68:71], a[160:163], v[36:39], v[68:71]
    v_mfma_f32_16x16x32_bf16 v[72:75], a[164:167], v[32:35], v[72:75]
    v_mfma_f32_16x16x32_bf16 v[76:79], a[164:167], v[36:39], v[76:79]
    v_mfma_f32_16x16x32_bf16 v[80:83], a[168:171], v[32:35], v[80:83]
    v_mfma_f32_16x16x32_bf16 v[84:87], a[168:171], v[36:39], v[84:87]
    v_mfma_f32_16x16x32_bf16 v[88:91], a[172:175], v[32:35], v[88:91]
    v_mfma_f32_16x16x32_bf16 v[92:95], a[172:175], v[36:39], v[92:95]
    ds_read_b128 v[32:35], v13 offset:14336
    ds_read_b128 v[36:39], v13 offset:30720
    s_waitcnt lgkmcnt(6)
    v_mfma_f32_16x16x32_bf16 v[64:67], a[176:179], v[40:43], v[64:67]
    v_mfma_f32_16x16x32_bf16 v[68:71], a[176:179], v[44:47], v[68:71]
    v_mfma_f32_16x16x32_bf16 v[72:75], a[180:183], v[40:43], v[72:75]
    v_mfma_f32_16x16x32_bf16 v[76:79], a[180:183], v[44:47], v[76:79]
    v_mfma_f32_16x16x32_bf16 v[80:83], a[184:187], v[40:43], v[80:83]
    v_mfma_f32_16x16x32_bf16 v[84:87], a[184:187], v[44:47], v[84:87]
    v_mfma_f32_16x16x32_bf16 v[88:91], a[188:191], v[40:43], v[88:91]
    v_mfma_f32_16x16x32_bf16 v[92:95], a[188:191], v[44:47], v[92:95]
    ds_read_b128 v[40:43], v13 offset:15360
    ds_read_b128 v[44:47], v13 offset:31744
    s_waitcnt lgkmcnt(6)
    v_mfma_f32_16x16x32_bf16 v[64:67], a[192:195], v[16:19], v[64:67]
    v_mfma_f32_16x16x32_bf16 v[68:71], a[192:195], v[20:23], v[68:71]
    v_mfma_f32_16x16x32_bf16 v[72:75], a[196:199], v[16:19], v[72:75]
    v_mfma_f32_16x16x32_bf16 v[76:79], a[196:199], v[20:23], v[76:79]
    v_mfma_f32_16x16x32_bf16 v[80:83], a[200:203], v[16:19], v[80:83]
    v_mfma_f32_16x16x32_bf16 v[84:87], a[200:203], v[20:23], v[84:87]
    v_mfma_f32_16x16x32_bf16 v[88:91], a[204:207], v[16:19], v[88:91]
    v_mfma_f32_16x16x32_bf16 v[92:95], a[204:207], v[20:23], v[92:95]
    s_waitcnt lgkmcnt(4)
    v_mfma_f32_16x16x32_bf16 v[64:67], a[208:211], v[24:27], v[64:67]
    v_mfma_f32_16x16x32_bf16 v[68:71], a[208:211], v[28:31], v[68:71]
    v_mfma_f32_16x16x32_bf16 v[72:75], a[212:215], v[24:27], v[72:75]
    v_mfma_f32_16x16x32_bf16 v[76:79], a[212:215], v[28:31], v[76:79]
    v_mfma_f32_16x16x32_bf16 v[80:83], a[216:219], v[24:27], v[80:83]
    v_mfma_f32_16x16x32_bf16 v[84:87], a[216:219], v[28:31], v[84:87]
    v_mfma_f32_16x16x32_bf16 v[88:91], a[220:223], v[24:27], v[88:91]
    v_mfma_f32_16x16x32_bf16 v[92:95], a[220:223], v[28:31], v[92:95]
    s_waitcnt lgkmcnt(2)
    v_mfma_f32_16x16x32_bf16 v[64:67], a[224:227], v[32:35], v[64:67]
    v_mfma_f32_16x16x32_bf16 v[68:71], a[224:227], v[36:39], v[68:71]
    v_mfma_f32_16x16x32_bf16 v[72:75], a[228:231], v[32:35], v[72:75]
    v_mfma_f32_16x16x32_bf16 v[76:79], a[228:231], v[36:39], v[76:79]
    v_mfma_f32_16x16x32_bf16 v[80:83], a[232:235], v[32:35], v[80:83]
    v_mfma_f32_16x16x32_bf16 v[84:87], a[232:235], v[36:39], v[84:87]
    v_mfma_f32_16x16x32_bf16 v[88:91], a[236:239], v[32:35], v[88:91]
    v_mfma_f32_16x16x32_bf16 v[92:95], a[236:239], v[36:39], v[92:95]
    s_waitcnt lgkmcnt(0)
    v_mfma_f32_16x16x32_bf16 v[64:67], a[240:243], v[40:43], v[64:67]
    v_mfma_f32_16x16x32_bf16 v[68:71], a[240:243], v[44:47], v[68:71]
    v_mfma_f32_16x16x32_bf16 v[72:75], a[244:247], v[40:43], v[72:75]
    v_mfma_f32_16x16x32_bf16 v[76:79], a[244:247], v[44:47], v[76:79]
    v_mfma_f32_16x16x32_bf16 v[80:83], a[248:251], v[40:43], v[80:83]
    v_mfma_f32_16x16x32_bf16 v[84:87], a[248:251], v[44:47], v[84:87]
    v_mfma_f32_16x16x32_bf16 v[88:91], a[252:255], v[40:43], v[88:91]
    v_mfma_f32_16x16x32_bf16 v[92:95], a[252:255], v[44:47], v[92:95]
    s_nop 2
    v_cvt_pk_bf16_f32 v96, v64, v72
    s_nop 2
    v_cvt_pk_bf16_f32 v97, v80, v88
    v_cvt_pk_bf16_f32 v98, v65, v73
    v_cvt_pk_bf16_f32 v99, v81, v89
    buffer_store_dwordx4 v[96:99], v10, s[60:63], s73 offen offset:0 sc1
    v_cvt_pk_bf16_f32 v100, v66, v74
    v_cvt_pk_bf16_f32 v101, v82, v90
    v_cvt_pk_bf16_f32 v102, v67, v75
    v_cvt_pk_bf16_f32 v103, v83, v91
    buffer_store_dwordx4 v[100:103], v10, s[60:63], s73 offen offset:1024 sc1
    v_cvt_pk_bf16_f32 v104, v68, v76
    v_cvt_pk_bf16_f32 v105, v84, v92
    v_cvt_pk_bf16_f32 v106, v69, v77
    v_cvt_pk_bf16_f32 v107, v85, v93
    buffer_store_dwordx4 v[104:107], v11, s[60:63], s73 offen offset:0 sc1
    v_cvt_pk_bf16_f32 v108, v70, v78
    v_cvt_pk_bf16_f32 v109, v86, v94
    v_cvt_pk_bf16_f32 v110, v71, v79
    v_cvt_pk_bf16_f32 v111, v87, v95
    buffer_store_dwordx4 v[108:111], v11, s[60:63], s73 offen offset:1024 sc1
    s_add_u32 s73, s73, 1048576
    s_add_u32 s74, s74, 1
    s_cmp_lg_u32 s74, 1
    s_cbranch_scc1 kve_5
    s_waitcnt vmcnt(0)
    s_add_u32 s9, s64, 2
    v_mov_b32 v12, s9
    s_mov_b64 exec, 1
    buffer_store_dword v12, off, s[60:63], s65 sc1
    s_mov_b64 exec, -1
kve_5:
    s_cmp_lt_u32 s74, 32
    s_cbranch_scc1 L_kv_K
    s_waitcnt vmcnt(0)
    v_mov_b32 v12, 100
    s_mov_b64 exec, 1
    buffer_store_dword v12, off, s[60:63], s65 sc1
    s_mov_b64 exec, -1
    s_add_u32 s64, s64, 2
    s_lshl_b32 s65, s64, 9
    s_lshl_b32 s9, s5, 4
    s_add_u32 s65, s65, s9
    s_lshl_b32 s9, s3, 2
    s_add_u32 s65, s65, s9
    s_add_u32 s65, s65, 6897664
    s_barrier
    s_branch L_FF_join
L_kv_V:
    s_waitcnt vmcnt(4)
    s_barrier
    s_max_u32 s9, s74, 2
    s_sub_u32 s9, s9, 1
    s_min_u32 s9, s9, s74
    s_lshl_b32 s9, s9, 1
    s_add_u32 s9, s9, s64
    v_mov_b32 v12, s9
    s_mov_b64 exec, 1
    buffer_store_dword v12, off, s[60:63], s65 sc1
    s_mov_b64 exec, -1
    s_xor_b32 s9, s75, 0x8000
    v_add_u32 v13, s9, v4
    s_add_u32 s9, s75, s67
    s_mov_b32 m0, s9
    s_nop 0
    buffer_load_dwordx4 v8, s[60:63], s72 offen offset:0 sc1 lds
    buffer_load_dwordx4 v8, s[60:63], s72 offen offset:1024 sc1 lds
    buffer_load_dwordx4 v8, s[60:63], s72 offen offset:2048 sc1 lds
    buffer_load_dwordx4 v8, s[60:63], s72 offen offset:3072 sc1 lds
    s_add_u32 s9, s9, 4096
    s_mov_b32 m0, s9
    s_nop 0
    buffer_load_dwordx4 v9, s[60:63], s72 offen offset:0 sc1 lds
    buffer_load_dwordx4 v9, s[60:63], s72 offen offset:1024 sc1 lds
    buffer_load_dwordx4 v9, s[60:63], s72 offen offset:2048 sc1 lds
    buffer_load_dwordx4 v9, s[60:63], s72 offen offset:3072 sc1 lds
    s_add_u32 s72, s72, 0x10000
    s_xor_b32 s75, s75, 0x8000
    ds_read_b128 v[16:19], v13 offset:0
    ds_read_b128 v[20:23], v13 offset:16384
    ds_read_b128 v[24:27], v13 offset:1024
    ds_read_b128 v[28:31], v13 offset:17408
    ds_read_b128 v[32:35], v13 offset:2048
    ds_read_b128 v[36:39], v13 offset:18432
    ds_read_b128 v[40:43], v13 offset:3072
    ds_read_b128 v[44:47], v13 offset:19456
    s_waitcnt lgkmcnt(6)
    v_mfma_f32_16x16x32_bf16 v[64:67], v[16:19], a[0:3], 0
    v_mfma_f32_16x16x32_bf16 v[68:71], v[20:23], a[0:3], 0
    v_mfma_f32_16x16x32_bf16 v[72:75], v[16:19], a[4:7], 0
    v_mfma_f32_16x16x32_bf16 v[76:79], v[20:23], a[4:7], 0
    v_mfma_f32_16x16x32_bf16 v[80:83], v[16:19], a[8:11], 0
    v_mfma_f32_16x16x32_bf16 v[84:87], v[20:23], a[8:11], 0
    v_mfma_f32_16x16x32_bf16 v[88:91], v[16:19], a[12:15], 0
    v_mfma_f32_16x16x32_bf16 v[92:95], v[20:23], a[12:15], 0
    ds_read_b128 v[16:19], v13 offset:4096
    ds_read_b128 v[20:23], v13 offset:20480
    s_waitcnt lgkmcnt(6)
    v_mfma_f32_16x16x32_bf16 v[64:67], v[24:27], a[16:19], v[64:67]
    v_mfma_f32_16x16x32_bf16 v[68:71], v[28:31], a[16:19], v[68:71]
    v_mfma_f32_16x16x32_bf16 v[72:75], v[24:27], a[20:23], v[72:75]
    v_mfma_f32_16x16x32_bf16 v[76:79], v[28:31], a[20:23], v[76:79]
    v_mfma_f32_16x16x32_bf16 v[80:83], v[24:27], a[24:27], v[80:83]
    v_mfma_f32_16x16x32_bf16 v[84:87], v[28:31], a[24:27], v[84:87]
    v_mfma_f32_16x16x32_bf16 v[88:91], v[24:27], a[28:31], v[88:91]
    v_mfma_f32_16x16x32_bf16 v[92:95], v[28:31], a[28:31], v[92:95]
    ds_read_b128 v[24:27], v13 offset:5120
    ds_read_b128 v[28:31], v13 offset:21504
    s_waitcnt lgkmcnt(6)
    v_mfma_f32_16x16x32_bf16 v[64:67], v[32:35], a[32:35], v[64:67]
    v_mfma_f32_16x16x32_bf16 v[68:71], v[36:39], a[32:35], v[68:71]
    v_mfma_f32_16x16x32_bf16 v[72:75], v[32:35], a[36:39], v[72:75]
    v_mfma_f32_16x16x32_bf16 v[76:79], v[36:39], a[36:39], v[76:79]
    v_mfma_f32_16x16x32_bf16 v[80:83], v[32:35], a[40:43], v[80:83]
    v_mfma_f32_16x16x32_bf16 v[84:87], v[36:39], a[40:43], v[84:87]
    v_mfma_f32_16x16x32_bf16 v[88:91], v[32:35], a[44:47], v[88:91]
    v_mfma_f32_16x16x32_bf16 v[92:95], v[36:39], a[44:47], v[92:95]
    ds_read_b128 v[32:35], v13 offset:6144
    ds_read_b128 v[36:39], v13 offset:22528
    s_waitcnt lgkmcnt(6)
    v_mfma_f32_16x16x32_bf16 v[64:67], v[40:43], a[48:51], v[64:67]
    v_mfma_f32_16x16x32_bf16 v[68:71], v[44:47], a[48:51], v[68:71]
    v_mfma_f32_16x16x32_bf16 v[72:75], v[40:43], a[52:55], v[72:75]
    v_mfma_f32_16x16x32_bf16 v[76:79], v[44:47], a[52:55], v[76:79]
    v_mfma_f32_16x16x32_bf16 v[80:83], v[40:43], a[56:59], v[80:83]
    v_mfma_f32_16x16x32_bf16 v[84:87], v[44:47], a[56:59], v[84:87]
    v_mfma_f32_16x16x32_bf16 v[88:91], v[40:43], a[60:63], v[88:91]
    v_mfma_f32_16x16x32_bf16 v[92:95], v[44:47], a[60:63], v[92:95]
    ds_read_b128 v[40:43], v13 offset:7168
    ds_read_b128 v[44:47], v13 offset:23552
    s_waitcnt lgkmcnt(6)
    v_mfma_f32_16x16x32_bf16 v[64:67], v[16:19], a[64:67], v[64:67]
    v_mfma_f32_16x16x32_bf16 v[68:71], v[20:23], a[64:67], v[68:71]
    v_mfma_f32_16x16x32_bf16 v[72:75], v[16:19], a[68:71], v[72:75]
    v_mfma_f32_16x16x32_bf16 v[76:79], v[20:23], a[68:71], v[76:79]
    v_mfma_f32_16x16x32_bf16 v[80:83], v[16:19], a[72:75], v[80:83]
    v_mfma_f32_16x16x32_bf16 v[84:87], v[20:23], a[72:75], v[84:87]
    v_mfma_f32_16x16x32_bf16 v[88:91], v[16:19], a[76:79], v[88:91]
    v_mfma_f32_16x16x32_bf16 v[92:95], v[20:23], a[76:79], v[92:95]
    ds_read_b128 v[16:19], v13 offset:8192
    ds_read_b128 v[20:23], v13 offset:24576
    s_waitcnt lgkmcnt(6)
    v_mfma_f32_16x16x32_bf16 v[64:67], v[24:27], a[80:83], v[64:67]
    v_mfma_f32_16x16x32_bf16 v[68:71], v[28:31], a[80:83], v[68:71]
    v_mfma_f32_16x16x32_bf16 v[72:75], v[24:27], a[84:87], v[72:75]
    v_mfma_f32_16x16x32_bf16 v[76:79], v[28:31], a[84:87], v[76:79]
    v_mfma_f32_16x16x32_bf16 v[80:83], v[24:27], a[88:91], v[80:83]
    v_mfma_f32_16x16x32_bf16 v[84:87], v[28:31], a[88:91], v[84:87]
    v_mfma_f32_16x16x32_bf16 v[88:91], v[24:27], a[92:95], v[88:91]
    v_mfma_f32_16x16x32_bf16 v[92:95], v[28:31], a[92:95], v[92:95]
    ds_read_b128 v[24:27], v13 offset:9216
    ds_read_b128 v[28:31], v13 offset:25600
    s_waitcnt lgkmcnt(6)
    v_mfma_f32_16x16x32_bf16 v[64:67], v[32:35], a[96:99], v[64:67]
    v_mfma_f32_16x16x32_bf16 v[68:71], v[36:39], a[96:99], v[68:71]
    v_mfma_f32_16x16x32_bf16 v[72:75], v[32:35], a[100:103], v[72:75]
    v_mfma_f32_16x16x32_bf16 v[76:79], v[36:39], a[100:103], v[76:79]
    v_mfma_f32_16x16x32_bf16 v[80:83], v[32:35], a[104:107], v[80:83]
    v_mfma_f32_16x16x32_bf16 v[84:87], v[36:39], a[104:107], v[84:87]
    v_mfma_f32_16x16x32_bf16 v[88:91], v[32:35], a[108:111], v[88:91]
    v_mfma_f32_16x16x32_bf16 v[92:95], v[36:39], a[108:111], v[92:95]
    ds_read_b128 v[32:35], v13 offset:10240
    ds_read_b128 v[36:39], v13 offset:26624
    s_waitcnt lgkmcnt(6)
    v_mfma_f32_16x16x32_bf16 v[64:67], v[40:43], a[112:115], v[64:67]
    v_mfma_f32_16x16x32_bf16 v[68:71], v[44:47], a[112:115], v[68:71]
    v_mfma_f32_16x16x32_bf16 v[72:75], v[40:43], a[116:119], v[72:75]
    v_mfma_f32_16x16x32_bf16 v[76:79], v[44:47], a[116:119], v[76:79]
    v_mfma_f32_16x16x32_bf16 v[80:83], v[40:43], a[120:123], v[80:83]
    v_mfma_f32_16x16x32_bf16 v[84:87], v[44:47], a[120:123], v[84:87]
    v_mfma_f32_16x16x32_bf16 v[88:91], v[40:43], a[124:127], v[88:91]
    v_mfma_f32_16x16x32_bf16 v[92:95], v[44:47], a[124:127], v[92:95]
    ds_read_b128 v[40:43], v13 offset:11264
    ds_read_b128 v[44:47], v13 offset:27648
    s_waitcnt lgkmcnt(6)
    v_mfma_f32_16x16x32_bf16 v[64:67], v[16:19], a[128:131], v[64:67]
    v_mfma_f32_16x16x32_bf16 v[68:71], v[20:23], a[128:131], v[68:71]
    v_mfma_f32_16x16x32_bf16 v[72:75], v[16:19], a[132:135], v[72:75]
    v_mfma_f32_16x16x32_bf16 v[76:79], v[20:23], a[132:135], v[76:79]
    v_mfma_f32_16x16x32_bf16 v[80:83], v[16:19], a[136:139], v[80:83]
    v_mfma_f32_16x16x32_bf16 v[84:87], v[20:23], a[136:139], v[84:87]
    v_mfma_f32_16x16x32_bf16 v[88:91], v[16:19], a[140:143], v[88:91]
    v_mfma_f32_16x16x32_bf16 v[92:95], v[20:23], a[140:143], v[92:95]
    ds_read_b128 v[16:19], v13 offset:12288
    ds_read_b128 v[20:23], v13 offset:28672
    s_waitcnt lgkmcnt(6)
    v_mfma_f32_16x16x32_bf16 v[64:67], v[24:27], a[144:147], v[64:67]
    v_mfma_f32_16x16x32_bf16 v[68:71], v[28:31], a[144:147], v[68:71]
    v_mfma_f32_16x16x32_bf16 v[72:75], v[24:27], a[148:151], v[72:75]
    v_mfma_f32_16x16x32_bf16 v[76:79], v[28:31], a[148:151], v[76:79]
    v_mfma_f32_16x16x32_bf16 v[80:83], v[24:27], a[152:155], v[80:83]
    v_mfma_f32_16x16x32_bf16 v[84:87], v[28:31], a[152:155], v[84:87]
    v_mfma_f32_16x16x32_bf16 v[88:91], v[24:27], a[156:159], v[88:91]
    v_mfma_f32_16x16x32_bf16 v[92:95], v[28:31], a[156:159], v[92:95]
    ds_read_b128 v[24:27], v13 offset:13312
    ds_read_b128 v[28:31], v13 offset:29696
    s_waitcnt lgkmcnt(6)
    v_mfma_f32_16x16x32_bf16 v[64:67], v[32:35], a[160:163], v[64:67]
    v_mfma_f32_16x16x32_bf16 v[68:71], v[36:39], a[160:163], v[68:71]
    v_mfma_f32_16x16x32_bf16 v[72:75], v[32:35], a[164:167], v[72:75]
    v_mfma_f32_16x16x32_bf16 v[76:79], v[36:39], a[164:167], v[76:79]
    v_mfma_f32_16x16x32_bf16 v[80:83], v[32:35], a[168:171], v[80:83]
    v_mfma_f32_16x16x32_bf16 v[84:87], v[36:39], a[168:171], v[84:87]
    v_mfma_f32_16x16x32_bf16 v[88:91], v[32:35], a[172:175], v[88:91]
    v_mfma_f32_16x16x32_bf16 v[92:95], v[36:39], a[172:175], v[92:95]
    ds_read_b128 v[32:35], v13 offset:14336
    ds_read_b128 v[36:39], v13 offset:30720
    s_waitcnt lgkmcnt(6)
    v_mfma_f32_16x16x32_bf16 v[64:67], v[40:43], a[176:179], v[64:67]
    v_mfma_f32_16x16x32_bf16 v[68:71], v[44:47], a[176:179], v[68:71]
    v_mfma_f32_16x16x32_bf16 v[72:75], v[40:43], a[180:183], v[72:75]
    v_mfma_f32_16x16x32_bf16 v[76:79], v[44:47], a[180:183], v[76:79]
    v_mfma_f32_16x16x32_bf16 v[80:83], v[40:43], a[184:187], v[80:83]
    v_mfma_f32_16x16x32_bf16 v[84:87], v[44:47], a[184:187], v[84:87]
    v_mfma_f32_16x16x32_bf16 v[88:91], v[40:43], a[188:191], v[88:91]
    v_mfma_f32_16x16x32_bf16 v[92:95], v[44:47], a[188:191], v[92:95]
    ds_read_b128 v[40:43], v13 offset:15360
    ds_read_b128 v[44:47], v13 offset:31744
    s_waitcnt lgkmcnt(6)
    v_mfma_f32_16x16x32_bf16 v[64:67], v[16:19], a[192:195], v[64:67]
    v_mfma_f32_16x16x32_bf16 v[68:71], v[20:23], a[192:195], v[68:71]
    v_mfma_f32_16x16x32_bf16 v[72:75], v[16:19], a[196:199], v[72:75]
    v_mfma_f32_16x16x32_bf16 v[76:79], v[20:23], a[196:199], v[76:79]
    v_mfma_f32_16x16x32_bf16 v[80:83], v[16:19], a[200:203], v[80:83]
    v_mfma_f32_16x16x32_bf16 v[84:87], v[20:23], a[200:203], v[84:87]
    v_mfma_f32_16x16x32_bf16 v[88:91], v[16:19], a[204:207], v[88:91]
    v_mfma_f32_16x16x32_bf16 v[92:95], v[20:23], a[204:207], v[92:95]
    s_waitcnt lgkmcnt(4)
    v_mfma_f32_16x16x32_bf16 v[64:67], v[24:27], a[208:211], v[64:67]
    v_mfma_f32_16x16x32_bf16 v[68:71], v[28:31], a[208:211], v[68:71]
    v_mfma_f32_16x16x32_bf16 v[72:75], v[24:27], a[212:215], v[72:75]
    v_mfma_f32_16x16x32_bf16 v[76:79], v[28:31], a[212:215], v[76:79]
    v_mfma_f32_16x16x32_bf16 v[80:83], v[24:27], a[216:219], v[80:83]
    v_mfma_f32_16x16x32_bf16 v[84:87], v[28:31], a[216:219], v[84:87]
    v_mfma_f32_16x16x32_bf16 v[88:91], v[24:27], a[220:223], v[88:91]
    v_mfma_f32_16x16x32_bf16 v[92:95], v[28:31], a[220:223], v[92:95]
    s_waitcnt lgkmcnt(2)
    v_mfma_f32_16x16x32_bf16 v[64:67], v[32:35], a[224:227], v[64:67]
    v_mfma_f32_16x16x32_bf16 v[68:71], v[36:39], a[224:227], v[68:71]
    v_mfma_f32_16x16x32_bf16 v[72:75], v[32:35], a[228:231], v[72:75]
    v_mfma_f32_16x16x32_bf16 v[76:79], v[36:39], a[228:231], v[76:79]
    v_mfma_f32_16x16x32_bf16 v[80:83], v[32:35], a[232:235], v[80:83]
    v_mfma_f32_16x16x32_bf16 v[84:87], v[36:39], a[232:235], v[84:87]
    v_mfma_f32_16x16x32_bf16 v[88:91], v[32:35], a[236:239], v[88:91]
    v_mfma_f32_16x16x32_bf16 v[92:95], v[36:39], a[236:239], v[92:95]
    s_waitcnt lgkmcnt(0)
    v_mfma_f32_16x16x32_bf16 v[64:67], v[40:43], a[240:243], v[64:67]
    v_mfma_f32_16x16x32_bf16 v[68:71], v[44:47], a[240:243], v[68:71]
    v_mfma_f32_16x16x32_bf16 v[72:75], v[40:43], a[244:247], v[72:75]
    v_mfma_f32_16x16x32_bf16 v[76:79], v[44:47], a[244:247], v[76:79]
    v_mfma_f32_16x16x32_bf16 v[80:83], v[40:43], a[248:251], v[80:83]
    v_mfma_f32_16x16x32_bf16 v[84:87], v[44:47], a[248:251], v[84:87]
    v_mfma_f32_16x16x32_bf16 v[88:91], v[40:43], a[252:255], v[88:91]
    v_mfma_f32_16x16x32_bf16 v[92:95], v[44:47], a[252:255], v[92:95]
    s_nop 0
    v_cvt_pk_bf16_f32 v96, v64, v65
    v_cvt_pk_bf16_f32 v97, v66, v67
    v_cvt_pk_bf16_f32 v98, v68, v69
    v_cvt_pk_bf16_f32 v99, v70, v71
    buffer_store_dwordx4 v[96:99], v10, s[60:63], s73 offen offset:0 sc1
    v_cvt_pk_bf16_f32 v100, v72, v73
    v_cvt_pk_bf16_f32 v101, v74, v75
    v_cvt_pk_bf16_f32 v102, v76, v77
    v_cvt_pk_bf16_f32 v103, v78, v79
    buffer_store_dwordx4 v[100:103], v11, s[60:63], s73 offen offset:0 sc1
    v_cvt_pk_bf16_f32 v104, v80, v81
    v_cvt_pk_bf16_f32 v105, v82, v83
    v_cvt_pk_bf16_f32 v106, v84, v85
    v_cvt_pk_bf16_f32 v107, v86, v87
    buffer_store_dwordx4 v[104:107], v10, s[60:63], s73 offen offset:1024 sc1
    v_cvt_pk_bf16_f32 v108, v88, v89
    v_cvt_pk_bf16_f32 v109, v90, v91
    v_cvt_pk_bf16_f32 v110, v92, v93
    v_cvt_pk_bf16_f32 v111, v94, v95
    buffer_store_dwordx4 v[108:111], v11, s[60:63], s73 offen offset:1024 sc1
    s_add_u32 s73, s73, 1048576
    s_add_u32 s74, s74, 1
    s_cmp_lg_u32 s74, 1
    s_cbranch_scc1 kve_6
    s_waitcnt vmcnt(0)
    s_add_u32 s9, s64, 2
    v_mov_b32 v12, s9
    s_mov_b64 exec, 1
    buffer_store_dword v12, off, s[60:63], s65 sc1
    s_mov_b64 exec, -1
kve_6:
    s_cmp_lt_u32 s74, 32
    s_cbranch_scc1 L_kv_V
    s_waitcnt vmcnt(0)
    v_mov_b32 v12, 100
    s_mov_b64 exec, 1
    buffer_store_dword v12, off, s[60:63], s65 sc1
    s_mov_b64 exec, -1
    s_add_u32 s64, s64, 2
    s_lshl_b32 s65, s64, 9
    s_lshl_b32 s9, s5, 4
    s_add_u32 s65, s65, s9
    s_lshl_b32 s9, s3, 2
    s_add_u32 s65, s65, s9
    s_add_u32 s65, s65, 6897664
    s_barrier
    s_branch L_FF_join
L_role_R:
L_pc_R:
    s_lshl_b32 s64, s5, 2
    s_add_u32 s64, s64, s3
    v_lshlrev_b32 v24, 13, v2
    v_lshl_add_u32 v24, v3, 4, v24
    s_lshr_b32 s9, s3, 1
    s_lshl_b32 s9, s9, 21
    s_and_b32 s10, s3, 1
    s_lshl_b32 s10, s10, 19
    s_add_u32 s9, s9, s10
    s_lshl_b32 s10, s5, 8
    s_add_u32 s9, s9, s10
    v_add_u32 v28, s9, v24
    s_lshl_b32 s76, s3, 15
    s_lshl_b32 s77, s3, 13
    s_add_u32 m0, s77, 0
    s_mov_b32 s14, 0
    buffer_load_dwordx4 v28, s[24:27], s14 offen lds
    s_add_u32 m0, s77, 1024
    s_mov_b32 s14, 32768
    buffer_load_dwordx4 v28, s[24:27], s14 offen lds
    s_add_u32 m0, s77, 2048
    s_mov_b32 s14, 65536
    buffer_load_dwordx4 v28, s[24:27], s14 offen lds
    s_add_u32 m0, s77, 3072
    s_mov_b32 s14, 98304
    buffer_load_dwordx4 v28, s[24:27], s14 offen lds
    s_add_u32 m0, s77, 4096
    s_mov_b32 s14, 131072
    buffer_load_dwordx4 v28, s[24:27], s14 offen lds
    s_add_u32 m0, s77, 5120
    s_mov_b32 s14, 163840
    buffer_load_dwordx4 v28, s[24:27], s14 offen lds
    s_add_u32 m0, s77, 6144
    s_mov_b32 s14, 196608
    buffer_load_dwordx4 v28, s[24:27], s14 offen lds
    s_add_u32 m0, s77, 7168
    s_mov_b32 s14, 229376
    buffer_load_dwordx4 v28, s[24:27], s14 offen lds
    s_add_u32 m0, s77, 32768
    s_mov_b32 s14, 262144
    buffer_load_dwordx4 v28, s[24:27], s14 offen lds
    s_add_u32 m0, s77, 33792
    s_mov_b32 s14, 294912
    buffer_load_dwordx4 v28, s[24:27], s14 offen lds
    s_add_u32 m0, s77, 34816
    s_mov_b32 s14, 327680
    buffer_load_dwordx4 v28, s[24:27], s14 offen lds
    s_add_u32 m0, s77, 35840
    s_mov_b32 s14, 360448
    buffer_load_dwordx4 v28, s[24:27], s14 offen lds
    s_add_u32 m0, s77, 36864
    s_mov_b32 s14, 393216
    buffer_load_dwordx4 v28, s[24:27], s14 offen lds
    s_add_u32 m0, s77, 37888
    s_mov_b32 s14, 425984
    buffer_load_dwordx4 v28, s[24:27], s14 offen lds
    s_add_u32 m0, s77, 38912
    s_mov_b32 s14, 458752
    buffer_load_dwordx4 v28, s[24:27], s14 offen lds
    s_add_u32 m0, s77, 39936
    s_mov_b32 s14, 491520
    buffer_load_dwordx4 v28, s[24:27], s14 offen lds
    s_add_u32 m0, s77, 65536
    s_mov_b32 s14, 1048576
    buffer_load_dwordx4 v28, s[24:27], s14 offen lds
    s_add_u32 m0, s77, 66560
    s_mov_b32 s14, 1081344
    buffer_load_dwordx4 v28, s[24:27], s14 offen lds
    s_add_u32 m0, s77, 67584
    s_mov_b32 s14, 1114112
    buffer_load_dwordx4 v28, s[24:27], s14 offen lds
    s_add_u32 m0, s77, 68608
    s_mov_b32 s14, 1146880
    buffer_load_dwordx4 v28, s[24:27], s14 offen lds
    s_add_u32 m0, s77, 69632
    s_mov_b32 s14, 1179648
    buffer_load_dwordx4 v28, s[24:27], s14 offen lds
    s_add_u32 m0, s77, 70656
    s_mov_b32 s14, 1212416
    buffer_load_dwordx4 v28, s[24:27], s14 offen lds
    s_add_u32 m0, s77, 71680
    s_mov_b32 s14, 1245184
    buffer_load_dwordx4 v28, s[24:27], s14 offen lds
    s_add_u32 m0, s77, 72704
    s_mov_b32 s14, 1277952
    buffer_load_dwordx4 v28, s[24:27], s14 offen lds
    s_waitcnt vmcnt(63)
    s_barrier
    s_cmp_lg_u32 s3, 0
    s_cbranch_scc1 pt_7
    s_or_b32 s9, s6, 192
    s_and_b32 s10, s5, 3
    s_lshl_b32 s10, s10, 3
    s_lshl_b32 s9, s9, s10
    v_mov_b32 v24, s9
    s_lshl_b32 s10, s4, 5
    s_and_b32 s11, s5, 0x1c
    s_add_u32 s10, s10, s11
    s_mov_b64 exec, 1
    buffer_atomic_or v24, off, s[56:59], s10 sc1
    s_mov_b64 exec, -1
pt_7:
    v_lshlrev_b32 v24, 12, v2
    v_lshl_add_u32 v24, v3, 4, v24
    s_xor_b32 s9, s3, 0
    s_lshl_b32 s72, s9, 15
    s_xor_b32 s9, s3, 1
    s_lshl_b32 s73, s9, 15
    s_xor_b32 s9, s3, 2
    s_lshl_b32 s74, s9, 15
    s_xor_b32 s9, s3, 3
    s_lshl_b32 s75, s9, 15
    s_lshl_b32 s9, s5, 17
    s_lshl_b32 s10, s3, 8
    s_add_u32 s9, s9, s10
    v_add_u32 v29, s9, v24
    v_add_u32 v12, s76, v4
    v_lshlrev_b32 v24, 12, v2
    v_lshl_add_u32 v24, v3, 2, v24
    s_xor_b32 s9, s3, 0
    s_and_b32 s10, s9, 1
    s_lshl_b32 s10, s10, 14
    s_lshr_b32 s9, s9, 1
    s_lshl_b32 s9, s9, 9
    s_add_u32 s9, s9, s10
    s_lshl_b32 s10, s3, 6
    s_add_u32 s9, s9, s10
    v_add_u32 v32, s9, v24
    s_xor_b32 s9, s3, 1
    s_and_b32 s10, s9, 1
    s_lshl_b32 s10, s10, 14
    s_lshr_b32 s9, s9, 1
    s_lshl_b32 s9, s9, 9
    s_add_u32 s9, s9, s10
    s_lshl_b32 s10, s3, 6
    s_add_u32 s9, s9, s10
    v_add_u32 v33, s9, v24
    s_xor_b32 s9, s3, 2
    s_and_b32 s10, s9, 1
    s_lshl_b32 s10, s10, 14
    s_lshr_b32 s9, s9, 1
    s_lshl_b32 s9, s9, 9
    s_add_u32 s9, s9, s10
    s_lshl_b32 s10, s3, 6
    s_add_u32 s9, s9, s10
    v_add_u32 v34, s9, v24
    s_xor_b32 s9, s3, 3
    s_and_b32 s10, s9, 1
    s_lshl_b32 s10, s10, 14
    s_lshr_b32 s9, s9, 1
    s_lshl_b32 s9, s9, 9
    s_add_u32 s9, s9, s10
    s_lshl_b32 s10, s3, 6
    s_add_u32 s9, s9, s10
    v_add_u32 v35, s9, v24
    s_mov_b32 s12, 84148480
    s_mov_b32 s13, 117834498
    v_and_b32 v24, 2, v1
    v_mov_b32 v25, 0x4444
    v_mov_b32 v26, 0xeeee
    v_cmp_eq_u32 vcc, 2, v24
    s_nop 1
    v_cndmask_b32 v6, v25, v26, vcc
    v_add_u32 v7, 131072, v4
    s_lshl_b32 s67, s3, 10
    v_add_u32 v16, s67, v7
    s_xor_b32 s9, s67, 1024
    v_add_u32 v17, s9, v7
    s_xor_b32 s9, s67, 2048
    v_add_u32 v18, s9, v7
    s_xor_b32 s9, s67, 3072
    v_add_u32 v19, s9, v7
    v_lshlrev_b32 v24, 12, v2
    v_lshrrev_b32 v25, 3, v3
    v_lshl_add_u32 v24, v25, 11, v24
    s_lshl_b32 s9, s3, 14
    v_and_b32 v25, 7, v3
    v_lshl_add_u32 v24, v25, 3, v24
    s_lshl_b32 s10, s5, 6
    s_add_u32 s9, s9, s10
    v_add_u32 v8, s9, v24
    v_lshlrev_b32 v24, 8, v2
    v_and_b32 v25, 3, v3
    v_lshl_add_u32 v24, v25, 6, v24
    v_lshrrev_b32 v25, 2, v3
    v_lshl_add_u32 v24, v25, 4, v24
    s_lshl_b32 s9, s64, 11
    v_add_u32 v9, s9, v5
    s_lshr_b32 s9, s64, 5
    s_lshl_b32 s9, s9, 11
    s_bfe_u32 s10, s64, 0x10004
    s_lshl_b32 s10, s10, 10
    s_add_u32 s9, s9, s10
    s_bfe_u32 s10, s64, 0x10003
    s_lshl_b32 s10, s10, 9
    s_add_u32 s9, s9, s10
    s_and_b32 s10, s64, 1
    s_lshl_b32 s10, s10, 8
    s_add_u32 s9, s9, s10
    s_bfe_u32 s10, s64, 0x20001
    s_lshl_b32 s10, s10, 6
    s_add_u32 s9, s9, s10
    v_and_b32 v24, 1, v3
    v_lshlrev_b32 v24, 4, v24
    v_bfe_u32 v25, v3, 1, 2
    v_lshl_add_u32 v24, v25, 2, v24
    v_lshrrev_b32 v25, 3, v3
    v_lshl_add_u32 v24, v25, 5, v24
    v_add_u32 v27, s9, v24
    v_bfe_u32 v24, v3, 1, 1
    v_lshlrev_b32 v24, 4, v24
    v_lshrrev_b32 v25, 1, v2
    v_lshl_add_u32 v24, v25, 5, v24
    v_and_b32 v25, 1, v2
    v_lshl_add_u32 v24, v25, 3, v24
    v_bfe_u32 v25, v3, 2, 1
    v_lshl_add_u32 v24, v25, 2, v24
    v_add_u32 v10, s9, v24
    v_mov_b32 v24, 0x7ff00000
    v_cmp_gt_u32 vcc, 16, v1
    s_nop 1
    v_cndmask_b32 v10, v24, v27, vcc
    s_lshr_b32 s9, s3, 1
    s_lshl_b32 s9, s9, 10
    s_and_b32 s10, s3, 1
    s_lshl_b32 s10, s10, 8
    s_add_u32 s9, s9, s10
    s_add_u32 s9, s9, 139264
    v_bfe_u32 v24, v3, 2, 1
    v_lshlrev_b32 v24, 9, v24
    v_lshrrev_b32 v25, 3, v3
    v_lshl_add_u32 v24, v25, 7, v24
    v_lshl_add_u32 v24, v2, 5, v24
    v_and_b32 v25, 3, v3
    v_lshl_add_u32 v24, v25, 2, v24
    v_add_u32 v11, s9, v24
    v_lshlrev_b32 v24, 7, v2
    v_lshrrev_b32 v25, 2, v3
    v_lshl_add_u32 v24, v25, 5, v24
    v_and_b32 v25, 1, v3
    v_lshl_add_u32 v24, v25, 4, v24
    v_add_u32 v13, 139264, v24
    s_lshl_b32 s9, s3, 9
    s_add_u32 s9, s9, 143360
    v_add_u32 v15, s9, v24
    v_xor_b32 v14, 512, v15
    v_min_u32 v24, 19, v1
    v_lshlrev_b32 v24, 2, v24
    s_lshl_b32 s9, s5, 7
    s_add_u32 s9, s9, 6881280
    v_add_u32 v20, s9, v24
    v_lshrrev_b32 v24, 2, v3
    v_lshlrev_b32 v24, 11, v24
    v_and_b32 v25, 1, v3
    v_lshl_add_u32 v24, v25, 10, v24
    v_lshl_add_u32 v24, v2, 7, v24
    v_bfe_u32 v25, v3, 1, 1
    v_lshl_add_u32 v24, v25, 6, v24
    s_and_b32 s9, s3, 1
    s_lshl_b32 s9, s9, 9
    s_lshr_b32 s10, s3, 1
    s_lshl_b32 s10, s10, 2
    s_add_u32 s78, s9, s10
    v_mov_b32 v23, v24
    v_mov_b32 v24, 0x3f80
    v_mov_b32 v25, 0x3f800000
    v_cmp_eq_u32 vcc, 0, v3
    s_nop 1
    v_cndmask_b32 v40, 0, v24, vcc
    v_cmp_eq_u32 vcc, 1, v3
    s_nop 1
    v_cndmask_b32 v40, v40, v25, vcc
    v_mov_b32 v24, 0x3f80
    v_mov_b32 v25, 0x3f800000
    v_cmp_eq_u32 vcc, 2, v3
    s_nop 1
    v_cndmask_b32 v41, 0, v24, vcc
    v_cmp_eq_u32 vcc, 3, v3
    s_nop 1
    v_cndmask_b32 v41, v41, v25, vcc
    v_mov_b32 v24, 0x3f80
    v_mov_b32 v25, 0x3f800000
    v_cmp_eq_u32 vcc, 4, v3
    s_nop 1
    v_cndmask_b32 v42, 0, v24, vcc
    v_cmp_eq_u32 vcc, 5, v3
    s_nop 1
    v_cndmask_b32 v42, v42, v25, vcc
    v_mov_b32 v24, 0x3f80
    v_mov_b32 v25, 0x3f800000
    v_cmp_eq_u32 vcc, 6, v3
    s_nop 1
    v_cndmask_b32 v43, 0, v24, vcc
    v_cmp_eq_u32 vcc, 7, v3
    s_nop 1
    v_cndmask_b32 v43, v43, v25, vcc
    v_mov_b32 v0, v40
    v_mov_b32 v1, v40
    v_mov_b32 v2, v40
    v_mov_b32 v3, v40
    s_lshl_b32 s9, s3, 11
    s_add_u32 s66, s9, 145408
    s_add_u32 s15, s67, 153600
    s_mov_b32 s68, 0
    s_mul_i32 s69, s5, 16384
    s_add_u32 s69, s69, 8388608
    s_mov_b32 s71, 0x3e0293ee
    s_waitcnt vmcnt(16)
    s_barrier
    s_add_u32 m0, s77, 98304
    s_mov_b32 s14, 1310720
    buffer_load_dwordx4 v28, s[24:27], s14 offen lds
    s_add_u32 m0, s77, 99328
    s_mov_b32 s14, 1343488
    buffer_load_dwordx4 v28, s[24:27], s14 offen lds
    s_add_u32 m0, s77, 100352
    s_mov_b32 s14, 1376256
    buffer_load_dwordx4 v28, s[24:27], s14 offen lds
    s_add_u32 m0, s77, 101376
    s_mov_b32 s14, 1409024
    buffer_load_dwordx4 v28, s[24:27], s14 offen lds
    s_add_u32 m0, s77, 102400
    s_mov_b32 s14, 1441792
    buffer_load_dwordx4 v28, s[24:27], s14 offen lds
    s_add_u32 m0, s77, 103424
    s_mov_b32 s14, 1474560
    buffer_load_dwordx4 v28, s[24:27], s14 offen lds
    s_add_u32 m0, s77, 104448
    s_mov_b32 s14, 1507328
    buffer_load_dwordx4 v28, s[24:27], s14 offen lds
    s_add_u32 m0, s77, 105472
    s_mov_b32 s14, 1540096
    buffer_load_dwordx4 v28, s[24:27], s14 offen lds
    v_add_u32 v36, 0, v32
    v_add_u32 v37, 0, v33
    v_add_u32 v38, 0, v34
    v_add_u32 v39, 0, v35
    ds_read2st64_b32 v[44:45], v36 offset0:0 offset1:1
    ds_read2st64_b32 v[46:47], v36 offset0:8 offset1:9
    ds_read2st64_b32 v[48:49], v37 offset0:0 offset1:1
    ds_read2st64_b32 v[50:51], v37 offset0:8 offset1:9
    ds_read2st64_b32 v[52:53], v38 offset0:0 offset1:1
    ds_read2st64_b32 v[54:55], v38 offset0:8 offset1:9
    ds_read2st64_b32 v[56:57], v39 offset0:0 offset1:1
    ds_read2st64_b32 v[58:59], v39 offset0:8 offset1:9
    s_waitcnt lgkmcnt(6)
    v_lshlrev_b32 v62, 16, v44
    v_mul_f32 v62, 0x3e0293ee, v62
    v_lshlrev_b32 v63, 16, v45
    v_mul_f32 v63, 0x3e0293ee, v63
    v_cvt_pk_bf16_f32 v60, v62, v63
    v_accvgpr_write_b32 a0, v60
    v_and_b32 v62, 0xffff0000, v44
    v_mul_f32 v62, 0x3e0293ee, v62
    v_and_b32 v63, 0xffff0000, v45
    v_mul_f32 v63, 0x3e0293ee, v63
    v_cvt_pk_bf16_f32 v61, v62, v63
    v_accvgpr_write_b32 a8, v61
    v_lshlrev_b32 v62, 16, v46
    v_mul_f32 v62, 0x3e0293ee, v62
    v_lshlrev_b32 v63, 16, v47
    v_mul_f32 v63, 0x3e0293ee, v63
    v_cvt_pk_bf16_f32 v60, v62, v63
    v_accvgpr_write_b32 a2, v60
    v_and_b32 v62, 0xffff0000, v46
    v_mul_f32 v62, 0x3e0293ee, v62
    v_and_b32 v63, 0xffff0000, v47
    v_mul_f32 v63, 0x3e0293ee, v63
    v_cvt_pk_bf16_f32 v61, v62, v63
    v_accvgpr_write_b32 a10, v61
    s_waitcnt lgkmcnt(4)
    v_lshlrev_b32 v62, 16, v48
    v_mul_f32 v62, 0x3e0293ee, v62
    v_lshlrev_b32 v63, 16, v49
    v_mul_f32 v63, 0x3e0293ee, v63
    v_cvt_pk_bf16_f32 v60, v62, v63
    v_accvgpr_write_b32 a16, v60
    v_and_b32 v62, 0xffff0000, v48
    v_mul_f32 v62, 0x3e0293ee, v62
    v_and_b32 v63, 0xffff0000, v49
    v_mul_f32 v63, 0x3e0293ee, v63
    v_cvt_pk_bf16_f32 v61, v62, v63
    v_accvgpr_write_b32 a24, v61
    v_lshlrev_b32 v62, 16, v50
    v_mul_f32 v62, 0x3e0293ee, v62
    v_lshlrev_b32 v63, 16, v51
    v_mul_f32 v63, 0x3e0293ee, v63
    v_cvt_pk_bf16_f32 v60, v62, v63
    v_accvgpr_write_b32 a18, v60
    v_and_b32 v62, 0xffff0000, v50
    v_mul_f32 v62, 0x3e0293ee, v62
    v_and_b32 v63, 0xffff0000, v51
    v_mul_f32 v63, 0x3e0293ee, v63
    v_cvt_pk_bf16_f32 v61, v62, v63
    v_accvgpr_write_b32 a26, v61
    s_waitcnt lgkmcnt(2)
    v_lshlrev_b32 v62, 16, v52
    v_mul_f32 v62, 0x3e0293ee, v62
    v_lshlrev_b32 v63, 16, v53
    v_mul_f32 v63, 0x3e0293ee, v63
    v_cvt_pk_bf16_f32 v60, v62, v63
    v_accvgpr_write_b32 a32, v60
    v_and_b32 v62, 0xffff0000, v52
    v_mul_f32 v62, 0x3e0293ee, v62
    v_and_b32 v63, 0xffff0000, v53
    v_mul_f32 v63, 0x3e0293ee, v63
    v_cvt_pk_bf16_f32 v61, v62, v63
    v_accvgpr_write_b32 a40, v61
    v_lshlrev_b32 v62, 16, v54
    v_mul_f32 v62, 0x3e0293ee, v62
    v_lshlrev_b32 v63, 16, v55
    v_mul_f32 v63, 0x3e0293ee, v63
    v_cvt_pk_bf16_f32 v60, v62, v63
    v_accvgpr_write_b32 a34, v60
    v_and_b32 v62, 0xffff0000, v54
    v_mul_f32 v62, 0x3e0293ee, v62
    v_and_b32 v63, 0xffff0000, v55
    v_mul_f32 v63, 0x3e0293ee, v63
    v_cvt_pk_bf16_f32 v61, v62, v63
    v_accvgpr_write_b32 a42, v61
    s_waitcnt lgkmcnt(0)
    v_lshlrev_b32 v62, 16, v56
    v_mul_f32 v62, 0x3e0293ee, v62
    v_lshlrev_b32 v63, 16, v57
    v_mul_f32 v63, 0x3e0293ee, v63
    v_cvt_pk_bf16_f32 v60, v62, v63
    v_accvgpr_write_b32 a48, v60
    v_and_b32 v62, 0xffff0000, v56
    v_mul_f32 v62, 0x3e0293ee, v62
    v_and_b32 v63, 0xffff0000, v57
    v_mul_f32 v63, 0x3e0293ee, v63
    v_cvt_pk_bf16_f32 v61, v62, v63
    v_accvgpr_write_b32 a56, v61
    v_lshlrev_b32 v62, 16, v58
    v_mul_f32 v62, 0x3e0293ee, v62
    v_lshlrev_b32 v63, 16, v59
    v_mul_f32 v63, 0x3e0293ee, v63
    v_cvt_pk_bf16_f32 v60, v62, v63
    v_accvgpr_write_b32 a50, v60
    v_and_b32 v62, 0xffff0000, v58
    v_mul_f32 v62, 0x3e0293ee, v62
    v_and_b32 v63, 0xffff0000, v59
    v_mul_f32 v63, 0x3e0293ee, v63
    v_cvt_pk_bf16_f32 v61, v62, v63
    v_accvgpr_write_b32 a58, v61
    ds_read2st64_b32 v[44:45], v36 offset0:4 offset1:5
    ds_read2st64_b32 v[46:47], v36 offset0:12 offset1:13
    ds_read2st64_b32 v[48:49], v37 offset0:4 offset1:5
    ds_read2st64_b32 v[50:51], v37 offset0:12 offset1:13
    ds_read2st64_b32 v[52:53], v38 offset0:4 offset1:5
    ds_read2st64_b32 v[54:55], v38 offset0:12 offset1:13
    ds_read2st64_b32 v[56:57], v39 offset0:4 offset1:5
    ds_read2st64_b32 v[58:59], v39 offset0:12 offset1:13
    s_waitcnt lgkmcnt(6)
    v_lshlrev_b32 v62, 16, v44
    v_mul_f32 v62, 0x3e0293ee, v62
    v_lshlrev_b32 v63, 16, v45
    v_mul_f32 v63, 0x3e0293ee, v63
    v_cvt_pk_bf16_f32 v60, v62, v63
    v_accvgpr_write_b32 a64, v60
    v_and_b32 v62, 0xffff0000, v44
    v_mul_f32 v62, 0x3e0293ee, v62
    v_and_b32 v63, 0xffff0000, v45
    v_mul_f32 v63, 0x3e0293ee, v63
    v_cvt_pk_bf16_f32 v61, v62, v63
    v_accvgpr_write_b32 a72, v61
    v_lshlrev_b32 v62, 16, v46
    v_mul_f32 v62, 0x3e0293ee, v62
    v_lshlrev_b32 v63, 16, v47
    v_mul_f32 v63, 0x3e0293ee, v63
    v_cvt_pk_bf16_f32 v60, v62, v63
    v_accvgpr_write_b32 a66, v60
    v_and_b32 v62, 0xffff0000, v46
    v_mul_f32 v62, 0x3e0293ee, v62
    v_and_b32 v63, 0xffff0000, v47
    v_mul_f32 v63, 0x3e0293ee, v63
    v_cvt_pk_bf16_f32 v61, v62, v63
    v_accvgpr_write_b32 a74, v61
    s_waitcnt lgkmcnt(4)
    v_lshlrev_b32 v62, 16, v48
    v_mul_f32 v62, 0x3e0293ee, v62
    v_lshlrev_b32 v63, 16, v49
    v_mul_f32 v63, 0x3e0293ee, v63
    v_cvt_pk_bf16_f32 v60, v62, v63
    v_accvgpr_write_b32 a80, v60
    v_and_b32 v62, 0xffff0000, v48
    v_mul_f32 v62, 0x3e0293ee, v62
    v_and_b32 v63, 0xffff0000, v49
    v_mul_f32 v63, 0x3e0293ee, v63
    v_cvt_pk_bf16_f32 v61, v62, v63
    v_accvgpr_write_b32 a88, v61
    v_lshlrev_b32 v62, 16, v50
    v_mul_f32 v62, 0x3e0293ee, v62
    v_lshlrev_b32 v63, 16, v51
    v_mul_f32 v63, 0x3e0293ee, v63
    v_cvt_pk_bf16_f32 v60, v62, v63
    v_accvgpr_write_b32 a82, v60
    v_and_b32 v62, 0xffff0000, v50
    v_mul_f32 v62, 0x3e0293ee, v62
    v_and_b32 v63, 0xffff0000, v51
    v_mul_f32 v63, 0x3e0293ee, v63
    v_cvt_pk_bf16_f32 v61, v62, v63
    v_accvgpr_write_b32 a90, v61
    s_waitcnt lgkmcnt(2)
    v_lshlrev_b32 v62, 16, v52
    v_mul_f32 v62, 0x3e0293ee, v62
    v_lshlrev_b32 v63, 16, v53
    v_mul_f32 v63, 0x3e0293ee, v63
    v_cvt_pk_bf16_f32 v60, v62, v63
    v_accvgpr_write_b32 a96, v60
    v_and_b32 v62, 0xffff0000, v52
    v_mul_f32 v62, 0x3e0293ee, v62
    v_and_b32 v63, 0xffff0000, v53
    v_mul_f32 v63, 0x3e0293ee, v63
    v_cvt_pk_bf16_f32 v61, v62, v63
    v_accvgpr_write_b32 a104, v61
    v_lshlrev_b32 v62, 16, v54
    v_mul_f32 v62, 0x3e0293ee, v62
    v_lshlrev_b32 v63, 16, v55
    v_mul_f32 v63, 0x3e0293ee, v63
    v_cvt_pk_bf16_f32 v60, v62, v63
    v_accvgpr_write_b32 a98, v60
    v_and_b32 v62, 0xffff0000, v54
    v_mul_f32 v62, 0x3e0293ee, v62
    v_and_b32 v63, 0xffff0000, v55
    v_mul_f32 v63, 0x3e0293ee, v63
    v_cvt_pk_bf16_f32 v61, v62, v63
    v_accvgpr_write_b32 a106, v61
    s_waitcnt lgkmcnt(0)
    v_lshlrev_b32 v62, 16, v56
    v_mul_f32 v62, 0x3e0293ee, v62
    v_lshlrev_b32 v63, 16, v57
    v_mul_f32 v63, 0x3e0293ee, v63
    v_cvt_pk_bf16_f32 v60, v62, v63
    v_accvgpr_write_b32 a112, v60
    v_and_b32 v62, 0xffff0000, v56
    v_mul_f32 v62, 0x3e0293ee, v62
    v_and_b32 v63, 0xffff0000, v57
    v_mul_f32 v63, 0x3e0293ee, v63
    v_cvt_pk_bf16_f32 v61, v62, v63
    v_accvgpr_write_b32 a120, v61
    v_lshlrev_b32 v62, 16, v58
    v_mul_f32 v62, 0x3e0293ee, v62
    v_lshlrev_b32 v63, 16, v59
    v_mul_f32 v63, 0x3e0293ee, v63
    v_cvt_pk_bf16_f32 v60, v62, v63
    v_accvgpr_write_b32 a114, v60
    v_and_b32 v62, 0xffff0000, v58
    v_mul_f32 v62, 0x3e0293ee, v62
    v_and_b32 v63, 0xffff0000, v59
    v_mul_f32 v63, 0x3e0293ee, v63
    v_cvt_pk_bf16_f32 v61, v62, v63
    v_accvgpr_write_b32 a122, v61
    s_waitcnt vmcnt(16)
    s_barrier
    s_add_u32 m0, s77, 0
    s_mov_b32 s14, 0
    buffer_load_dwordx4 v28, s[28:31], s14 offen lds
    s_add_u32 m0, s77, 1024
    s_mov_b32 s14, 32768
    buffer_load_dwordx4 v28, s[28:31], s14 offen lds
    s_add_u32 m0, s77, 2048
    s_mov_b32 s14, 65536
    buffer_load_dwordx4 v28, s[28:31], s14 offen lds
    s_add_u32 m0, s77, 3072
    s_mov_b32 s14, 98304
    buffer_load_dwordx4 v28, s[28:31], s14 offen lds
    s_add_u32 m0, s77, 4096
    s_mov_b32 s14, 131072
    buffer_load_dwordx4 v28, s[28:31], s14 offen lds
    s_add_u32 m0, s77, 5120
    s_mov_b32 s14, 163840
    buffer_load_dwordx4 v28, s[28:31], s14 offen lds
    s_add_u32 m0, s77, 6144
    s_mov_b32 s14, 196608
    buffer_load_dwordx4 v28, s[28:31], s14 offen lds
    s_add_u32 m0, s77, 7168
    s_mov_b32 s14, 229376
    buffer_load_dwordx4 v28, s[28:31], s14 offen lds
    v_add_u32 v36, 32768, v32
    v_add_u32 v37, 32768, v33
    v_add_u32 v38, 32768, v34
    v_add_u32 v39, 32768, v35
    ds_read2st64_b32 v[44:45], v36 offset0:0 offset1:1
    ds_read2st64_b32 v[46:47], v36 offset0:8 offset1:9
    ds_read2st64_b32 v[48:49], v37 offset0:0 offset1:1
    ds_read2st64_b32 v[50:51], v37 offset0:8 offset1:9
    ds_read2st64_b32 v[52:53], v38 offset0:0 offset1:1
    ds_read2st64_b32 v[54:55], v38 offset0:8 offset1:9
    ds_read2st64_b32 v[56:57], v39 offset0:0 offset1:1
    ds_read2st64_b32 v[58:59], v39 offset0:8 offset1:9
    s_waitcnt lgkmcnt(6)
    v_lshlrev_b32 v62, 16, v44
    v_mul_f32 v62, 0x3e0293ee, v62
    v_lshlrev_b32 v63, 16, v45
    v_mul_f32 v63, 0x3e0293ee, v63
    v_cvt_pk_bf16_f32 v60, v62, v63
    v_accvgpr_write_b32 a1, v60
    v_and_b32 v62, 0xffff0000, v44
    v_mul_f32 v62, 0x3e0293ee, v62
    v_and_b32 v63, 0xffff0000, v45
    v_mul_f32 v63, 0x3e0293ee, v63
    v_cvt_pk_bf16_f32 v61, v62, v63
    v_accvgpr_write_b32 a9, v61
    v_lshlrev_b32 v62, 16, v46
    v_mul_f32 v62, 0x3e0293ee, v62
    v_lshlrev_b32 v63, 16, v47
    v_mul_f32 v63, 0x3e0293ee, v63
    v_cvt_pk_bf16_f32 v60, v62, v63
    v_accvgpr_write_b32 a3, v60
    v_and_b32 v62, 0xffff0000, v46
    v_mul_f32 v62, 0x3e0293ee, v62
    v_and_b32 v63, 0xffff0000, v47
    v_mul_f32 v63, 0x3e0293ee, v63
    v_cvt_pk_bf16_f32 v61, v62, v63
    v_accvgpr_write_b32 a11, v61
    s_waitcnt lgkmcnt(4)
    v_lshlrev_b32 v62, 16, v48
    v_mul_f32 v62, 0x3e0293ee, v62
    v_lshlrev_b32 v63, 16, v49
    v_mul_f32 v63, 0x3e0293ee, v63
    v_cvt_pk_bf16_f32 v60, v62, v63
    v_accvgpr_write_b32 a17, v60
    v_and_b32 v62, 0xffff0000, v48
    v_mul_f32 v62, 0x3e0293ee, v62
    v_and_b32 v63, 0xffff0000, v49
    v_mul_f32 v63, 0x3e0293ee, v63
    v_cvt_pk_bf16_f32 v61, v62, v63
    v_accvgpr_write_b32 a25, v61
    v_lshlrev_b32 v62, 16, v50
    v_mul_f32 v62, 0x3e0293ee, v62
    v_lshlrev_b32 v63, 16, v51
    v_mul_f32 v63, 0x3e0293ee, v63
    v_cvt_pk_bf16_f32 v60, v62, v63
    v_accvgpr_write_b32 a19, v60
    v_and_b32 v62, 0xffff0000, v50
    v_mul_f32 v62, 0x3e0293ee, v62
    v_and_b32 v63, 0xffff0000, v51
    v_mul_f32 v63, 0x3e0293ee, v63
    v_cvt_pk_bf16_f32 v61, v62, v63
    v_accvgpr_write_b32 a27, v61
    s_waitcnt lgkmcnt(2)
    v_lshlrev_b32 v62, 16, v52
    v_mul_f32 v62, 0x3e0293ee, v62
    v_lshlrev_b32 v63, 16, v53
    v_mul_f32 v63, 0x3e0293ee, v63
    v_cvt_pk_bf16_f32 v60, v62, v63
    v_accvgpr_write_b32 a33, v60
    v_and_b32 v62, 0xffff0000, v52
    v_mul_f32 v62, 0x3e0293ee, v62
    v_and_b32 v63, 0xffff0000, v53
    v_mul_f32 v63, 0x3e0293ee, v63
    v_cvt_pk_bf16_f32 v61, v62, v63
    v_accvgpr_write_b32 a41, v61
    v_lshlrev_b32 v62, 16, v54
    v_mul_f32 v62, 0x3e0293ee, v62
    v_lshlrev_b32 v63, 16, v55
    v_mul_f32 v63, 0x3e0293ee, v63
    v_cvt_pk_bf16_f32 v60, v62, v63
    v_accvgpr_write_b32 a35, v60
    v_and_b32 v62, 0xffff0000, v54
    v_mul_f32 v62, 0x3e0293ee, v62
    v_and_b32 v63, 0xffff0000, v55
    v_mul_f32 v63, 0x3e0293ee, v63
    v_cvt_pk_bf16_f32 v61, v62, v63
    v_accvgpr_write_b32 a43, v61
    s_waitcnt lgkmcnt(0)
    v_lshlrev_b32 v62, 16, v56
    v_mul_f32 v62, 0x3e0293ee, v62
    v_lshlrev_b32 v63, 16, v57
    v_mul_f32 v63, 0x3e0293ee, v63
    v_cvt_pk_bf16_f32 v60, v62, v63
    v_accvgpr_write_b32 a49, v60
    v_and_b32 v62, 0xffff0000, v56
    v_mul_f32 v62, 0x3e0293ee, v62
    v_and_b32 v63, 0xffff0000, v57
    v_mul_f32 v63, 0x3e0293ee, v63
    v_cvt_pk_bf16_f32 v61, v62, v63
    v_accvgpr_write_b32 a57, v61
    v_lshlrev_b32 v62, 16, v58
    v_mul_f32 v62, 0x3e0293ee, v62
    v_lshlrev_b32 v63, 16, v59
    v_mul_f32 v63, 0x3e0293ee, v63
    v_cvt_pk_bf16_f32 v60, v62, v63
    v_accvgpr_write_b32 a51, v60
    v_and_b32 v62, 0xffff0000, v58
    v_mul_f32 v62, 0x3e0293ee, v62
    v_and_b32 v63, 0xffff0000, v59
    v_mul_f32 v63, 0x3e0293ee, v63
    v_cvt_pk_bf16_f32 v61, v62, v63
    v_accvgpr_write_b32 a59, v61
    ds_read2st64_b32 v[44:45], v36 offset0:4 offset1:5
    ds_read2st64_b32 v[46:47], v36 offset0:12 offset1:13
    ds_read2st64_b32 v[48:49], v37 offset0:4 offset1:5
    ds_read2st64_b32 v[50:51], v37 offset0:12 offset1:13
    ds_read2st64_b32 v[52:53], v38 offset0:4 offset1:5
    ds_read2st64_b32 v[54:55], v38 offset0:12 offset1:13
    ds_read2st64_b32 v[56:57], v39 offset0:4 offset1:5
    ds_read2st64_b32 v[58:59], v39 offset0:12 offset1:13
    s_waitcnt lgkmcnt(6)
    v_lshlrev_b32 v62, 16, v44
    v_mul_f32 v62, 0x3e0293ee, v62
    v_lshlrev_b32 v63, 16, v45
    v_mul_f32 v63, 0x3e0293ee, v63
    v_cvt_pk_bf16_f32 v60, v62, v63
    v_accvgpr_write_b32 a65, v60
    v_and_b32 v62, 0xffff0000, v44
    v_mul_f32 v62, 0x3e0293ee, v62
    v_and_b32 v63, 0xffff0000, v45
    v_mul_f32 v63, 0x3e0293ee, v63
    v_cvt_pk_bf16_f32 v61, v62, v63
    v_accvgpr_write_b32 a73, v61
    v_lshlrev_b32 v62, 16, v46
    v_mul_f32 v62, 0x3e0293ee, v62
    v_lshlrev_b32 v63, 16, v47
    v_mul_f32 v63, 0x3e0293ee, v63
    v_cvt_pk_bf16_f32 v60, v62, v63
    v_accvgpr_write_b32 a67, v60
    v_and_b32 v62, 0xffff0000, v46
    v_mul_f32 v62, 0x3e0293ee, v62
    v_and_b32 v63, 0xffff0000, v47
    v_mul_f32 v63, 0x3e0293ee, v63
    v_cvt_pk_bf16_f32 v61, v62, v63
    v_accvgpr_write_b32 a75, v61
    s_waitcnt lgkmcnt(4)
    v_lshlrev_b32 v62, 16, v48
    v_mul_f32 v62, 0x3e0293ee, v62
    v_lshlrev_b32 v63, 16, v49
    v_mul_f32 v63, 0x3e0293ee, v63
    v_cvt_pk_bf16_f32 v60, v62, v63
    v_accvgpr_write_b32 a81, v60
    v_and_b32 v62, 0xffff0000, v48
    v_mul_f32 v62, 0x3e0293ee, v62
    v_and_b32 v63, 0xffff0000, v49
    v_mul_f32 v63, 0x3e0293ee, v63
    v_cvt_pk_bf16_f32 v61, v62, v63
    v_accvgpr_write_b32 a89, v61
    v_lshlrev_b32 v62, 16, v50
    v_mul_f32 v62, 0x3e0293ee, v62
    v_lshlrev_b32 v63, 16, v51
    v_mul_f32 v63, 0x3e0293ee, v63
    v_cvt_pk_bf16_f32 v60, v62, v63
    v_accvgpr_write_b32 a83, v60
    v_and_b32 v62, 0xffff0000, v50
    v_mul_f32 v62, 0x3e0293ee, v62
    v_and_b32 v63, 0xffff0000, v51
    v_mul_f32 v63, 0x3e0293ee, v63
    v_cvt_pk_bf16_f32 v61, v62, v63
    v_accvgpr_write_b32 a91, v61
    s_waitcnt lgkmcnt(2)
    v_lshlrev_b32 v62, 16, v52
    v_mul_f32 v62, 0x3e0293ee, v62
    v_lshlrev_b32 v63, 16, v53
    v_mul_f32 v63, 0x3e0293ee, v63
    v_cvt_pk_bf16_f32 v60, v62, v63
    v_accvgpr_write_b32 a97, v60
    v_and_b32 v62, 0xffff0000, v52
    v_mul_f32 v62, 0x3e0293ee, v62
    v_and_b32 v63, 0xffff0000, v53
    v_mul_f32 v63, 0x3e0293ee, v63
    v_cvt_pk_bf16_f32 v61, v62, v63
    v_accvgpr_write_b32 a105, v61
    v_lshlrev_b32 v62, 16, v54
    v_mul_f32 v62, 0x3e0293ee, v62
    v_lshlrev_b32 v63, 16, v55
    v_mul_f32 v63, 0x3e0293ee, v63
    v_cvt_pk_bf16_f32 v60, v62, v63
    v_accvgpr_write_b32 a99, v60
    v_and_b32 v62, 0xffff0000, v54
    v_mul_f32 v62, 0x3e0293ee, v62
    v_and_b32 v63, 0xffff0000, v55
    v_mul_f32 v63, 0x3e0293ee, v63
    v_cvt_pk_bf16_f32 v61, v62, v63
    v_accvgpr_write_b32 a107, v61
    s_waitcnt lgkmcnt(0)
    v_lshlrev_b32 v62, 16, v56
    v_mul_f32 v62, 0x3e0293ee, v62
    v_lshlrev_b32 v63, 16, v57
    v_mul_f32 v63, 0x3e0293ee, v63
    v_cvt_pk_bf16_f32 v60, v62, v63
    v_accvgpr_write_b32 a113, v60
    v_and_b32 v62, 0xffff0000, v56
    v_mul_f32 v62, 0x3e0293ee, v62
    v_and_b32 v63, 0xffff0000, v57
    v_mul_f32 v63, 0x3e0293ee, v63
    v_cvt_pk_bf16_f32 v61, v62, v63
    v_accvgpr_write_b32 a121, v61
    v_lshlrev_b32 v62, 16, v58
    v_mul_f32 v62, 0x3e0293ee, v62
    v_lshlrev_b32 v63, 16, v59
    v_mul_f32 v63, 0x3e0293ee, v63
    v_cvt_pk_bf16_f32 v60, v62, v63
    v_accvgpr_write_b32 a115, v60
    v_and_b32 v62, 0xffff0000, v58
    v_mul_f32 v62, 0x3e0293ee, v62
    v_and_b32 v63, 0xffff0000, v59
    v_mul_f32 v63, 0x3e0293ee, v63
    v_cvt_pk_bf16_f32 v61, v62, v63
    v_accvgpr_write_b32 a123, v61
    s_waitcnt vmcnt(16)
    s_barrier
    s_add_u32 m0, s77, 32768
    s_mov_b32 s14, 262144
    buffer_load_dwordx4 v28, s[28:31], s14 offen lds
    s_add_u32 m0, s77, 33792
    s_mov_b32 s14, 294912
    buffer_load_dwordx4 v28, s[28:31], s14 offen lds
    s_add_u32 m0, s77, 34816
    s_mov_b32 s14, 327680
    buffer_load_dwordx4 v28, s[28:31], s14 offen lds
    s_add_u32 m0, s77, 35840
    s_mov_b32 s14, 360448
    buffer_load_dwordx4 v28, s[28:31], s14 offen lds
    s_add_u32 m0, s77, 36864
    s_mov_b32 s14, 393216
    buffer_load_dwordx4 v28, s[28:31], s14 offen lds
    s_add_u32 m0, s77, 37888
    s_mov_b32 s14, 425984
    buffer_load_dwordx4 v28, s[28:31], s14 offen lds
    s_add_u32 m0, s77, 38912
    s_mov_b32 s14, 458752
    buffer_load_dwordx4 v28, s[28:31], s14 offen lds
    s_add_u32 m0, s77, 39936
    s_mov_b32 s14, 491520
    buffer_load_dwordx4 v28, s[28:31], s14 offen lds
    v_add_u32 v36, 65536, v32
    v_add_u32 v37, 65536, v33
    v_add_u32 v38, 65536, v34
    v_add_u32 v39, 65536, v35
    ds_read2st64_b32 v[44:45], v36 offset0:0 offset1:1
    ds_read2st64_b32 v[46:47], v36 offset0:8 offset1:9
    ds_read2st64_b32 v[48:49], v37 offset0:0 offset1:1
    ds_read2st64_b32 v[50:51], v37 offset0:8 offset1:9
    ds_read2st64_b32 v[52:53], v38 offset0:0 offset1:1
    ds_read2st64_b32 v[54:55], v38 offset0:8 offset1:9
    ds_read2st64_b32 v[56:57], v39 offset0:0 offset1:1
    ds_read2st64_b32 v[58:59], v39 offset0:8 offset1:9
    s_waitcnt lgkmcnt(6)
    v_lshlrev_b32 v62, 16, v44
    v_mul_f32 v62, 0x3e0293ee, v62
    v_lshlrev_b32 v63, 16, v45
    v_mul_f32 v63, 0x3e0293ee, v63
    v_cvt_pk_bf16_f32 v60, v62, v63
    v_accvgpr_write_b32 a4, v60
    v_and_b32 v62, 0xffff0000, v44
    v_mul_f32 v62, 0x3e0293ee, v62
    v_and_b32 v63, 0xffff0000, v45
    v_mul_f32 v63, 0x3e0293ee, v63
    v_cvt_pk_bf16_f32 v61, v62, v63
    v_accvgpr_write_b32 a12, v61
    v_lshlrev_b32 v62, 16, v46
    v_mul_f32 v62, 0x3e0293ee, v62
    v_lshlrev_b32 v63, 16, v47
    v_mul_f32 v63, 0x3e0293ee, v63
    v_cvt_pk_bf16_f32 v60, v62, v63
    v_accvgpr_write_b32 a6, v60
    v_and_b32 v62, 0xffff0000, v46
    v_mul_f32 v62, 0x3e0293ee, v62
    v_and_b32 v63, 0xffff0000, v47
    v_mul_f32 v63, 0x3e0293ee, v63
    v_cvt_pk_bf16_f32 v61, v62, v63
    v_accvgpr_write_b32 a14, v61
    s_waitcnt lgkmcnt(4)
    v_lshlrev_b32 v62, 16, v48
    v_mul_f32 v62, 0x3e0293ee, v62
    v_lshlrev_b32 v63, 16, v49
    v_mul_f32 v63, 0x3e0293ee, v63
    v_cvt_pk_bf16_f32 v60, v62, v63
    v_accvgpr_write_b32 a20, v60
    v_and_b32 v62, 0xffff0000, v48
    v_mul_f32 v62, 0x3e0293ee, v62
    v_and_b32 v63, 0xffff0000, v49
    v_mul_f32 v63, 0x3e0293ee, v63
    v_cvt_pk_bf16_f32 v61, v62, v63
    v_accvgpr_write_b32 a28, v61
    v_lshlrev_b32 v62, 16, v50
    v_mul_f32 v62, 0x3e0293ee, v62
    v_lshlrev_b32 v63, 16, v51
    v_mul_f32 v63, 0x3e0293ee, v63
    v_cvt_pk_bf16_f32 v60, v62, v63
    v_accvgpr_write_b32 a22, v60
    v_and_b32 v62, 0xffff0000, v50
    v_mul_f32 v62, 0x3e0293ee, v62
    v_and_b32 v63, 0xffff0000, v51
    v_mul_f32 v63, 0x3e0293ee, v63
    v_cvt_pk_bf16_f32 v61, v62, v63
    v_accvgpr_write_b32 a30, v61
    s_waitcnt lgkmcnt(2)
    v_lshlrev_b32 v62, 16, v52
    v_mul_f32 v62, 0x3e0293ee, v62
    v_lshlrev_b32 v63, 16, v53
    v_mul_f32 v63, 0x3e0293ee, v63
    v_cvt_pk_bf16_f32 v60, v62, v63
    v_accvgpr_write_b32 a36, v60
    v_and_b32 v62, 0xffff0000, v52
    v_mul_f32 v62, 0x3e0293ee, v62
    v_and_b32 v63, 0xffff0000, v53
    v_mul_f32 v63, 0x3e0293ee, v63
    v_cvt_pk_bf16_f32 v61, v62, v63
    v_accvgpr_write_b32 a44, v61
    v_lshlrev_b32 v62, 16, v54
    v_mul_f32 v62, 0x3e0293ee, v62
    v_lshlrev_b32 v63, 16, v55
    v_mul_f32 v63, 0x3e0293ee, v63
    v_cvt_pk_bf16_f32 v60, v62, v63
    v_accvgpr_write_b32 a38, v60
    v_and_b32 v62, 0xffff0000, v54
    v_mul_f32 v62, 0x3e0293ee, v62
    v_and_b32 v63, 0xffff0000, v55
    v_mul_f32 v63, 0x3e0293ee, v63
    v_cvt_pk_bf16_f32 v61, v62, v63
    v_accvgpr_write_b32 a46, v61
    s_waitcnt lgkmcnt(0)
    v_lshlrev_b32 v62, 16, v56
    v_mul_f32 v62, 0x3e0293ee, v62
    v_lshlrev_b32 v63, 16, v57
    v_mul_f32 v63, 0x3e0293ee, v63
    v_cvt_pk_bf16_f32 v60, v62, v63
    v_accvgpr_write_b32 a52, v60
    v_and_b32 v62, 0xffff0000, v56
    v_mul_f32 v62, 0x3e0293ee, v62
    v_and_b32 v63, 0xffff0000, v57
    v_mul_f32 v63, 0x3e0293ee, v63
    v_cvt_pk_bf16_f32 v61, v62, v63
    v_accvgpr_write_b32 a60, v61
    v_lshlrev_b32 v62, 16, v58
    v_mul_f32 v62, 0x3e0293ee, v62
    v_lshlrev_b32 v63, 16, v59
    v_mul_f32 v63, 0x3e0293ee, v63
    v_cvt_pk_bf16_f32 v60, v62, v63
    v_accvgpr_write_b32 a54, v60
    v_and_b32 v62, 0xffff0000, v58
    v_mul_f32 v62, 0x3e0293ee, v62
    v_and_b32 v63, 0xffff0000, v59
    v_mul_f32 v63, 0x3e0293ee, v63
    v_cvt_pk_bf16_f32 v61, v62, v63
    v_accvgpr_write_b32 a62, v61
    ds_read2st64_b32 v[44:45], v36 offset0:4 offset1:5
    ds_read2st64_b32 v[46:47], v36 offset0:12 offset1:13
    ds_read2st64_b32 v[48:49], v37 offset0:4 offset1:5
    ds_read2st64_b32 v[50:51], v37 offset0:12 offset1:13
    ds_read2st64_b32 v[52:53], v38 offset0:4 offset1:5
    ds_read2st64_b32 v[54:55], v38 offset0:12 offset1:13
    ds_read2st64_b32 v[56:57], v39 offset0:4 offset1:5
    ds_read2st64_b32 v[58:59], v39 offset0:12 offset1:13
    s_waitcnt lgkmcnt(6)
    v_lshlrev_b32 v62, 16, v44
    v_mul_f32 v62, 0x3e0293ee, v62
    v_lshlrev_b32 v63, 16, v45
    v_mul_f32 v63, 0x3e0293ee, v63
    v_cvt_pk_bf16_f32 v60, v62, v63
    v_accvgpr_write_b32 a68, v60
    v_and_b32 v62, 0xffff0000, v44
    v_mul_f32 v62, 0x3e0293ee, v62
    v_and_b32 v63, 0xffff0000, v45
    v_mul_f32 v63, 0x3e0293ee, v63
    v_cvt_pk_bf16_f32 v61, v62, v63
    v_accvgpr_write_b32 a76, v61
    v_lshlrev_b32 v62, 16, v46
    v_mul_f32 v62, 0x3e0293ee, v62
    v_lshlrev_b32 v63, 16, v47
    v_mul_f32 v63, 0x3e0293ee, v63
    v_cvt_pk_bf16_f32 v60, v62, v63
    v_accvgpr_write_b32 a70, v60
    v_and_b32 v62, 0xffff0000, v46
    v_mul_f32 v62, 0x3e0293ee, v62
    v_and_b32 v63, 0xffff0000, v47
    v_mul_f32 v63, 0x3e0293ee, v63
    v_cvt_pk_bf16_f32 v61, v62, v63
    v_accvgpr_write_b32 a78, v61
    s_waitcnt lgkmcnt(4)
    v_lshlrev_b32 v62, 16, v48
    v_mul_f32 v62, 0x3e0293ee, v62
    v_lshlrev_b32 v63, 16, v49
    v_mul_f32 v63, 0x3e0293ee, v63
    v_cvt_pk_bf16_f32 v60, v62, v63
    v_accvgpr_write_b32 a84, v60
    v_and_b32 v62, 0xffff0000, v48
    v_mul_f32 v62, 0x3e0293ee, v62
    v_and_b32 v63, 0xffff0000, v49
    v_mul_f32 v63, 0x3e0293ee, v63
    v_cvt_pk_bf16_f32 v61, v62, v63
    v_accvgpr_write_b32 a92, v61
    v_lshlrev_b32 v62, 16, v50
    v_mul_f32 v62, 0x3e0293ee, v62
    v_lshlrev_b32 v63, 16, v51
    v_mul_f32 v63, 0x3e0293ee, v63
    v_cvt_pk_bf16_f32 v60, v62, v63
    v_accvgpr_write_b32 a86, v60
    v_and_b32 v62, 0xffff0000, v50
    v_mul_f32 v62, 0x3e0293ee, v62
    v_and_b32 v63, 0xffff0000, v51
    v_mul_f32 v63, 0x3e0293ee, v63
    v_cvt_pk_bf16_f32 v61, v62, v63
    v_accvgpr_write_b32 a94, v61
    s_waitcnt lgkmcnt(2)
    v_lshlrev_b32 v62, 16, v52
    v_mul_f32 v62, 0x3e0293ee, v62
    v_lshlrev_b32 v63, 16, v53
    v_mul_f32 v63, 0x3e0293ee, v63
    v_cvt_pk_bf16_f32 v60, v62, v63
    v_accvgpr_write_b32 a100, v60
    v_and_b32 v62, 0xffff0000, v52
    v_mul_f32 v62, 0x3e0293ee, v62
    v_and_b32 v63, 0xffff0000, v53
    v_mul_f32 v63, 0x3e0293ee, v63
    v_cvt_pk_bf16_f32 v61, v62, v63
    v_accvgpr_write_b32 a108, v61
    v_lshlrev_b32 v62, 16, v54
    v_mul_f32 v62, 0x3e0293ee, v62
    v_lshlrev_b32 v63, 16, v55
    v_mul_f32 v63, 0x3e0293ee, v63
    v_cvt_pk_bf16_f32 v60, v62, v63
    v_accvgpr_write_b32 a102, v60
    v_and_b32 v62, 0xffff0000, v54
    v_mul_f32 v62, 0x3e0293ee, v62
    v_and_b32 v63, 0xffff0000, v55
    v_mul_f32 v63, 0x3e0293ee, v63
    v_cvt_pk_bf16_f32 v61, v62, v63
    v_accvgpr_write_b32 a110, v61
    s_waitcnt lgkmcnt(0)
    v_lshlrev_b32 v62, 16, v56
    v_mul_f32 v62, 0x3e0293ee, v62
    v_lshlrev_b32 v63, 16, v57
    v_mul_f32 v63, 0x3e0293ee, v63
    v_cvt_pk_bf16_f32 v60, v62, v63
    v_accvgpr_write_b32 a116, v60
    v_and_b32 v62, 0xffff0000, v56
    v_mul_f32 v62, 0x3e0293ee, v62
    v_and_b32 v63, 0xffff0000, v57
    v_mul_f32 v63, 0x3e0293ee, v63
    v_cvt_pk_bf16_f32 v61, v62, v63
    v_accvgpr_write_b32 a124, v61
    v_lshlrev_b32 v62, 16, v58
    v_mul_f32 v62, 0x3e0293ee, v62
    v_lshlrev_b32 v63, 16, v59
    v_mul_f32 v63, 0x3e0293ee, v63
    v_cvt_pk_bf16_f32 v60, v62, v63
    v_accvgpr_write_b32 a118, v60
    v_and_b32 v62, 0xffff0000, v58
    v_mul_f32 v62, 0x3e0293ee, v62
    v_and_b32 v63, 0xffff0000, v59
    v_mul_f32 v63, 0x3e0293ee, v63
    v_cvt_pk_bf16_f32 v61, v62, v63
    v_accvgpr_write_b32 a126, v61
    s_waitcnt vmcnt(16)
    s_barrier
    s_add_u32 m0, s77, 65536
    s_mov_b32 s14, 1048576
    buffer_load_dwordx4 v28, s[28:31], s14 offen lds
    s_add_u32 m0, s77, 66560
    s_mov_b32 s14, 1081344
    buffer_load_dwordx4 v28, s[28:31], s14 offen lds
    s_add_u32 m0, s77, 67584
    s_mov_b32 s14, 1114112
    buffer_load_dwordx4 v28, s[28:31], s14 offen lds
    s_add_u32 m0, s77, 68608
    s_mov_b32 s14, 1146880
    buffer_load_dwordx4 v28, s[28:31], s14 offen lds
    s_add_u32 m0, s77, 69632
    s_mov_b32 s14, 1179648
    buffer_load_dwordx4 v28, s[28:31], s14 offen lds
    s_add_u32 m0, s77, 70656
    s_mov_b32 s14, 1212416
    buffer_load_dwordx4 v28, s[28:31], s14 offen lds
    s_add_u32 m0, s77, 71680
    s_mov_b32 s14, 1245184
    buffer_load_dwordx4 v28, s[28:31], s14 offen lds
    s_add_u32 m0, s77, 72704
    s_mov_b32 s14, 1277952
    buffer_load_dwordx4 v28, s[28:31], s14 offen lds
    v_add_u32 v36, 98304, v32
    v_add_u32 v37, 98304, v33
    v_add_u32 v38, 98304, v34
    v_add_u32 v39, 98304, v35
    ds_read2st64_b32 v[44:45], v36 offset0:0 offset1:1
    ds_read2st64_b32 v[46:47], v36 offset0:8 offset1:9
    ds_read2st64_b32 v[48:49], v37 offset0:0 offset1:1
    ds_read2st64_b32 v[50:51], v37 offset0:8 offset1:9
    ds_read2st64_b32 v[52:53], v38 offset0:0 offset1:1
    ds_read2st64_b32 v[54:55], v38 offset0:8 offset1:9
    ds_read2st64_b32 v[56:57], v39 offset0:0 offset1:1
    ds_read2st64_b32 v[58:59], v39 offset0:8 offset1:9
    s_waitcnt lgkmcnt(6)
    v_lshlrev_b32 v62, 16, v44
    v_mul_f32 v62, 0x3e0293ee, v62
    v_lshlrev_b32 v63, 16, v45
    v_mul_f32 v63, 0x3e0293ee, v63
    v_cvt_pk_bf16_f32 v60, v62, v63
    v_accvgpr_write_b32 a5, v60
    v_and_b32 v62, 0xffff0000, v44
    v_mul_f32 v62, 0x3e0293ee, v62
    v_and_b32 v63, 0xffff0000, v45
    v_mul_f32 v63, 0x3e0293ee, v63
    v_cvt_pk_bf16_f32 v61, v62, v63
    v_accvgpr_write_b32 a13, v61
    v_lshlrev_b32 v62, 16, v46
    v_mul_f32 v62, 0x3e0293ee, v62
    v_lshlrev_b32 v63, 16, v47
    v_mul_f32 v63, 0x3e0293ee, v63
    v_cvt_pk_bf16_f32 v60, v62, v63
    v_accvgpr_write_b32 a7, v60
    v_and_b32 v62, 0xffff0000, v46
    v_mul_f32 v62, 0x3e0293ee, v62
    v_and_b32 v63, 0xffff0000, v47
    v_mul_f32 v63, 0x3e0293ee, v63
    v_cvt_pk_bf16_f32 v61, v62, v63
    v_accvgpr_write_b32 a15, v61
    s_waitcnt lgkmcnt(4)
    v_lshlrev_b32 v62, 16, v48
    v_mul_f32 v62, 0x3e0293ee, v62
    v_lshlrev_b32 v63, 16, v49
    v_mul_f32 v63, 0x3e0293ee, v63
    v_cvt_pk_bf16_f32 v60, v62, v63
    v_accvgpr_write_b32 a21, v60
    v_and_b32 v62, 0xffff0000, v48
    v_mul_f32 v62, 0x3e0293ee, v62
    v_and_b32 v63, 0xffff0000, v49
    v_mul_f32 v63, 0x3e0293ee, v63
    v_cvt_pk_bf16_f32 v61, v62, v63
    v_accvgpr_write_b32 a29, v61
    v_lshlrev_b32 v62, 16, v50
    v_mul_f32 v62, 0x3e0293ee, v62
    v_lshlrev_b32 v63, 16, v51
    v_mul_f32 v63, 0x3e0293ee, v63
    v_cvt_pk_bf16_f32 v60, v62, v63
    v_accvgpr_write_b32 a23, v60
    v_and_b32 v62, 0xffff0000, v50
    v_mul_f32 v62, 0x3e0293ee, v62
    v_and_b32 v63, 0xffff0000, v51
    v_mul_f32 v63, 0x3e0293ee, v63
    v_cvt_pk_bf16_f32 v61, v62, v63
    v_accvgpr_write_b32 a31, v61
    s_waitcnt lgkmcnt(2)
    v_lshlrev_b32 v62, 16, v52
    v_mul_f32 v62, 0x3e0293ee, v62
    v_lshlrev_b32 v63, 16, v53
    v_mul_f32 v63, 0x3e0293ee, v63
    v_cvt_pk_bf16_f32 v60, v62, v63
    v_accvgpr_write_b32 a37, v60
    v_and_b32 v62, 0xffff0000, v52
    v_mul_f32 v62, 0x3e0293ee, v62
    v_and_b32 v63, 0xffff0000, v53
    v_mul_f32 v63, 0x3e0293ee, v63
    v_cvt_pk_bf16_f32 v61, v62, v63
    v_accvgpr_write_b32 a45, v61
    v_lshlrev_b32 v62, 16, v54
    v_mul_f32 v62, 0x3e0293ee, v62
    v_lshlrev_b32 v63, 16, v55
    v_mul_f32 v63, 0x3e0293ee, v63
    v_cvt_pk_bf16_f32 v60, v62, v63
    v_accvgpr_write_b32 a39, v60
    v_and_b32 v62, 0xffff0000, v54
    v_mul_f32 v62, 0x3e0293ee, v62
    v_and_b32 v63, 0xffff0000, v55
    v_mul_f32 v63, 0x3e0293ee, v63
    v_cvt_pk_bf16_f32 v61, v62, v63
    v_accvgpr_write_b32 a47, v61
    s_waitcnt lgkmcnt(0)
    v_lshlrev_b32 v62, 16, v56
    v_mul_f32 v62, 0x3e0293ee, v62
    v_lshlrev_b32 v63, 16, v57
    v_mul_f32 v63, 0x3e0293ee, v63
    v_cvt_pk_bf16_f32 v60, v62, v63
    v_accvgpr_write_b32 a53, v60
    v_and_b32 v62, 0xffff0000, v56
    v_mul_f32 v62, 0x3e0293ee, v62
    v_and_b32 v63, 0xffff0000, v57
    v_mul_f32 v63, 0x3e0293ee, v63
    v_cvt_pk_bf16_f32 v61, v62, v63
    v_accvgpr_write_b32 a61, v61
    v_lshlrev_b32 v62, 16, v58
    v_mul_f32 v62, 0x3e0293ee, v62
    v_lshlrev_b32 v63, 16, v59
    v_mul_f32 v63, 0x3e0293ee, v63
    v_cvt_pk_bf16_f32 v60, v62, v63
    v_accvgpr_write_b32 a55, v60
    v_and_b32 v62, 0xffff0000, v58
    v_mul_f32 v62, 0x3e0293ee, v62
    v_and_b32 v63, 0xffff0000, v59
    v_mul_f32 v63, 0x3e0293ee, v63
    v_cvt_pk_bf16_f32 v61, v62, v63
    v_accvgpr_write_b32 a63, v61
    ds_read2st64_b32 v[44:45], v36 offset0:4 offset1:5
    ds_read2st64_b32 v[46:47], v36 offset0:12 offset1:13
    ds_read2st64_b32 v[48:49], v37 offset0:4 offset1:5
    ds_read2st64_b32 v[50:51], v37 offset0:12 offset1:13
    ds_read2st64_b32 v[52:53], v38 offset0:4 offset1:5
    ds_read2st64_b32 v[54:55], v38 offset0:12 offset1:13
    ds_read2st64_b32 v[56:57], v39 offset0:4 offset1:5
    ds_read2st64_b32 v[58:59], v39 offset0:12 offset1:13
    s_waitcnt lgkmcnt(6)
    v_lshlrev_b32 v62, 16, v44
    v_mul_f32 v62, 0x3e0293ee, v62
    v_lshlrev_b32 v63, 16, v45
    v_mul_f32 v63, 0x3e0293ee, v63
    v_cvt_pk_bf16_f32 v60, v62, v63
    v_accvgpr_write_b32 a69, v60
    v_and_b32 v62, 0xffff0000, v44
    v_mul_f32 v62, 0x3e0293ee, v62
    v_and_b32 v63, 0xffff0000, v45
    v_mul_f32 v63, 0x3e0293ee, v63
    v_cvt_pk_bf16_f32 v61, v62, v63
    v_accvgpr_write_b32 a77, v61
    v_lshlrev_b32 v62, 16, v46
    v_mul_f32 v62, 0x3e0293ee, v62
    v_lshlrev_b32 v63, 16, v47
    v_mul_f32 v63, 0x3e0293ee, v63
    v_cvt_pk_bf16_f32 v60, v62, v63
    v_accvgpr_write_b32 a71, v60
    v_and_b32 v62, 0xffff0000, v46
    v_mul_f32 v62, 0x3e0293ee, v62
    v_and_b32 v63, 0xffff0000, v47
    v_mul_f32 v63, 0x3e0293ee, v63
    v_cvt_pk_bf16_f32 v61, v62, v63
    v_accvgpr_write_b32 a79, v61
    s_waitcnt lgkmcnt(4)
    v_lshlrev_b32 v62, 16, v48
    v_mul_f32 v62, 0x3e0293ee, v62
    v_lshlrev_b32 v63, 16, v49
    v_mul_f32 v63, 0x3e0293ee, v63
    v_cvt_pk_bf16_f32 v60, v62, v63
    v_accvgpr_write_b32 a85, v60
    v_and_b32 v62, 0xffff0000, v48
    v_mul_f32 v62, 0x3e0293ee, v62
    v_and_b32 v63, 0xffff0000, v49
    v_mul_f32 v63, 0x3e0293ee, v63
    v_cvt_pk_bf16_f32 v61, v62, v63
    v_accvgpr_write_b32 a93, v61
    v_lshlrev_b32 v62, 16, v50
    v_mul_f32 v62, 0x3e0293ee, v62
    v_lshlrev_b32 v63, 16, v51
    v_mul_f32 v63, 0x3e0293ee, v63
    v_cvt_pk_bf16_f32 v60, v62, v63
    v_accvgpr_write_b32 a87, v60
    v_and_b32 v62, 0xffff0000, v50
    v_mul_f32 v62, 0x3e0293ee, v62
    v_and_b32 v63, 0xffff0000, v51
    v_mul_f32 v63, 0x3e0293ee, v63
    v_cvt_pk_bf16_f32 v61, v62, v63
    v_accvgpr_write_b32 a95, v61
    s_waitcnt lgkmcnt(2)
    v_lshlrev_b32 v62, 16, v52
    v_mul_f32 v62, 0x3e0293ee, v62
    v_lshlrev_b32 v63, 16, v53
    v_mul_f32 v63, 0x3e0293ee, v63
    v_cvt_pk_bf16_f32 v60, v62, v63
    v_accvgpr_write_b32 a101, v60
    v_and_b32 v62, 0xffff0000, v52
    v_mul_f32 v62, 0x3e0293ee, v62
    v_and_b32 v63, 0xffff0000, v53
    v_mul_f32 v63, 0x3e0293ee, v63
    v_cvt_pk_bf16_f32 v61, v62, v63
    v_accvgpr_write_b32 a109, v61
    v_lshlrev_b32 v62, 16, v54
    v_mul_f32 v62, 0x3e0293ee, v62
    v_lshlrev_b32 v63, 16, v55
    v_mul_f32 v63, 0x3e0293ee, v63
    v_cvt_pk_bf16_f32 v60, v62, v63
    v_accvgpr_write_b32 a103, v60
    v_and_b32 v62, 0xffff0000, v54
    v_mul_f32 v62, 0x3e0293ee, v62
    v_and_b32 v63, 0xffff0000, v55
    v_mul_f32 v63, 0x3e0293ee, v63
    v_cvt_pk_bf16_f32 v61, v62, v63
    v_accvgpr_write_b32 a111, v61
    s_waitcnt lgkmcnt(0)
    v_lshlrev_b32 v62, 16, v56
    v_mul_f32 v62, 0x3e0293ee, v62
    v_lshlrev_b32 v63, 16, v57
    v_mul_f32 v63, 0x3e0293ee, v63
    v_cvt_pk_bf16_f32 v60, v62, v63
    v_accvgpr_write_b32 a117, v60
    v_and_b32 v62, 0xffff0000, v56
    v_mul_f32 v62, 0x3e0293ee, v62
    v_and_b32 v63, 0xffff0000, v57
    v_mul_f32 v63, 0x3e0293ee, v63
    v_cvt_pk_bf16_f32 v61, v62, v63
    v_accvgpr_write_b32 a125, v61
    v_lshlrev_b32 v62, 16, v58
    v_mul_f32 v62, 0x3e0293ee, v62
    v_lshlrev_b32 v63, 16, v59
    v_mul_f32 v63, 0x3e0293ee, v63
    v_cvt_pk_bf16_f32 v60, v62, v63
    v_accvgpr_write_b32 a119, v60
    v_and_b32 v62, 0xffff0000, v58
    v_mul_f32 v62, 0x3e0293ee, v62
    v_and_b32 v63, 0xffff0000, v59
    v_mul_f32 v63, 0x3e0293ee, v63
    v_cvt_pk_bf16_f32 v61, v62, v63
    v_accvgpr_write_b32 a127, v61
    s_waitcnt vmcnt(16)
    s_barrier
    s_add_u32 m0, s77, 98304
    s_mov_b32 s14, 1310720
    buffer_load_dwordx4 v28, s[28:31], s14 offen lds
    s_add_u32 m0, s77, 99328
    s_mov_b32 s14, 1343488
    buffer_load_dwordx4 v28, s[28:31], s14 offen lds
    s_add_u32 m0, s77, 100352
    s_mov_b32 s14, 1376256
    buffer_load_dwordx4 v28, s[28:31], s14 offen lds
    s_add_u32 m0, s77, 101376
    s_mov_b32 s14, 1409024
    buffer_load_dwordx4 v28, s[28:31], s14 offen lds
    s_add_u32 m0, s77, 102400
    s_mov_b32 s14, 1441792
    buffer_load_dwordx4 v28, s[28:31], s14 offen lds
    s_add_u32 m0, s77, 103424
    s_mov_b32 s14, 1474560
    buffer_load_dwordx4 v28, s[28:31], s14 offen lds
    s_add_u32 m0, s77, 104448
    s_mov_b32 s14, 1507328
    buffer_load_dwordx4 v28, s[28:31], s14 offen lds
    s_add_u32 m0, s77, 105472
    s_mov_b32 s14, 1540096
    buffer_load_dwordx4 v28, s[28:31], s14 offen lds
    v_add_u32 v36, 0, v32
    v_add_u32 v37, 0, v33
    v_add_u32 v38, 0, v34
    v_add_u32 v39, 0, v35
    ds_read2st64_b32 v[44:45], v36 offset0:0 offset1:1
    ds_read2st64_b32 v[46:47], v36 offset0:8 offset1:9
    ds_read2st64_b32 v[48:49], v37 offset0:0 offset1:1
    ds_read2st64_b32 v[50:51], v37 offset0:8 offset1:9
    ds_read2st64_b32 v[52:53], v38 offset0:0 offset1:1
    ds_read2st64_b32 v[54:55], v38 offset0:8 offset1:9
    ds_read2st64_b32 v[56:57], v39 offset0:0 offset1:1
    ds_read2st64_b32 v[58:59], v39 offset0:8 offset1:9
    s_waitcnt lgkmcnt(6)
    v_perm_b32 v60, v45, v44, s12
    v_accvgpr_write_b32 a128, v60
    v_perm_b32 v61, v45, v44, s13
    v_accvgpr_write_b32 a136, v61
    v_perm_b32 v60, v47, v46, s12
    v_accvgpr_write_b32 a130, v60
    v_perm_b32 v61, v47, v46, s13
    v_accvgpr_write_b32 a138, v61
    s_waitcnt lgkmcnt(4)
    v_perm_b32 v60, v49, v48, s12
    v_accvgpr_write_b32 a144, v60
    v_perm_b32 v61, v49, v48, s13
    v_accvgpr_write_b32 a152, v61
    v_perm_b32 v60, v51, v50, s12
    v_accvgpr_write_b32 a146, v60
    v_perm_b32 v61, v51, v50, s13
    v_accvgpr_write_b32 a154, v61
    s_waitcnt lgkmcnt(2)
    v_perm_b32 v60, v53, v52, s12
    v_accvgpr_write_b32 a160, v60
    v_perm_b32 v61, v53, v52, s13
    v_accvgpr_write_b32 a168, v61
    v_perm_b32 v60, v55, v54, s12
    v_accvgpr_write_b32 a162, v60
    v_perm_b32 v61, v55, v54, s13
    v_accvgpr_write_b32 a170, v61
    s_waitcnt lgkmcnt(0)
    v_perm_b32 v60, v57, v56, s12
    v_accvgpr_write_b32 a176, v60
    v_perm_b32 v61, v57, v56, s13
    v_accvgpr_write_b32 a184, v61
    v_perm_b32 v60, v59, v58, s12
    v_accvgpr_write_b32 a178, v60
    v_perm_b32 v61, v59, v58, s13
    v_accvgpr_write_b32 a186, v61
    ds_read2st64_b32 v[44:45], v36 offset0:4 offset1:5
    ds_read2st64_b32 v[46:47], v36 offset0:12 offset1:13
    ds_read2st64_b32 v[48:49], v37 offset0:4 offset1:5
    ds_read2st64_b32 v[50:51], v37 offset0:12 offset1:13
    ds_read2st64_b32 v[52:53], v38 offset0:4 offset1:5
    ds_read2st64_b32 v[54:55], v38 offset0:12 offset1:13
    ds_read2st64_b32 v[56:57], v39 offset0:4 offset1:5
    ds_read2st64_b32 v[58:59], v39 offset0:12 offset1:13
    s_waitcnt lgkmcnt(6)
    v_perm_b32 v60, v45, v44, s12
    v_accvgpr_write_b32 a192, v60
    v_perm_b32 v61, v45, v44, s13
    v_accvgpr_write_b32 a200, v61
    v_perm_b32 v60, v47, v46, s12
    v_accvgpr_write_b32 a194, v60
    v_perm_b32 v61, v47, v46, s13
    v_accvgpr_write_b32 a202, v61
    s_waitcnt lgkmcnt(4)
    v_perm_b32 v60, v49, v48, s12
    v_accvgpr_write_b32 a208, v60
    v_perm_b32 v61, v49, v48, s13
    v_accvgpr_write_b32 a216, v61
    v_perm_b32 v60, v51, v50, s12
    v_accvgpr_write_b32 a210, v60
    v_perm_b32 v61, v51, v50, s13
    v_accvgpr_write_b32 a218, v61
    s_waitcnt lgkmcnt(2)
    v_perm_b32 v60, v53, v52, s12
    v_accvgpr_write_b32 a224, v60
    v_perm_b32 v61, v53, v52, s13
    v_accvgpr_write_b32 a232, v61
    v_perm_b32 v60, v55, v54, s12
    v_accvgpr_write_b32 a226, v60
    v_perm_b32 v61, v55, v54, s13
    v_accvgpr_write_b32 a234, v61
    s_waitcnt lgkmcnt(0)
    v_perm_b32 v60, v57, v56, s12
    v_accvgpr_write_b32 a240, v60
    v_perm_b32 v61, v57, v56, s13
    v_accvgpr_write_b32 a248, v61
    v_perm_b32 v60, v59, v58, s12
    v_accvgpr_write_b32 a242, v60
    v_perm_b32 v61, v59, v58, s13
    v_accvgpr_write_b32 a250, v61
    s_waitcnt vmcnt(16)
    s_barrier
    s_add_u32 m0, s77, 0
    s_mov_b32 s14, 0
    buffer_load_dwordx4 v28, s[32:35], s14 offen lds
    s_add_u32 m0, s77, 1024
    s_mov_b32 s14, 32768
    buffer_load_dwordx4 v28, s[32:35], s14 offen lds
    s_add_u32 m0, s77, 2048
    s_mov_b32 s14, 65536
    buffer_load_dwordx4 v28, s[32:35], s14 offen lds
    s_add_u32 m0, s77, 3072
    s_mov_b32 s14, 98304
    buffer_load_dwordx4 v28, s[32:35], s14 offen lds
    s_add_u32 m0, s77, 4096
    s_mov_b32 s14, 131072
    buffer_load_dwordx4 v28, s[32:35], s14 offen lds
    s_add_u32 m0, s77, 5120
    s_mov_b32 s14, 163840
    buffer_load_dwordx4 v28, s[32:35], s14 offen lds
    s_add_u32 m0, s77, 6144
    s_mov_b32 s14, 196608
    buffer_load_dwordx4 v28, s[32:35], s14 offen lds
    s_add_u32 m0, s77, 7168
    s_mov_b32 s14, 229376
    buffer_load_dwordx4 v28, s[32:35], s14 offen lds
    v_add_u32 v36, 32768, v32
    v_add_u32 v37, 32768, v33
    v_add_u32 v38, 32768, v34
    v_add_u32 v39, 32768, v35
    ds_read2st64_b32 v[44:45], v36 offset0:0 offset1:1
    ds_read2st64_b32 v[46:47], v36 offset0:8 offset1:9
    ds_read2st64_b32 v[48:49], v37 offset0:0 offset1:1
    ds_read2st64_b32 v[50:51], v37 offset0:8 offset1:9
    ds_read2st64_b32 v[52:53], v38 offset0:0 offset1:1
    ds_read2st64_b32 v[54:55], v38 offset0:8 offset1:9
    ds_read2st64_b32 v[56:57], v39 offset0:0 offset1:1
    ds_read2st64_b32 v[58:59], v39 offset0:8 offset1:9
    s_waitcnt lgkmcnt(6)
    v_perm_b32 v60, v45, v44, s12
    v_accvgpr_write_b32 a129, v60
    v_perm_b32 v61, v45, v44, s13
    v_accvgpr_write_b32 a137, v61
    v_perm_b32 v60, v47, v46, s12
    v_accvgpr_write_b32 a131, v60
    v_perm_b32 v61, v47, v46, s13
    v_accvgpr_write_b32 a139, v61
    s_waitcnt lgkmcnt(4)
    v_perm_b32 v60, v49, v48, s12
    v_accvgpr_write_b32 a145, v60
    v_perm_b32 v61, v49, v48, s13
    v_accvgpr_write_b32 a153, v61
    v_perm_b32 v60, v51, v50, s12
    v_accvgpr_write_b32 a147, v60
    v_perm_b32 v61, v51, v50, s13
    v_accvgpr_write_b32 a155, v61
    s_waitcnt lgkmcnt(2)
    v_perm_b32 v60, v53, v52, s12
    v_accvgpr_write_b32 a161, v60
    v_perm_b32 v61, v53, v52, s13
    v_accvgpr_write_b32 a169, v61
    v_perm_b32 v60, v55, v54, s12
    v_accvgpr_write_b32 a163, v60
    v_perm_b32 v61, v55, v54, s13
    v_accvgpr_write_b32 a171, v61
    s_waitcnt lgkmcnt(0)
    v_perm_b32 v60, v57, v56, s12
    v_accvgpr_write_b32 a177, v60
    v_perm_b32 v61, v57, v56, s13
    v_accvgpr_write_b32 a185, v61
    v_perm_b32 v60, v59, v58, s12
    v_accvgpr_write_b32 a179, v60
    v_perm_b32 v61, v59, v58, s13
    v_accvgpr_write_b32 a187, v61
    ds_read2st64_b32 v[44:45], v36 offset0:4 offset1:5
    ds_read2st64_b32 v[46:47], v36 offset0:12 offset1:13
    ds_read2st64_b32 v[48:49], v37 offset0:4 offset1:5
    ds_read2st64_b32 v[50:51], v37 offset0:12 offset1:13
    ds_read2st64_b32 v[52:53], v38 offset0:4 offset1:5
    ds_read2st64_b32 v[54:55], v38 offset0:12 offset1:13
    ds_read2st64_b32 v[56:57], v39 offset0:4 offset1:5
    ds_read2st64_b32 v[58:59], v39 offset0:12 offset1:13
    s_waitcnt lgkmcnt(6)
    v_perm_b32 v60, v45, v44, s12
    v_accvgpr_write_b32 a193, v60
    v_perm_b32 v61, v45, v44, s13
    v_accvgpr_write_b32 a201, v61
    v_perm_b32 v60, v47, v46, s12
    v_accvgpr_write_b32 a195, v60
    v_perm_b32 v61, v47, v46, s13
    v_accvgpr_write_b32 a203, v61
    s_waitcnt lgkmcnt(4)
    v_perm_b32 v60, v49, v48, s12
    v_accvgpr_write_b32 a209, v60
    v_perm_b32 v61, v49, v48, s13
    v_accvgpr_write_b32 a217, v61
    v_perm_b32 v60, v51, v50, s12
    v_accvgpr_write_b32 a211, v60
    v_perm_b32 v61, v51, v50, s13
    v_accvgpr_write_b32 a219, v61
    s_waitcnt lgkmcnt(2)
    v_perm_b32 v60, v53, v52, s12
    v_accvgpr_write_b32 a225, v60
    v_perm_b32 v61, v53, v52, s13
    v_accvgpr_write_b32 a233, v61
    v_perm_b32 v60, v55, v54, s12
    v_accvgpr_write_b32 a227, v60
    v_perm_b32 v61, v55, v54, s13
    v_accvgpr_write_b32 a235, v61
    s_waitcnt lgkmcnt(0)
    v_perm_b32 v60, v57, v56, s12
    v_accvgpr_write_b32 a241, v60
    v_perm_b32 v61, v57, v56, s13
    v_accvgpr_write_b32 a249, v61
    v_perm_b32 v60, v59, v58, s12
    v_accvgpr_write_b32 a243, v60
    v_perm_b32 v61, v59, v58, s13
    v_accvgpr_write_b32 a251, v61
    s_waitcnt vmcnt(16)
    s_barrier
    s_add_u32 m0, s77, 32768
    s_mov_b32 s14, 262144
    buffer_load_dwordx4 v28, s[32:35], s14 offen lds
    s_add_u32 m0, s77, 33792
    s_mov_b32 s14, 294912
    buffer_load_dwordx4 v28, s[32:35], s14 offen lds
    s_add_u32 m0, s77, 34816
    s_mov_b32 s14, 327680
    buffer_load_dwordx4 v28, s[32:35], s14 offen lds
    s_add_u32 m0, s77, 35840
    s_mov_b32 s14, 360448
    buffer_load_dwordx4 v28, s[32:35], s14 offen lds
    s_add_u32 m0, s77, 36864
    s_mov_b32 s14, 393216
    buffer_load_dwordx4 v28, s[32:35], s14 offen lds
    s_add_u32 m0, s77, 37888
    s_mov_b32 s14, 425984
    buffer_load_dwordx4 v28, s[32:35], s14 offen lds
    s_add_u32 m0, s77, 38912
    s_mov_b32 s14, 458752
    buffer_load_dwordx4 v28, s[32:35], s14 offen lds
    s_add_u32 m0, s77, 39936
    s_mov_b32 s14, 491520
    buffer_load_dwordx4 v28, s[32:35], s14 offen lds
    v_add_u32 v36, 65536, v32
    v_add_u32 v37, 65536, v33
    v_add_u32 v38, 65536, v34
    v_add_u32 v39, 65536, v35
    ds_read2st64_b32 v[44:45], v36 offset0:0 offset1:1
    ds_read2st64_b32 v[46:47], v36 offset0:8 offset1:9
    ds_read2st64_b32 v[48:49], v37 offset0:0 offset1:1
    ds_read2st64_b32 v[50:51], v37 offset0:8 offset1:9
    ds_read2st64_b32 v[52:53], v38 offset0:0 offset1:1
    ds_read2st64_b32 v[54:55], v38 offset0:8 offset1:9
    ds_read2st64_b32 v[56:57], v39 offset0:0 offset1:1
    ds_read2st64_b32 v[58:59], v39 offset0:8 offset1:9
    s_waitcnt lgkmcnt(6)
    v_perm_b32 v60, v45, v44, s12
    v_accvgpr_write_b32 a132, v60
    v_perm_b32 v61, v45, v44, s13
    v_accvgpr_write_b32 a140, v61
    v_perm_b32 v60, v47, v46, s12
    v_accvgpr_write_b32 a134, v60
    v_perm_b32 v61, v47, v46, s13
    v_accvgpr_write_b32 a142, v61
    s_waitcnt lgkmcnt(4)
    v_perm_b32 v60, v49, v48, s12
    v_accvgpr_write_b32 a148, v60
    v_perm_b32 v61, v49, v48, s13
    v_accvgpr_write_b32 a156, v61
    v_perm_b32 v60, v51, v50, s12
    v_accvgpr_write_b32 a150, v60
    v_perm_b32 v61, v51, v50, s13
    v_accvgpr_write_b32 a158, v61
    s_waitcnt lgkmcnt(2)
    v_perm_b32 v60, v53, v52, s12
    v_accvgpr_write_b32 a164, v60
    v_perm_b32 v61, v53, v52, s13
    v_accvgpr_write_b32 a172, v61
    v_perm_b32 v60, v55, v54, s12
    v_accvgpr_write_b32 a166, v60
    v_perm_b32 v61, v55, v54, s13
    v_accvgpr_write_b32 a174, v61
    s_waitcnt lgkmcnt(0)
    v_perm_b32 v60, v57, v56, s12
    v_accvgpr_write_b32 a180, v60
    v_perm_b32 v61, v57, v56, s13
    v_accvgpr_write_b32 a188, v61
    v_perm_b32 v60, v59, v58, s12
    v_accvgpr_write_b32 a182, v60
    v_perm_b32 v61, v59, v58, s13
    v_accvgpr_write_b32 a190, v61
    ds_read2st64_b32 v[44:45], v36 offset0:4 offset1:5
    ds_read2st64_b32 v[46:47], v36 offset0:12 offset1:13
    ds_read2st64_b32 v[48:49], v37 offset0:4 offset1:5
    ds_read2st64_b32 v[50:51], v37 offset0:12 offset1:13
    ds_read2st64_b32 v[52:53], v38 offset0:4 offset1:5
    ds_read2st64_b32 v[54:55], v38 offset0:12 offset1:13
    ds_read2st64_b32 v[56:57], v39 offset0:4 offset1:5
    ds_read2st64_b32 v[58:59], v39 offset0:12 offset1:13
    s_waitcnt lgkmcnt(6)
    v_perm_b32 v60, v45, v44, s12
    v_accvgpr_write_b32 a196, v60
    v_perm_b32 v61, v45, v44, s13
    v_accvgpr_write_b32 a204, v61
    v_perm_b32 v60, v47, v46, s12
    v_accvgpr_write_b32 a198, v60
    v_perm_b32 v61, v47, v46, s13
    v_accvgpr_write_b32 a206, v61
    s_waitcnt lgkmcnt(4)
    v_perm_b32 v60, v49, v48, s12
    v_accvgpr_write_b32 a212, v60
    v_perm_b32 v61, v49, v48, s13
    v_accvgpr_write_b32 a220, v61
    v_perm_b32 v60, v51, v50, s12
    v_accvgpr_write_b32 a214, v60
    v_perm_b32 v61, v51, v50, s13
    v_accvgpr_write_b32 a222, v61
    s_waitcnt lgkmcnt(2)
    v_perm_b32 v60, v53, v52, s12
    v_accvgpr_write_b32 a228, v60
    v_perm_b32 v61, v53, v52, s13
    v_accvgpr_write_b32 a236, v61
    v_perm_b32 v60, v55, v54, s12
    v_accvgpr_write_b32 a230, v60
    v_perm_b32 v61, v55, v54, s13
    v_accvgpr_write_b32 a238, v61
    s_waitcnt lgkmcnt(0)
    v_perm_b32 v60, v57, v56, s12
    v_accvgpr_write_b32 a244, v60
    v_perm_b32 v61, v57, v56, s13
    v_accvgpr_write_b32 a252, v61
    v_perm_b32 v60, v59, v58, s12
    v_accvgpr_write_b32 a246, v60
    v_perm_b32 v61, v59, v58, s13
    v_accvgpr_write_b32 a254, v61
    s_waitcnt vmcnt(16)
    s_barrier
    s_add_u32 m0, s77, 65536
    s_mov_b32 s14, 1048576
    buffer_load_dwordx4 v28, s[32:35], s14 offen lds
    s_add_u32 m0, s77, 66560
    s_mov_b32 s14, 1081344
    buffer_load_dwordx4 v28, s[32:35], s14 offen lds
    s_add_u32 m0, s77, 67584
    s_mov_b32 s14, 1114112
    buffer_load_dwordx4 v28, s[32:35], s14 offen lds
    s_add_u32 m0, s77, 68608
    s_mov_b32 s14, 1146880
    buffer_load_dwordx4 v28, s[32:35], s14 offen lds
    s_add_u32 m0, s77, 69632
    s_mov_b32 s14, 1179648
    buffer_load_dwordx4 v28, s[32:35], s14 offen lds
    s_add_u32 m0, s77, 70656
    s_mov_b32 s14, 1212416
    buffer_load_dwordx4 v28, s[32:35], s14 offen lds
    s_add_u32 m0, s77, 71680
    s_mov_b32 s14, 1245184
    buffer_load_dwordx4 v28, s[32:35], s14 offen lds
    s_add_u32 m0, s77, 72704
    s_mov_b32 s14, 1277952
    buffer_load_dwordx4 v28, s[32:35], s14 offen lds
    v_add_u32 v36, 98304, v32
    v_add_u32 v37, 98304, v33
    v_add_u32 v38, 98304, v34
    v_add_u32 v39, 98304, v35
    ds_read2st64_b32 v[44:45], v36 offset0:0 offset1:1
    ds_read2st64_b32 v[46:47], v36 offset0:8 offset1:9
    ds_read2st64_b32 v[48:49], v37 offset0:0 offset1:1
    ds_read2st64_b32 v[50:51], v37 offset0:8 offset1:9
    ds_read2st64_b32 v[52:53], v38 offset0:0 offset1:1
    ds_read2st64_b32 v[54:55], v38 offset0:8 offset1:9
    ds_read2st64_b32 v[56:57], v39 offset0:0 offset1:1
    ds_read2st64_b32 v[58:59], v39 offset0:8 offset1:9
    s_waitcnt lgkmcnt(6)
    v_perm_b32 v60, v45, v44, s12
    v_accvgpr_write_b32 a133, v60
    v_perm_b32 v61, v45, v44, s13
    v_accvgpr_write_b32 a141, v61
    v_perm_b32 v60, v47, v46, s12
    v_accvgpr_write_b32 a135, v60
    v_perm_b32 v61, v47, v46, s13
    v_accvgpr_write_b32 a143, v61
    s_waitcnt lgkmcnt(4)
    v_perm_b32 v60, v49, v48, s12
    v_accvgpr_write_b32 a149, v60
    v_perm_b32 v61, v49, v48, s13
    v_accvgpr_write_b32 a157, v61
    v_perm_b32 v60, v51, v50, s12
    v_accvgpr_write_b32 a151, v60
    v_perm_b32 v61, v51, v50, s13
    v_accvgpr_write_b32 a159, v61
    s_waitcnt lgkmcnt(2)
    v_perm_b32 v60, v53, v52, s12
    v_accvgpr_write_b32 a165, v60
    v_perm_b32 v61, v53, v52, s13
    v_accvgpr_write_b32 a173, v61
    v_perm_b32 v60, v55, v54, s12
    v_accvgpr_write_b32 a167, v60
    v_perm_b32 v61, v55, v54, s13
    v_accvgpr_write_b32 a175, v61
    s_waitcnt lgkmcnt(0)
    v_perm_b32 v60, v57, v56, s12
    v_accvgpr_write_b32 a181, v60
    v_perm_b32 v61, v57, v56, s13
    v_accvgpr_write_b32 a189, v61
    v_perm_b32 v60, v59, v58, s12
    v_accvgpr_write_b32 a183, v60
    v_perm_b32 v61, v59, v58, s13
    v_accvgpr_write_b32 a191, v61
    ds_read2st64_b32 v[44:45], v36 offset0:4 offset1:5
    ds_read2st64_b32 v[46:47], v36 offset0:12 offset1:13
    ds_read2st64_b32 v[48:49], v37 offset0:4 offset1:5
    ds_read2st64_b32 v[50:51], v37 offset0:12 offset1:13
    ds_read2st64_b32 v[52:53], v38 offset0:4 offset1:5
    ds_read2st64_b32 v[54:55], v38 offset0:12 offset1:13
    ds_read2st64_b32 v[56:57], v39 offset0:4 offset1:5
    ds_read2st64_b32 v[58:59], v39 offset0:12 offset1:13
    s_waitcnt lgkmcnt(6)
    v_perm_b32 v60, v45, v44, s12
    v_accvgpr_write_b32 a197, v60
    v_perm_b32 v61, v45, v44, s13
    v_accvgpr_write_b32 a205, v61
    v_perm_b32 v60, v47, v46, s12
    v_accvgpr_write_b32 a199, v60
    v_perm_b32 v61, v47, v46, s13
    v_accvgpr_write_b32 a207, v61
    s_waitcnt lgkmcnt(4)
    v_perm_b32 v60, v49, v48, s12
    v_accvgpr_write_b32 a213, v60
    v_perm_b32 v61, v49, v48, s13
    v_accvgpr_write_b32 a221, v61
    v_perm_b32 v60, v51, v50, s12
    v_accvgpr_write_b32 a215, v60
    v_perm_b32 v61, v51, v50, s13
    v_accvgpr_write_b32 a223, v61
    s_waitcnt lgkmcnt(2)
    v_perm_b32 v60, v53, v52, s12
    v_accvgpr_write_b32 a229, v60
    v_perm_b32 v61, v53, v52, s13
    v_accvgpr_write_b32 a237, v61
    v_perm_b32 v60, v55, v54, s12
    v_accvgpr_write_b32 a231, v60
    v_perm_b32 v61, v55, v54, s13
    v_accvgpr_write_b32 a239, v61
    s_waitcnt lgkmcnt(0)
    v_perm_b32 v60, v57, v56, s12
    v_accvgpr_write_b32 a245, v60
    v_perm_b32 v61, v57, v56, s13
    v_accvgpr_write_b32 a253, v61
    v_perm_b32 v60, v59, v58, s12
    v_accvgpr_write_b32 a247, v60
    v_perm_b32 v61, v59, v58, s13
    v_accvgpr_write_b32 a255, v61
    s_waitcnt vmcnt(16)
    s_barrier
    s_add_u32 m0, s77, 98304
    s_mov_b32 s14, 1310720
    buffer_load_dwordx4 v28, s[32:35], s14 offen lds
    s_add_u32 m0, s77, 99328
    s_mov_b32 s14, 1343488
    buffer_load_dwordx4 v28, s[32:35], s14 offen lds
    s_add_u32 m0, s77, 100352
    s_mov_b32 s14, 1376256
    buffer_load_dwordx4 v28, s[32:35], s14 offen lds
    s_add_u32 m0, s77, 101376
    s_mov_b32 s14, 1409024
    buffer_load_dwordx4 v28, s[32:35], s14 offen lds
    s_add_u32 m0, s77, 102400
    s_mov_b32 s14, 1441792
    buffer_load_dwordx4 v28, s[32:35], s14 offen lds
    s_add_u32 m0, s77, 103424
    s_mov_b32 s14, 1474560
    buffer_load_dwordx4 v28, s[32:35], s14 offen lds
    s_add_u32 m0, s77, 104448
    s_mov_b32 s14, 1507328
    buffer_load_dwordx4 v28, s[32:35], s14 offen lds
    s_add_u32 m0, s77, 105472
    s_mov_b32 s14, 1540096
    buffer_load_dwordx4 v28, s[32:35], s14 offen lds
    buffer_load_dword v30, v5, s[56:59], 0 offen sc1
    v_add_u32 v36, 0, v32
    v_add_u32 v37, 0, v33
    v_add_u32 v38, 0, v34
    v_add_u32 v39, 0, v35
    ds_read2st64_b32 v[44:45], v36 offset0:0 offset1:1
    ds_read2st64_b32 v[46:47], v36 offset0:8 offset1:9
    ds_read2st64_b32 v[48:49], v37 offset0:0 offset1:1
    ds_read2st64_b32 v[50:51], v37 offset0:8 offset1:9
    ds_read2st64_b32 v[52:53], v38 offset0:0 offset1:1
    ds_read2st64_b32 v[54:55], v38 offset0:8 offset1:9
    ds_read2st64_b32 v[56:57], v39 offset0:0 offset1:1
    ds_read2st64_b32 v[58:59], v39 offset0:8 offset1:9
    s_waitcnt lgkmcnt(6)
    v_perm_b32 v128, v45, v44, s12
    v_perm_b32 v136, v45, v44, s13
    v_perm_b32 v130, v47, v46, s12
    v_perm_b32 v138, v47, v46, s13
    s_waitcnt lgkmcnt(4)
    v_perm_b32 v144, v49, v48, s12
    v_perm_b32 v152, v49, v48, s13
    v_perm_b32 v146, v51, v50, s12
    v_perm_b32 v154, v51, v50, s13
    s_waitcnt lgkmcnt(2)
    v_perm_b32 v160, v53, v52, s12
    v_perm_b32 v168, v53, v52, s13
    v_perm_b32 v162, v55, v54, s12
    v_perm_b32 v170, v55, v54, s13
    s_waitcnt lgkmcnt(0)
    v_perm_b32 v176, v57, v56, s12
    v_perm_b32 v184, v57, v56, s13
    v_perm_b32 v178, v59, v58, s12
    v_perm_b32 v186, v59, v58, s13
    ds_read2st64_b32 v[44:45], v36 offset0:4 offset1:5
    ds_read2st64_b32 v[46:47], v36 offset0:12 offset1:13
    ds_read2st64_b32 v[48:49], v37 offset0:4 offset1:5
    ds_read2st64_b32 v[50:51], v37 offset0:12 offset1:13
    ds_read2st64_b32 v[52:53], v38 offset0:4 offset1:5
    ds_read2st64_b32 v[54:55], v38 offset0:12 offset1:13
    ds_read2st64_b32 v[56:57], v39 offset0:4 offset1:5
    ds_read2st64_b32 v[58:59], v39 offset0:12 offset1:13
    s_waitcnt lgkmcnt(6)
    v_perm_b32 v192, v45, v44, s12
    v_perm_b32 v200, v45, v44, s13
    v_perm_b32 v194, v47, v46, s12
    v_perm_b32 v202, v47, v46, s13
    s_waitcnt lgkmcnt(4)
    v_perm_b32 v208, v49, v48, s12
    v_perm_b32 v216, v49, v48, s13
    v_perm_b32 v210, v51, v50, s12
    v_perm_b32 v218, v51, v50, s13
    s_waitcnt lgkmcnt(2)
    v_perm_b32 v224, v53, v52, s12
    v_perm_b32 v232, v53, v52, s13
    v_perm_b32 v226, v55, v54, s12
    v_perm_b32 v234, v55, v54, s13
    s_waitcnt lgkmcnt(0)
    v_perm_b32 v240, v57, v56, s12
    v_perm_b32 v248, v57, v56, s13
    v_perm_b32 v242, v59, v58, s12
    v_perm_b32 v250, v59, v58, s13
    s_waitcnt vmcnt(17)
    s_barrier
    s_add_u32 s14, s72, 0
    buffer_load_dwordx4 v[64:67], v29, s[36:39], s14 offen
    s_add_u32 s14, s72, 1024
    buffer_load_dwordx4 v[68:71], v29, s[36:39], s14 offen
    s_add_u32 s14, s72, 2048
    buffer_load_dwordx4 v[72:75], v29, s[36:39], s14 offen
    s_add_u32 s14, s72, 3072
    buffer_load_dwordx4 v[76:79], v29, s[36:39], s14 offen
    s_add_u32 s14, s72, 16384
    buffer_load_dwordx4 v[80:83], v29, s[36:39], s14 offen
    s_add_u32 s14, s72, 17408
    buffer_load_dwordx4 v[84:87], v29, s[36:39], s14 offen
    s_add_u32 s14, s72, 18432
    buffer_load_dwordx4 v[88:91], v29, s[36:39], s14 offen
    s_add_u32 s14, s72, 19456
    buffer_load_dwordx4 v[92:95], v29, s[36:39], s14 offen
    s_add_u32 s14, s73, 0
    buffer_load_dwordx4 v[96:99], v29, s[36:39], s14 offen
    s_add_u32 s14, s73, 1024
    buffer_load_dwordx4 v[100:103], v29, s[36:39], s14 offen
    s_add_u32 s14, s73, 2048
    buffer_load_dwordx4 v[104:107], v29, s[36:39], s14 offen
    s_add_u32 s14, s73, 3072
    buffer_load_dwordx4 v[108:111], v29, s[36:39], s14 offen
    s_add_u32 s14, s73, 16384
    buffer_load_dwordx4 v[112:115], v29, s[36:39], s14 offen
    s_add_u32 s14, s73, 17408
    buffer_load_dwordx4 v[116:119], v29, s[36:39], s14 offen
    s_add_u32 s14, s73, 18432
    buffer_load_dwordx4 v[120:123], v29, s[36:39], s14 offen
    s_add_u32 s14, s73, 19456
    buffer_load_dwordx4 v[124:127], v29, s[36:39], s14 offen
    s_cmp_lg_u32 s3, 0
    s_cbranch_scc1 rw_8
    s_add_u32 m0, s76, 10240
    s_add_u32 s14, s74, 0
    buffer_load_dwordx4 v29, s[36:39], s14 offen lds
    s_add_u32 m0, s76, 11264
    s_add_u32 s14, s74, 1024
    buffer_load_dwordx4 v29, s[36:39], s14 offen lds
    s_add_u32 m0, s76, 12288
    s_add_u32 s14, s74, 2048
    buffer_load_dwordx4 v29, s[36:39], s14 offen lds
    s_add_u32 m0, s76, 13312
    s_add_u32 s14, s74, 3072
    buffer_load_dwordx4 v29, s[36:39], s14 offen lds
    s_add_u32 m0, s76, 16384
    s_add_u32 s14, s74, 16384
    buffer_load_dwordx4 v29, s[36:39], s14 offen lds
    s_add_u32 m0, s76, 17408
    s_add_u32 s14, s74, 17408
    buffer_load_dwordx4 v29, s[36:39], s14 offen lds
    s_add_u32 m0, s76, 18432
    s_add_u32 s14, s74, 18432
    buffer_load_dwordx4 v29, s[36:39], s14 offen lds
    s_add_u32 m0, s76, 19456
    s_add_u32 s14, s74, 19456
    buffer_load_dwordx4 v29, s[36:39], s14 offen lds
    s_add_u32 m0, s76, 22528
    s_add_u32 s14, s75, 0
    buffer_load_dwordx4 v29, s[36:39], s14 offen lds
    s_add_u32 m0, s76, 23552
    s_add_u32 s14, s75, 1024
    buffer_load_dwordx4 v29, s[36:39], s14 offen lds
    s_add_u32 m0, s76, 24576
    s_add_u32 s14, s75, 2048
    buffer_load_dwordx4 v29, s[36:39], s14 offen lds
    s_add_u32 m0, s76, 25600
    s_add_u32 s14, s75, 3072
    buffer_load_dwordx4 v29, s[36:39], s14 offen lds
    s_add_u32 m0, s76, 28672
    s_add_u32 s14, s75, 16384
    buffer_load_dwordx4 v29, s[36:39], s14 offen lds
    s_add_u32 m0, s76, 29696
    s_add_u32 s14, s75, 17408
    buffer_load_dwordx4 v29, s[36:39], s14 offen lds
    s_add_u32 m0, s76, 30720
    s_add_u32 s14, s75, 18432
    buffer_load_dwordx4 v29, s[36:39], s14 offen lds
    s_add_u32 m0, s76, 31744
    s_add_u32 s14, s75, 19456
    buffer_load_dwordx4 v29, s[36:39], s14 offen lds
rw_8:
    v_add_u32 v36, 32768, v32
    v_add_u32 v37, 32768, v33
    v_add_u32 v38, 32768, v34
    v_add_u32 v39, 32768, v35
    ds_read2st64_b32 v[44:45], v36 offset0:0 offset1:1
    ds_read2st64_b32 v[46:47], v36 offset0:8 offset1:9
    ds_read2st64_b32 v[48:49], v37 offset0:0 offset1:1
    ds_read2st64_b32 v[50:51], v37 offset0:8 offset1:9
    ds_read2st64_b32 v[52:53], v38 offset0:0 offset1:1
    ds_read2st64_b32 v[54:55], v38 offset0:8 offset1:9
    ds_read2st64_b32 v[56:57], v39 offset0:0 offset1:1
    ds_read2st64_b32 v[58:59], v39 offset0:8 offset1:9
    s_waitcnt lgkmcnt(6)
    v_perm_b32 v129, v45, v44, s12
    v_perm_b32 v137, v45, v44, s13
    v_perm_b32 v131, v47, v46, s12
    v_perm_b32 v139, v47, v46, s13
    s_waitcnt lgkmcnt(4)
    v_perm_b32 v145, v49, v48, s12
    v_perm_b32 v153, v49, v48, s13
    v_perm_b32 v147, v51, v50, s12
    v_perm_b32 v155, v51, v50, s13
    s_waitcnt lgkmcnt(2)
    v_perm_b32 v161, v53, v52, s12
    v_perm_b32 v169, v53, v52, s13
    v_perm_b32 v163, v55, v54, s12
    v_perm_b32 v171, v55, v54, s13
    s_waitcnt lgkmcnt(0)
    v_perm_b32 v177, v57, v56, s12
    v_perm_b32 v185, v57, v56, s13
    v_perm_b32 v179, v59, v58, s12
    v_perm_b32 v187, v59, v58, s13
    ds_read2st64_b32 v[44:45], v36 offset0:4 offset1:5
    ds_read2st64_b32 v[46:47], v36 offset0:12 offset1:13
    ds_read2st64_b32 v[48:49], v37 offset0:4 offset1:5
    ds_read2st64_b32 v[50:51], v37 offset0:12 offset1:13
    ds_read2st64_b32 v[52:53], v38 offset0:4 offset1:5
    ds_read2st64_b32 v[54:55], v38 offset0:12 offset1:13
    ds_read2st64_b32 v[56:57], v39 offset0:4 offset1:5
    ds_read2st64_b32 v[58:59], v39 offset0:12 offset1:13
    s_waitcnt lgkmcnt(6)
    v_perm_b32 v193, v45, v44, s12
    v_perm_b32 v201, v45, v44, s13
    v_perm_b32 v195, v47, v46, s12
    v_perm_b32 v203, v47, v46, s13
    s_waitcnt lgkmcnt(4)
    v_perm_b32 v209, v49, v48, s12
    v_perm_b32 v217, v49, v48, s13
    v_perm_b32 v211, v51, v50, s12
    v_perm_b32 v219, v51, v50, s13
    s_waitcnt lgkmcnt(2)
    v_perm_b32 v225, v53, v52, s12
    v_perm_b32 v233, v53, v52, s13
    v_perm_b32 v227, v55, v54, s12
    v_perm_b32 v235, v55, v54, s13
    s_waitcnt lgkmcnt(0)
    v_perm_b32 v241, v57, v56, s12
    v_perm_b32 v249, v57, v56, s13
    v_perm_b32 v243, v59, v58, s12
    v_perm_b32 v251, v59, v58, s13
    s_waitcnt vmcnt(25)
    s_barrier
    s_cmp_lg_u32 s3, 1
    s_cbranch_scc1 rw_9
    s_add_u32 m0, s76, 10240
    s_add_u32 s14, s74, 0
    buffer_load_dwordx4 v29, s[36:39], s14 offen lds
    s_add_u32 m0, s76, 11264
    s_add_u32 s14, s74, 1024
    buffer_load_dwordx4 v29, s[36:39], s14 offen lds
    s_add_u32 m0, s76, 12288
    s_add_u32 s14, s74, 2048
    buffer_load_dwordx4 v29, s[36:39], s14 offen lds
    s_add_u32 m0, s76, 13312
    s_add_u32 s14, s74, 3072
    buffer_load_dwordx4 v29, s[36:39], s14 offen lds
    s_add_u32 m0, s76, 16384
    s_add_u32 s14, s74, 16384
    buffer_load_dwordx4 v29, s[36:39], s14 offen lds
    s_add_u32 m0, s76, 17408
    s_add_u32 s14, s74, 17408
    buffer_load_dwordx4 v29, s[36:39], s14 offen lds
    s_add_u32 m0, s76, 18432
    s_add_u32 s14, s74, 18432
    buffer_load_dwordx4 v29, s[36:39], s14 offen lds
    s_add_u32 m0, s76, 19456
    s_add_u32 s14, s74, 19456
    buffer_load_dwordx4 v29, s[36:39], s14 offen lds
    s_add_u32 m0, s76, 22528
    s_add_u32 s14, s75, 0
    buffer_load_dwordx4 v29, s[36:39], s14 offen lds
    s_add_u32 m0, s76, 23552
    s_add_u32 s14, s75, 1024
    buffer_load_dwordx4 v29, s[36:39], s14 offen lds
    s_add_u32 m0, s76, 24576
    s_add_u32 s14, s75, 2048
    buffer_load_dwordx4 v29, s[36:39], s14 offen lds
    s_add_u32 m0, s76, 25600
    s_add_u32 s14, s75, 3072
    buffer_load_dwordx4 v29, s[36:39], s14 offen lds
    s_add_u32 m0, s76, 28672
    s_add_u32 s14, s75, 16384
    buffer_load_dwordx4 v29, s[36:39], s14 offen lds
    s_add_u32 m0, s76, 29696
    s_add_u32 s14, s75, 17408
    buffer_load_dwordx4 v29, s[36:39], s14 offen lds
    s_add_u32 m0, s76, 30720
    s_add_u32 s14, s75, 18432
    buffer_load_dwordx4 v29, s[36:39], s14 offen lds
    s_add_u32 m0, s76, 31744
    s_add_u32 s14, s75, 19456
    buffer_load_dwordx4 v29, s[36:39], s14 offen lds
rw_9:
    v_add_u32 v36, 65536, v32
    v_add_u32 v37, 65536, v33
    v_add_u32 v38, 65536, v34
    v_add_u32 v39, 65536, v35
    ds_read2st64_b32 v[44:45], v36 offset0:0 offset1:1
    ds_read2st64_b32 v[46:47], v36 offset0:8 offset1:9
    ds_read2st64_b32 v[48:49], v37 offset0:0 offset1:1
    ds_read2st64_b32 v[50:51], v37 offset0:8 offset1:9
    ds_read2st64_b32 v[52:53], v38 offset0:0 offset1:1
    ds_read2st64_b32 v[54:55], v38 offset0:8 offset1:9
    ds_read2st64_b32 v[56:57], v39 offset0:0 offset1:1
    ds_read2st64_b32 v[58:59], v39 offset0:8 offset1:9
    s_waitcnt lgkmcnt(6)
    v_perm_b32 v132, v45, v44, s12
    v_perm_b32 v140, v45, v44, s13
    v_perm_b32 v134, v47, v46, s12
    v_perm_b32 v142, v47, v46, s13
    s_waitcnt lgkmcnt(4)
    v_perm_b32 v148, v49, v48, s12
    v_perm_b32 v156, v49, v48, s13
    v_perm_b32 v150, v51, v50, s12
    v_perm_b32 v158, v51, v50, s13
    s_waitcnt lgkmcnt(2)
    v_perm_b32 v164, v53, v52, s12
    v_perm_b32 v172, v53, v52, s13
    v_perm_b32 v166, v55, v54, s12
    v_perm_b32 v174, v55, v54, s13
    s_waitcnt lgkmcnt(0)
    v_perm_b32 v180, v57, v56, s12
    v_perm_b32 v188, v57, v56, s13
    v_perm_b32 v182, v59, v58, s12
    v_perm_b32 v190, v59, v58, s13
    ds_read2st64_b32 v[44:45], v36 offset0:4 offset1:5
    ds_read2st64_b32 v[46:47], v36 offset0:12 offset1:13
    ds_read2st64_b32 v[48:49], v37 offset0:4 offset1:5
    ds_read2st64_b32 v[50:51], v37 offset0:12 offset1:13
    ds_read2st64_b32 v[52:53], v38 offset0:4 offset1:5
    ds_read2st64_b32 v[54:55], v38 offset0:12 offset1:13
    ds_read2st64_b32 v[56:57], v39 offset0:4 offset1:5
    ds_read2st64_b32 v[58:59], v39 offset0:12 offset1:13
    s_waitcnt lgkmcnt(6)
    v_perm_b32 v196, v45, v44, s12
    v_perm_b32 v204, v45, v44, s13
    v_perm_b32 v198, v47, v46, s12
    v_perm_b32 v206, v47, v46, s13
    s_waitcnt lgkmcnt(4)
    v_perm_b32 v212, v49, v48, s12
    v_perm_b32 v220, v49, v48, s13
    v_perm_b32 v214, v51, v50, s12
    v_perm_b32 v222, v51, v50, s13
    s_waitcnt lgkmcnt(2)
    v_perm_b32 v228, v53, v52, s12
    v_perm_b32 v236, v53, v52, s13
    v_perm_b32 v230, v55, v54, s12
    v_perm_b32 v238, v55, v54, s13
    s_waitcnt lgkmcnt(0)
    v_perm_b32 v244, v57, v56, s12
    v_perm_b32 v252, v57, v56, s13
    v_perm_b32 v246, v59, v58, s12
    v_perm_b32 v254, v59, v58, s13
    s_waitcnt vmcnt(17)
    s_barrier
    s_cmp_lg_u32 s3, 2
    s_cbranch_scc1 rw_10
    s_add_u32 m0, s76, 10240
    s_add_u32 s14, s74, 0
    buffer_load_dwordx4 v29, s[36:39], s14 offen lds
    s_add_u32 m0, s76, 11264
    s_add_u32 s14, s74, 1024
    buffer_load_dwordx4 v29, s[36:39], s14 offen lds
    s_add_u32 m0, s76, 12288
    s_add_u32 s14, s74, 2048
    buffer_load_dwordx4 v29, s[36:39], s14 offen lds
    s_add_u32 m0, s76, 13312
    s_add_u32 s14, s74, 3072
    buffer_load_dwordx4 v29, s[36:39], s14 offen lds
    s_add_u32 m0, s76, 16384
    s_add_u32 s14, s74, 16384
    buffer_load_dwordx4 v29, s[36:39], s14 offen lds
    s_add_u32 m0, s76, 17408
    s_add_u32 s14, s74, 17408
    buffer_load_dwordx4 v29, s[36:39], s14 offen lds
    s_add_u32 m0, s76, 18432
    s_add_u32 s14, s74, 18432
    buffer_load_dwordx4 v29, s[36:39], s14 offen lds
    s_add_u32 m0, s76, 19456
    s_add_u32 s14, s74, 19456
    buffer_load_dwordx4 v29, s[36:39], s14 offen lds
    s_add_u32 m0, s76, 22528
    s_add_u32 s14, s75, 0
    buffer_load_dwordx4 v29, s[36:39], s14 offen lds
    s_add_u32 m0, s76, 23552
    s_add_u32 s14, s75, 1024
    buffer_load_dwordx4 v29, s[36:39], s14 offen lds
    s_add_u32 m0, s76, 24576
    s_add_u32 s14, s75, 2048
    buffer_load_dwordx4 v29, s[36:39], s14 offen lds
    s_add_u32 m0, s76, 25600
    s_add_u32 s14, s75, 3072
    buffer_load_dwordx4 v29, s[36:39], s14 offen lds
    s_add_u32 m0, s76, 28672
    s_add_u32 s14, s75, 16384
    buffer_load_dwordx4 v29, s[36:39], s14 offen lds
    s_add_u32 m0, s76, 29696
    s_add_u32 s14, s75, 17408
    buffer_load_dwordx4 v29, s[36:39], s14 offen lds
    s_add_u32 m0, s76, 30720
    s_add_u32 s14, s75, 18432
    buffer_load_dwordx4 v29, s[36:39], s14 offen lds
    s_add_u32 m0, s76, 31744
    s_add_u32 s14, s75, 19456
    buffer_load_dwordx4 v29, s[36:39], s14 offen lds
rw_10:
    s_waitcnt vmcnt(16)
    s_branch wtp_13
wt_11:
    buffer_load_dword v30, v5, s[56:59], 0 offen sc1
    s_waitcnt vmcnt(0)
    s_mov_b32 s79, 1
wtp_13:
    s_mov_b32 s9, 3233857728
    v_and_b32 v26, s9, v30
    v_cmp_ne_u32 vcc, s9, v26
    s_and_b32 vcc_lo, vcc_lo, 4294967295
    s_and_b32 vcc_hi, vcc_hi, 4278255615
    s_cmp_eq_u64 vcc, 0
    s_cbranch_scc1 wtd_12
    s_sleep 1
    s_sub_u32 s8, s8, 1
    s_cbranch_scc0 wt_11
    s_mov_b32 s8, 0
wtd_12:
    s_mul_i32 s9, s6, 0x01010101
    v_and_b32 v30, 0x0f0f0f0f, v30
    v_cmp_ne_u32 vcc, s9, v30
    s_lshl_b32 s10, s4, 3
    s_lshr_b64 s[10:11], vcc, s10
    s_and_b32 s10, s10, 0xff
    s_cmp_lg_u32 s10, 0
    s_cselect_b32 s7, 1, 0
    buffer_load_dword v21, v20, s[60:63], 0 offen sc1
    s_lshl_b32 s9, s64, 11
    v_lshlrev_b32 v26, 4, v5
    v_and_b32 v26, 0x7c0, v26
    v_cmp_lt_u32 vcc, 124, v5
    v_mov_b32 v27, 0x80000
    s_nop 0
    v_cndmask_b32 v27, 0, v27, vcc
    v_add_u32 v26, v26, v27
    s_add_u32 s9, s9, 2097152
    buffer_load_dword v31, v26, s[60:63], s9 offen sc1
    s_lshl_b32 s9, s64, 8
    s_add_u32 s9, s9, 6291456
    buffer_load_dword v31, v5, s[60:63], s9 offen sc1
    v_add_u32 v36, 98304, v32
    v_add_u32 v37, 98304, v33
    v_add_u32 v38, 98304, v34
    v_add_u32 v39, 98304, v35
    ds_read2st64_b32 v[44:45], v36 offset0:0 offset1:1
    ds_read2st64_b32 v[46:47], v36 offset0:8 offset1:9
    ds_read2st64_b32 v[48:49], v37 offset0:0 offset1:1
    ds_read2st64_b32 v[50:51], v37 offset0:8 offset1:9
    ds_read2st64_b32 v[52:53], v38 offset0:0 offset1:1
    ds_read2st64_b32 v[54:55], v38 offset0:8 offset1:9
    ds_read2st64_b32 v[56:57], v39 offset0:0 offset1:1
    ds_read2st64_b32 v[58:59], v39 offset0:8 offset1:9
    s_waitcnt lgkmcnt(6)
    v_perm_b32 v133, v45, v44, s12
    v_perm_b32 v141, v45, v44, s13
    v_perm_b32 v135, v47, v46, s12
    v_perm_b32 v143, v47, v46, s13
    s_waitcnt lgkmcnt(4)
    v_perm_b32 v149, v49, v48, s12
    v_perm_b32 v157, v49, v48, s13
    v_perm_b32 v151, v51, v50, s12
    v_perm_b32 v159, v51, v50, s13
    s_waitcnt lgkmcnt(2)
    v_perm_b32 v165, v53, v52, s12
    v_perm_b32 v173, v53, v52, s13
    v_perm_b32 v167, v55, v54, s12
    v_perm_b32 v175, v55, v54, s13
    s_waitcnt lgkmcnt(0)
    v_perm_b32 v181, v57, v56, s12
    v_perm_b32 v189, v57, v56, s13
    v_perm_b32 v183, v59, v58, s12
    v_perm_b32 v191, v59, v58, s13
    ds_read2st64_b32 v[44:45], v36 offset0:4 offset1:5
    ds_read2st64_b32 v[46:47], v36 offset0:12 offset1:13
    ds_read2st64_b32 v[48:49], v37 offset0:4 offset1:5
    ds_read2st64_b32 v[50:51], v37 offset0:12 offset1:13
    ds_read2st64_b32 v[52:53], v38 offset0:4 offset1:5
    ds_read2st64_b32 v[54:55], v38 offset0:12 offset1:13
    ds_read2st64_b32 v[56:57], v39 offset0:4 offset1:5
    ds_read2st64_b32 v[58:59], v39 offset0:12 offset1:13
    s_waitcnt lgkmcnt(6)
    v_perm_b32 v197, v45, v44, s12
    v_perm_b32 v205, v45, v44, s13
    v_perm_b32 v199, v47, v46, s12
    v_perm_b32 v207, v47, v46, s13
    s_waitcnt lgkmcnt(4)
    v_perm_b32 v213, v49, v48, s12
    v_perm_b32 v221, v49, v48, s13
    v_perm_b32 v215, v51, v50, s12
    v_perm_b32 v223, v51, v50, s13
    s_waitcnt lgkmcnt(2)
    v_perm_b32 v229, v53, v52, s12
    v_perm_b32 v237, v53, v52, s13
    v_perm_b32 v231, v55, v54, s12
    v_perm_b32 v239, v55, v54, s13
    s_waitcnt lgkmcnt(0)
    v_perm_b32 v245, v57, v56, s12
    v_perm_b32 v253, v57, v56, s13
    v_perm_b32 v247, v59, v58, s12
    v_perm_b32 v255, v59, v58, s13
    s_barrier
    s_cmp_lg_u32 s3, 3
    s_cbranch_scc1 rw_14
    s_add_u32 m0, s76, 10240
    s_add_u32 s14, s74, 0
    buffer_load_dwordx4 v29, s[36:39], s14 offen lds
    s_add_u32 m0, s76, 11264
    s_add_u32 s14, s74, 1024
    buffer_load_dwordx4 v29, s[36:39], s14 offen lds
    s_add_u32 m0, s76, 12288
    s_add_u32 s14, s74, 2048
    buffer_load_dwordx4 v29, s[36:39], s14 offen lds
    s_add_u32 m0, s76, 13312
    s_add_u32 s14, s74, 3072
    buffer_load_dwordx4 v29, s[36:39], s14 offen lds
    s_add_u32 m0, s76, 16384
    s_add_u32 s14, s74, 16384
    buffer_load_dwordx4 v29, s[36:39], s14 offen lds
    s_add_u32 m0, s76, 17408
    s_add_u32 s14, s74, 17408
    buffer_load_dwordx4 v29, s[36:39], s14 offen lds
    s_add_u32 m0, s76, 18432
    s_add_u32 s14, s74, 18432
    buffer_load_dwordx4 v29, s[36:39], s14 offen lds
    s_add_u32 m0, s76, 19456
    s_add_u32 s14, s74, 19456
    buffer_load_dwordx4 v29, s[36:39], s14 offen lds
    s_add_u32 m0, s76, 22528
    s_add_u32 s14, s75, 0
    buffer_load_dwordx4 v29, s[36:39], s14 offen lds
    s_add_u32 m0, s76, 23552
    s_add_u32 s14, s75, 1024
    buffer_load_dwordx4 v29, s[36:39], s14 offen lds
    s_add_u32 m0, s76, 24576
    s_add_u32 s14, s75, 2048
    buffer_load_dwordx4 v29, s[36:39], s14 offen lds
    s_add_u32 m0, s76, 25600
    s_add_u32 s14, s75, 3072
    buffer_load_dwordx4 v29, s[36:39], s14 offen lds
    s_add_u32 m0, s76, 28672
    s_add_u32 s14, s75, 16384
    buffer_load_dwordx4 v29, s[36:39], s14 offen lds
    s_add_u32 m0, s76, 29696
    s_add_u32 s14, s75, 17408
    buffer_load_dwordx4 v29, s[36:39], s14 offen lds
    s_add_u32 m0, s76, 30720
    s_add_u32 s14, s75, 18432
    buffer_load_dwordx4 v29, s[36:39], s14 offen lds
    s_add_u32 m0, s76, 31744
    s_add_u32 s14, s75, 19456
    buffer_load_dwordx4 v29, s[36:39], s14 offen lds
    s_waitcnt vmcnt(16)
    s_branch rw_14x
rw_14:
    s_waitcnt vmcnt(0)
rw_14x:
    v_cmp_gt_u32 vcc, 1, v21
    s_cbranch_vccz rg_15
wf_16:
    buffer_load_dword v21, v20, s[60:63], 0 offen sc1
    s_waitcnt vmcnt(0)
    v_cmp_gt_u32 vcc, 1, v21
    s_cbranch_vccz wfd_17
    s_sleep 1
    s_sub_u32 s8, s8, 1
    s_cbranch_scc0 wf_16
    s_mov_b32 s8, 0
wfd_17:
rg_15:
    s_lshl_b32 s9, s67, 1
    s_add_u32 s9, s9, s69
    s_mov_b32 m0, s66
    s_nop 0
    buffer_load_dwordx4 v4, s[60:63], s9 offen offset:0 sc1 lds
    buffer_load_dwordx4 v4, s[60:63], s9 offen offset:1024 sc1 lds
    s_add_u32 s9, s69, s67
    s_add_u32 s9, s9, 8192
    s_mov_b32 m0, s15
    s_nop 0
    buffer_load_dwordx4 v4, s[60:63], s9 offen sc1 lds
    s_add_u32 s9, s9, 4096
    s_add_u32 m0, s15, 4096
    s_nop 0
    buffer_load_dwordx4 v4, s[60:63], s9 offen sc1 lds
    s_add_u32 s69, s69, 524288
    buffer_load_dword v28, v23, s[20:23], s78 offen offset:0
    buffer_load_dword v29, v23, s[20:23], s78 offen offset:16
    buffer_load_dword v30, v23, s[20:23], s78 offen offset:32
    buffer_load_dword v31, v23, s[20:23], s78 offen offset:48
    buffer_load_dword v32, v23, s[20:23], s78 offen offset:8
    buffer_load_dword v33, v23, s[20:23], s78 offen offset:24
    buffer_load_dword v34, v23, s[20:23], s78 offen offset:40
    buffer_load_dword v35, v23, s[20:23], s78 offen offset:56
    ds_write_b128 v12, a[0:3] offset:8192
    ds_write_b128 v12, a[4:7] offset:9216
    ds_write_b128 v12, a[72:75] offset:14336
    ds_write_b128 v12, a[76:79] offset:15360
    ds_write_b128 v12, a[192:195] offset:20480
    ds_write_b128 v12, a[196:199] offset:21504
    s_waitcnt lgkmcnt(0)
    v_perm_b32 v44, v68, v64, s12
    v_perm_b32 v45, v68, v64, s13
    v_perm_b32 v46, v76, v72, s12
    v_perm_b32 v47, v76, v72, s13
    v_perm_b32 v48, v84, v80, s12
    v_perm_b32 v49, v84, v80, s13
    v_perm_b32 v50, v92, v88, s12
    v_perm_b32 v51, v92, v88, s13
    ds_write_b128 v12, v[44:47] offset:0
    ds_write_b128 v12, v[48:51] offset:1024
    v_perm_b32 v52, v69, v65, s12
    v_perm_b32 v53, v69, v65, s13
    v_perm_b32 v54, v77, v73, s12
    v_perm_b32 v55, v77, v73, s13
    v_perm_b32 v56, v85, v81, s12
    v_perm_b32 v57, v85, v81, s13
    v_perm_b32 v58, v93, v89, s12
    v_perm_b32 v59, v93, v89, s13
    ds_write_b128 v12, v[52:55] offset:2048
    ds_write_b128 v12, v[56:59] offset:3072
    v_perm_b32 v44, v70, v66, s12
    v_perm_b32 v45, v70, v66, s13
    v_perm_b32 v46, v78, v74, s12
    v_perm_b32 v47, v78, v74, s13
    v_perm_b32 v48, v86, v82, s12
    v_perm_b32 v49, v86, v82, s13
    v_perm_b32 v50, v94, v90, s12
    v_perm_b32 v51, v94, v90, s13
    ds_write_b128 v12, v[44:47] offset:4096
    ds_write_b128 v12, v[48:51] offset:5120
    v_perm_b32 v52, v71, v67, s12
    v_perm_b32 v53, v71, v67, s13
    v_perm_b32 v54, v79, v75, s12
    v_perm_b32 v55, v79, v75, s13
    v_perm_b32 v56, v87, v83, s12
    v_perm_b32 v57, v87, v83, s13
    v_perm_b32 v58, v95, v91, s12
    v_perm_b32 v59, v95, v91, s13
    ds_write_b128 v12, v[52:55] offset:6144
    ds_write_b128 v12, v[56:59] offset:7168
    v_perm_b32 v60, v100, v96, s12
    v_accvgpr_write_b32 a0, v60
    v_perm_b32 v61, v100, v96, s13
    v_accvgpr_write_b32 a1, v61
    v_perm_b32 v60, v108, v104, s12
    v_accvgpr_write_b32 a2, v60
    v_perm_b32 v61, v108, v104, s13
    v_accvgpr_write_b32 a3, v61
    v_perm_b32 v60, v116, v112, s12
    v_accvgpr_write_b32 a4, v60
    v_perm_b32 v61, v116, v112, s13
    v_accvgpr_write_b32 a5, v61
    v_perm_b32 v60, v124, v120, s12
    v_accvgpr_write_b32 a6, v60
    v_perm_b32 v61, v124, v120, s13
    v_accvgpr_write_b32 a7, v61
    v_perm_b32 v60, v101, v97, s12
    v_accvgpr_write_b32 a72, v60
    v_perm_b32 v61, v101, v97, s13
    v_accvgpr_write_b32 a73, v61
    v_perm_b32 v60, v109, v105, s12
    v_accvgpr_write_b32 a74, v60
    v_perm_b32 v61, v109, v105, s13
    v_accvgpr_write_b32 a75, v61
    v_perm_b32 v60, v117, v113, s12
    v_accvgpr_write_b32 a76, v60
    v_perm_b32 v61, v117, v113, s13
    v_accvgpr_write_b32 a77, v61
    v_perm_b32 v60, v125, v121, s12
    v_accvgpr_write_b32 a78, v60
    v_perm_b32 v61, v125, v121, s13
    v_accvgpr_write_b32 a79, v61
    v_perm_b32 v60, v102, v98, s12
    v_accvgpr_write_b32 a192, v60
    v_perm_b32 v61, v102, v98, s13
    v_accvgpr_write_b32 a193, v61
    v_perm_b32 v60, v110, v106, s12
    v_accvgpr_write_b32 a194, v60
    v_perm_b32 v61, v110, v106, s13
    v_accvgpr_write_b32 a195, v61
    v_perm_b32 v60, v118, v114, s12
    v_accvgpr_write_b32 a196, v60
    v_perm_b32 v61, v118, v114, s13
    v_accvgpr_write_b32 a197, v61
    v_perm_b32 v60, v126, v122, s12
    v_accvgpr_write_b32 a198, v60
    v_perm_b32 v61, v126, v122, s13
    v_accvgpr_write_b32 a199, v61
    v_perm_b32 v52, v103, v99, s12
    v_perm_b32 v53, v103, v99, s13
    v_perm_b32 v54, v111, v107, s12
    v_perm_b32 v55, v111, v107, s13
    v_perm_b32 v56, v119, v115, s12
    v_perm_b32 v57, v119, v115, s13
    v_perm_b32 v58, v127, v123, s12
    v_perm_b32 v59, v127, v123, s13
    ds_write_b128 v12, v[52:55] offset:26624
    ds_write_b128 v12, v[56:59] offset:27648
    s_waitcnt vmcnt(12)
    ds_read_b128 v[64:67], v12 offset:10240
    ds_read_b128 v[68:71], v12 offset:11264
    ds_read_b128 v[72:75], v12 offset:12288
    ds_read_b128 v[76:79], v12 offset:13312
    ds_read_b128 v[80:83], v12 offset:16384
    ds_read_b128 v[84:87], v12 offset:17408
    ds_read_b128 v[88:91], v12 offset:18432
    ds_read_b128 v[92:95], v12 offset:19456
    s_waitcnt lgkmcnt(0)
    ds_read_b128 v[96:99], v12 offset:22528
    ds_read_b128 v[100:103], v12 offset:23552
    ds_read_b128 v[104:107], v12 offset:24576
    ds_read_b128 v[108:111], v12 offset:25600
    ds_read_b128 v[112:115], v12 offset:28672
    ds_read_b128 v[116:119], v12 offset:29696
    ds_read_b128 v[120:123], v12 offset:30720
    ds_read_b128 v[124:127], v12 offset:31744
    s_waitcnt lgkmcnt(0)
    buffer_load_dword v21, v20, s[60:63], 0 offen sc1
    ds_write_b128 v12, a[8:11] offset:10240
    ds_write_b128 v12, a[12:15] offset:11264
    ds_write_b128 v12, a[64:67] offset:12288
    ds_write_b128 v12, a[68:71] offset:13312
    ds_write_b128 v12, a[128:131] offset:16384
    ds_write_b128 v12, a[132:135] offset:17408
    ds_write_b128 v12, a[136:139] offset:18432
    ds_write_b128 v12, a[140:143] offset:19456
    ds_write_b128 v12, a[200:203] offset:22528
    ds_write_b128 v12, a[204:207] offset:23552
    s_waitcnt lgkmcnt(0)
    v_perm_b32 v60, v68, v64, s12
    v_accvgpr_write_b32 a8, v60
    v_perm_b32 v61, v68, v64, s13
    v_accvgpr_write_b32 a9, v61
    v_perm_b32 v60, v76, v72, s12
    v_accvgpr_write_b32 a10, v60
    v_perm_b32 v61, v76, v72, s13
    v_accvgpr_write_b32 a11, v61
    v_perm_b32 v60, v84, v80, s12
    v_accvgpr_write_b32 a12, v60
    v_perm_b32 v61, v84, v80, s13
    v_accvgpr_write_b32 a13, v61
    v_perm_b32 v60, v92, v88, s12
    v_accvgpr_write_b32 a14, v60
    v_perm_b32 v61, v92, v88, s13
    v_accvgpr_write_b32 a15, v61
    v_perm_b32 v60, v100, v96, s12
    v_accvgpr_write_b32 a64, v60
    v_perm_b32 v61, v100, v96, s13
    v_accvgpr_write_b32 a65, v61
    v_perm_b32 v60, v108, v104, s12
    v_accvgpr_write_b32 a66, v60
    v_perm_b32 v61, v108, v104, s13
    v_accvgpr_write_b32 a67, v61
    v_perm_b32 v60, v116, v112, s12
    v_accvgpr_write_b32 a68, v60
    v_perm_b32 v61, v116, v112, s13
    v_accvgpr_write_b32 a69, v61
    v_perm_b32 v60, v124, v120, s12
    v_accvgpr_write_b32 a70, v60
    v_perm_b32 v61, v124, v120, s13
    v_accvgpr_write_b32 a71, v61
    v_perm_b32 v60, v69, v65, s12
    v_accvgpr_write_b32 a128, v60
    v_perm_b32 v61, v69, v65, s13
    v_accvgpr_write_b32 a129, v61
    v_perm_b32 v60, v77, v73, s12
    v_accvgpr_write_b32 a130, v60
    v_perm_b32 v61, v77, v73, s13
    v_accvgpr_write_b32 a131, v61
    v_perm_b32 v60, v85, v81, s12
    v_accvgpr_write_b32 a132, v60
    v_perm_b32 v61, v85, v81, s13
    v_accvgpr_write_b32 a133, v61
    v_perm_b32 v60, v93, v89, s12
    v_accvgpr_write_b32 a134, v60
    v_perm_b32 v61, v93, v89, s13
    v_accvgpr_write_b32 a135, v61
    v_perm_b32 v60, v101, v97, s12
    v_accvgpr_write_b32 a136, v60
    v_perm_b32 v61, v101, v97, s13
    v_accvgpr_write_b32 a137, v61
    v_perm_b32 v60, v109, v105, s12
    v_accvgpr_write_b32 a138, v60
    v_perm_b32 v61, v109, v105, s13
    v_accvgpr_write_b32 a139, v61
    v_perm_b32 v60, v117, v113, s12
    v_accvgpr_write_b32 a140, v60
    v_perm_b32 v61, v117, v113, s13
    v_accvgpr_write_b32 a141, v61
    v_perm_b32 v60, v125, v121, s12
    v_accvgpr_write_b32 a142, v60
    v_perm_b32 v61, v125, v121, s13
    v_accvgpr_write_b32 a143, v61
    v_perm_b32 v60, v70, v66, s12
    v_accvgpr_write_b32 a200, v60
    v_perm_b32 v61, v70, v66, s13
    v_accvgpr_write_b32 a201, v61
    v_perm_b32 v60, v78, v74, s12
    v_accvgpr_write_b32 a202, v60
    v_perm_b32 v61, v78, v74, s13
    v_accvgpr_write_b32 a203, v61
    v_perm_b32 v60, v86, v82, s12
    v_accvgpr_write_b32 a204, v60
    v_perm_b32 v61, v86, v82, s13
    v_accvgpr_write_b32 a205, v61
    v_perm_b32 v60, v94, v90, s12
    v_accvgpr_write_b32 a206, v60
    v_perm_b32 v61, v94, v90, s13
    v_accvgpr_write_b32 a207, v61
    v_perm_b32 v52, v102, v98, s12
    v_perm_b32 v53, v102, v98, s13
    v_perm_b32 v54, v110, v106, s12
    v_perm_b32 v55, v110, v106, s13
    v_perm_b32 v56, v118, v114, s12
    v_perm_b32 v57, v118, v114, s13
    v_perm_b32 v58, v126, v122, s12
    v_perm_b32 v59, v126, v122, s13
    ds_write_b128 v12, v[52:55] offset:24576
    ds_write_b128 v12, v[56:59] offset:25600
    v_perm_b32 v44, v71, v67, s12
    v_perm_b32 v45, v71, v67, s13
    v_perm_b32 v46, v79, v75, s12
    v_perm_b32 v47, v79, v75, s13
    v_perm_b32 v48, v87, v83, s12
    v_perm_b32 v49, v87, v83, s13
    v_perm_b32 v50, v95, v91, s12
    v_perm_b32 v51, v95, v91, s13
    ds_write_b128 v12, v[44:47] offset:28672
    ds_write_b128 v12, v[48:51] offset:29696
    v_perm_b32 v52, v103, v99, s12
    v_perm_b32 v53, v103, v99, s13
    v_perm_b32 v54, v111, v107, s12
    v_perm_b32 v55, v111, v107, s13
    v_perm_b32 v56, v119, v115, s12
    v_perm_b32 v57, v119, v115, s13
    v_perm_b32 v58, v127, v123, s12
    v_perm_b32 v59, v127, v123, s13
    ds_write_b128 v12, v[52:55] offset:30720
    ds_write_b128 v12, v[56:59] offset:31744
    v_mov_b32 v100, 0
    v_mov_b32 v101, 0
    v_mov_b32 v102, 0
    v_mov_b32 v103, 0
    v_mov_b32 v104, 0
    v_mov_b32 v105, 0
    v_mov_b32 v106, 0
    v_mov_b32 v107, 0
    v_mov_b32 v108, 0
    v_mov_b32 v109, 0
    v_mov_b32 v110, 0
    v_mov_b32 v111, 0
    v_mov_b32 v112, 0
    v_mov_b32 v113, 0
    v_mov_b32 v114, 0
    v_mov_b32 v115, 0
    v_mov_b32 v116, 0
    v_mov_b32 v117, 0
    v_mov_b32 v118, 0
    v_mov_b32 v119, 0
    v_mov_b32 v120, 0
    v_mov_b32 v121, 0
    v_mov_b32 v122, 0
    v_mov_b32 v123, 0
    v_mov_b32 v124, 0
    v_mov_b32 v125, 0
    v_mov_b32 v126, 0
    v_mov_b32 v127, 0
    s_waitcnt lgkmcnt(0)
    s_lshr_b32 s4, s5, 4
    s_lshl_b32 s72, s5, 12
    s_add_u32 s72, s72, s67
    s_add_u32 s70, s72, 8126464
    s_add_u32 s72, s72, 44040192
    s_add_u32 s5, s72, 8650752
    v_add_u32 v5, 2048, v11
    v_mov_b32 v44, 0
    v_mov_b32 v48, 0x3f803f80
    v_mov_b32 v45, 0
    v_mov_b32 v49, 0x3f803f80
    v_mov_b32 v46, 0
    v_mov_b32 v50, 0x3f803f80
    v_mov_b32 v47, 0
    v_mov_b32 v51, 0x3f803f80
    v_mov_b32 v52, -1
    v_mov_b32 v53, -1
    v_mov_b32 v54, -1
    v_mov_b32 v55, -1
    ds_write_b128 v7, v[52:55] offset:8192
    ds_write_b128 v7, v[52:55] offset:9216
    ds_write_b128 v7, v[52:55] offset:10240
    ds_write_b128 v7, v[52:55] offset:11264
    ds_write_b128 v7, v[52:55] offset:12288
    ds_write_b128 v7, v[52:55] offset:13312
    ds_write_b128 v7, v[44:47] offset:30720
    ds_write_b128 v7, v[48:51] offset:31744
    s_waitcnt lgkmcnt(0)
    ds_read_b128 v[44:47], v12 offset:8192
    ds_read_b128 v[48:51], v12 offset:9216
    ds_read_b128 v[52:55], v12 offset:10240
    ds_read_b128 v[56:59], v12 offset:11264
    ds_read_b128 v[60:63], v12 offset:12288
    ds_read_b128 v[64:67], v12 offset:13312
    ds_read_b128 v[36:39], v12 offset:14336
    ds_read_b128 v[40:43], v12 offset:15360
    s_waitcnt lgkmcnt(0)
    ds_read_b128 v[68:71], v12 offset:16384
    ds_read_b128 v[72:75], v12 offset:17408
    ds_read_b128 v[76:79], v12 offset:18432
    ds_read_b128 v[80:83], v12 offset:19456
    ds_read_b128 v[84:87], v12 offset:20480
    ds_read_b128 v[88:91], v12 offset:21504
    ds_read_b128 v[92:95], v12 offset:22528
    ds_read_b128 v[96:99], v12 offset:23552
    s_waitcnt vmcnt(0) lgkmcnt(0)
    s_mov_b32 s12, 0x3e0293ee
    s_mov_b32 s13, 0x3e0293ee
    s_mov_b32 s0, 0xffff
    s_mov_b32 s1, 0
    s_mov_b32 s64, 0x55555555
    s_mov_b32 s65, 0x55555555
    s_mov_b32 s71, 0x49800000
    s_mov_b32 s73, 2621440
    s_mov_b32 s79, 0
    s_cmp_lg_u32 s7, 0
    s_cbranch_scc1 L_R_far
    s_branch L_R_near
L_R_w_near:
    s_waitcnt vmcnt(2) lgkmcnt(0)
    v_max3_u32 v22, v28, v29, v30
    v_max3_u32 v23, v31, v32, v33
    v_max3_u32 v22, v22, v34, v35
    v_max_u32 v22, v22, v23
    v_cmp_eq_u32 vcc, -1, v22
    s_cbranch_vccnz L_R_h2fail_near
L_R_near:
    ds_write_b128 v16, v[28:31]
    v_smfmac_f32_16x16x64_bf16 v[100:103], v[28:31], v[44:51], v6
    ds_write_b128 v16, v[32:35] offset:4096
    v_smfmac_f32_16x16x64_bf16 v[104:107], v[28:31], v[52:59], v6
    s_add_u32 s10, s68, 2
    v_cmp_gt_u32 vcc, s10, v21
    v_smfmac_f32_16x16x64_bf16 v[100:103], v[32:35], v[60:67], v6
    s_cbranch_vccnz L_R_kvslow_near
L_R_kvok_near:
    v_smfmac_f32_16x16x64_bf16 v[104:107], v[32:35], v[36:43], v6
    s_lshl_b32 s10, s67, 2
    s_add_u32 s10, s10, s69
    v_lshlrev_b32 v22, 2, v4
    v_smfmac_f32_16x16x64_bf16 v[108:111], v[28:31], v[68:75], v6
    v_smfmac_f32_16x16x64_bf16 v[112:115], v[28:31], v[76:83], v6
    s_waitcnt lgkmcnt(0)
    s_barrier
    ds_read_b128 v[44:47], v17 offset:0
    v_smfmac_f32_16x16x64_bf16 v[108:111], v[32:35], v[84:91], v6
    ds_read_b128 v[48:51], v18 offset:0
    buffer_load_dword v21, v22, s[60:63], s10 offen sc1
    v_smfmac_f32_16x16x64_bf16 v[112:115], v[32:35], v[92:99], v6
    ds_read_b128 v[52:55], v19 offset:0
    buffer_load_dword v21, v20, s[60:63], 0 offen sc1
    v_smfmac_f32_16x16x64_bf16 v[116:119], v[28:31], v[128:135], v6
    ds_read_b128 v[56:59], v17 offset:4096
    buffer_store_dwordx4 v[124:127], v4, s[60:63], s70 offen sc1
    s_mov_b32 s70, s72
    v_smfmac_f32_16x16x64_bf16 v[120:123], v[28:31], v[136:143], v6
    s_and_b32 s9, s68, 3
    s_xor_b32 s73, s73, 0x80000
    ds_read_b128 v[64:67], v19 offset:4096
    v_smfmac_f32_16x16x64_bf16 v[116:119], v[32:35], v[192:199], v6
    s_lshl_b32 s74, s9, 13
    s_add_u32 s74, s74, 6291456
    ds_read_b128 v[60:63], v18 offset:4096
    v_smfmac_f32_16x16x64_bf16 v[120:123], v[32:35], v[200:207], v6
    s_cmp_eq_u32 s68, 63
    s_cbranch_scc1 L_R_done
    s_waitcnt lgkmcnt(4)
    v_smfmac_f32_16x16x64_bf16 v[100:103], v[44:47], a[16:23], v6
    s_xor_b32 s75, s74, 0x4000
    ds_read_b128 v[68:71], v7 offset:14336
    v_smfmac_f32_16x16x64_bf16 v[100:103], v[48:51], a[32:39], v6
    s_add_u32 s72, s72, 0x20000
    ds_read_b128 v[72:75], v7 offset:15360
    s_waitcnt lgkmcnt(4)
    v_smfmac_f32_16x16x64_bf16 v[100:103], v[52:55], a[48:55], v6
    s_add_u32 s11, s74, s67
    ds_read_b128 v[76:79], v7 offset:16384
    v_smfmac_f32_16x16x64_bf16 v[100:103], v[56:59], a[80:87], v6
    ds_read_b128 v[80:83], v7 offset:17408
    s_waitcnt lgkmcnt(4)
    v_smfmac_f32_16x16x64_bf16 v[100:103], v[64:67], a[112:119], v6
    s_add_u32 s14, s11, 4096
    ds_read_b128 v[84:87], v7 offset:18432
    v_mov_b32 v22, -1
    v_smfmac_f32_16x16x64_bf16 v[100:103], v[60:63], a[96:103], v6
    s_bfe_u32 s13, s68, 0x10001
    ds_read_b128 v[88:91], v7 offset:19456
    v_smfmac_f32_16x16x64_bf16 v[104:107], v[44:47], a[24:31], v6
    buffer_store_dword v22, v10, s[60:63], s75 offen
    v_smfmac_f32_16x16x64_bf16 v[104:107], v[48:51], a[40:47], v6
    ds_read_b128 v[92:95], v7 offset:20480
    v_mov_b32 v23, 0
    v_smfmac_f32_16x16x64_bf16 v[104:107], v[52:55], a[56:63], v6
    ds_read_b128 v[96:99], v7 offset:21504
    v_add_f32 v100, v100, v102
    v_smfmac_f32_16x16x64_bf16 v[104:107], v[56:59], a[88:95], v6
    v_add_f32 v101, v101, v103
    v_smfmac_f32_16x16x64_bf16 v[104:107], v[64:67], a[120:127], v6
    s_and_b32 s12, s68, 1
    v_mov_b32 v24, 0
    v_smfmac_f32_16x16x64_bf16 v[104:107], v[60:63], a[104:111], v6
    s_lshl_b32 s9, s67, 1
    s_add_u32 s9, s9, s69
    s_mov_b32 m0, s66
    v_smfmac_f32_16x16x64_bf16 v[108:111], v[44:47], a[144:151], v6
    s_waitcnt vmcnt(4)
    s_nop 0
    v_smfmac_f32_16x16x64_bf16 v[108:111], v[48:51], a[160:167], v6
    s_nop 0
    v_add_f32 v104, v104, v106
    v_add_f32 v105, v105, v107
    v_smfmac_f32_16x16x64_bf16 v[108:111], v[52:55], a[176:183], v6
    v_cvt_pk_bf16_f32 v100, v100, v104
    v_cvt_pk_bf16_f32 v101, v101, v105
    v_smfmac_f32_16x16x64_bf16 v[108:111], v[56:59], a[208:215], v6
    v_and_or_b32 v100, v100, -2, s12
    v_and_or_b32 v101, v101, -2, s12
    ds_write2_b32 v11, v100, v101 offset0:0 offset1:4
    v_smfmac_f32_16x16x64_bf16 v[108:111], v[60:63], a[224:231], v6
    v_smfmac_f32_16x16x64_bf16 v[108:111], v[64:67], a[240:247], v6
    v_smfmac_f32_16x16x64_bf16 v[112:115], v[44:47], a[152:159], v6
    v_smfmac_f32_16x16x64_bf16 v[112:115], v[48:51], a[168:175], v6
    s_nop 0
    s_nop 0
    v_smfmac_f32_16x16x64_bf16 v[112:115], v[52:55], a[184:191], v6
    ds_read_b128 v[28:31], v13 offset:0
    s_nop 0
    v_smfmac_f32_16x16x64_bf16 v[112:115], v[56:59], a[216:223], v6
    ds_read_b128 v[32:35], v13 offset:512
    v_add_f32 v108, v108, v110
    v_smfmac_f32_16x16x64_bf16 v[112:115], v[60:63], a[232:239], v6
    ds_read_b128 v[36:39], v13 offset:1024
    v_add_f32 v109, v109, v111
    v_smfmac_f32_16x16x64_bf16 v[112:115], v[64:67], a[248:255], v6
    ds_read_b128 v[40:43], v13 offset:1536
    s_nop 0
    s_nop 0
    v_smfmac_f32_16x16x64_bf16 v[116:119], v[44:47], v[144:151], v6
    s_nop 0
    s_nop 0
    v_smfmac_f32_16x16x64_bf16 v[120:123], v[44:47], v[152:159], v6
    s_nop 0
    v_add_f32 v112, v112, v114
    v_add_f32 v113, v113, v115
    v_smfmac_f32_16x16x64_bf16 v[116:119], v[48:51], v[160:167], v6
    ds_read_b128 v[44:47], v7 offset:31744
    v_cvt_pk_bf16_f32 v124, v108, v112
    v_cvt_pk_bf16_f32 v125, v109, v113
    v_smfmac_f32_16x16x64_bf16 v[120:123], v[48:51], v[168:175], v6
    v_and_or_b32 v22, v124, -2, s12
    v_and_or_b32 v27, v125, -2, s12
    ds_write2_b32 v5, v22, v27 offset0:0 offset1:4
    s_waitcnt lgkmcnt(2)
L_R_qgo_near:
    v_mfma_f32_16x16x32_bf16 v[100:103], v[68:71], v[28:31], 0
    v_bitop3_b32 v26, v28, v32, s12 bitop3:0x7e
    v_bitop3_b32 v22, v36, v40, s12 bitop3:0x7e
    v_mfma_f32_16x16x32_bf16 v[100:103], v[72:75], v[32:35], v[100:103]
    v_bitop3_b32 v26, v26, v22, 1 bitop3:0xa8
    v_cmp_ne_u32 vcc, 0, v26
    v_mfma_f32_16x16x32_bf16 v[100:103], v[76:79], v[36:39], v[100:103]
    s_cbranch_vccnz L_R_qfail_near
L_R_qok_near:
    buffer_load_dwordx4 v4, s[60:63], s9 offen sc1 lds
    v_mfma_f32_16x16x32_bf16 v[100:103], v[80:83], v[40:43], v[100:103]
    buffer_load_dwordx4 v4, s[60:63], s9 offen offset:1024 sc1 lds
    v_mfma_f32_16x16x32_bf16 v[104:107], v[84:87], v[28:31], 0
    ds_read_b128 v[68:71], v13 offset:2048
    s_nop 0
    v_mfma_f32_16x16x32_bf16 v[104:107], v[88:91], v[32:35], v[104:107]
    ds_read_b128 v[72:75], v13 offset:2560
    s_nop 0
    v_mfma_f32_16x16x32_bf16 v[104:107], v[92:95], v[36:39], v[104:107]
    ds_read_b128 v[76:79], v13 offset:3072
    v_exp_f32 v48, v100
    v_mfma_f32_16x16x32_bf16 v[104:107], v[96:99], v[40:43], v[104:107]
    ds_read_b128 v[80:83], v13 offset:3584
    v_exp_f32 v49, v101
    v_smfmac_f32_16x16x64_bf16 v[116:119], v[52:55], v[176:183], v6
    ds_read_b128 v[84:87], v16 offset:22528
    v_exp_f32 v50, v102
    v_smfmac_f32_16x16x64_bf16 v[120:123], v[52:55], v[184:191], v6
    ds_read_b128 v[88:91], v16 offset:26624
    v_exp_f32 v51, v103
    v_smfmac_f32_16x16x64_bf16 v[116:119], v[56:59], v[208:215], v6
    v_cvt_pk_bf16_f32 v112, v48, v49
    s_waitcnt lgkmcnt(2)
L_R_kgo_near:
    v_mfma_f32_16x16x32_bf16 v[108:111], v[68:71], v[28:31], 0
    v_bitop3_b32 v26, v68, v72, s12 bitop3:0x7e
    v_bitop3_b32 v22, v76, v80, s12 bitop3:0x7e
    v_mfma_f32_16x16x32_bf16 v[108:111], v[72:75], v[32:35], v[108:111]
    v_bitop3_b32 v26, v26, v22, 1 bitop3:0xa8
    v_cmp_ne_u32 vcc, 0, v26
    v_mfma_f32_16x16x32_bf16 v[108:111], v[76:79], v[36:39], v[108:111]
    s_cbranch_vccnz L_R_kfail_near
L_R_kok_near:
    v_exp_f32 v48, v104
    v_mfma_f32_16x16x32_bf16 v[108:111], v[80:83], v[40:43], v[108:111]
    v_exp_f32 v49, v105
    v_smfmac_f32_16x16x64_bf16 v[116:119], v[60:63], v[224:231], v6
    ds_read_b128 v[28:31], v12 offset:0
    v_cvt_pk_bf16_f32 v113, v50, v51
    v_smfmac_f32_16x16x64_bf16 v[116:119], v[64:67], v[240:247], v6
    ds_read_b128 v[32:35], v12 offset:1024
    v_exp_f32 v26, v106
    v_smfmac_f32_16x16x64_bf16 v[120:123], v[56:59], v[216:223], v6
    ds_read_b128 v[36:39], v12 offset:2048
    v_exp_f32 v27, v107
    v_smfmac_f32_16x16x64_bf16 v[120:123], v[60:63], v[232:239], v6
    ds_read_b128 v[40:43], v12 offset:3072
    v_exp_f32 v50, v108
    v_smfmac_f32_16x16x64_bf16 v[120:123], v[64:67], v[248:255], v6
    ds_read_b128 v[68:71], v12 offset:4096
    v_exp_f32 v51, v109
    v_cvt_pk_bf16_f32 v114, v48, v49
    v_cvt_pk_bf16_f32 v115, v26, v27
    v_add_f32 v116, v116, v118
    s_waitcnt lgkmcnt(5)
    v_mfma_f32_16x16x32_bf16 v[52:55], v[44:47], v[112:115], 0
    ds_read_b128 v[72:75], v12 offset:5120
    v_cvt_pk_bf16_f32 v22, v50, v51
    v_add_f32 v117, v117, v119
    v_mfma_f32_16x16x32_bf16 v[92:95], v[84:87], v[112:115], 0
    ds_read_b128 v[56:59], v7 offset:30720
    v_cvt_pk_bf16_f32 v25, v50, v51
    v_cvt_pk_bf16_f32 v126, v116, v117
    v_mfma_f32_16x16x32_bf16 v[96:99], v[88:91], v[112:115], 0
    ds_read_b128 v[60:63], v7 offset:30720
    v_add_f32 v120, v120, v122
    v_add_f32 v121, v121, v123
    v_mfma_f32_16x16x16_bf16 v[52:55], v[44:45], v[22:23], v[52:55]
    v_cvt_pk_bf16_f32 v127, v120, v121
    s_nop 0
    s_nop 0
    v_mfma_f32_16x16x16_bf16 v[92:95], v[126:127], v[22:23], v[92:95]
    ds_read_b128 v[64:67], v7 offset:30720
    ds_read_b128 v[76:79], v12 offset:6144
    s_add_u32 s9, s69, s67
    v_mfma_f32_16x16x16_bf16 v[96:99], v[126:127], v[24:25], v[96:99]
    ds_read_b128 v[80:83], v12 offset:7168
    v_rcp_f32 v26, v52
    ds_read_b128 v[48:51], v7 offset:30720
    v_max_f32 v27, v26, v52
    v_cmp_nge_f32 vcc, s71, v27
    s_cbranch_vccnz L_R_resc_near
L_R_rescdone_near:
    v_pk_mul_f32 v[92:93], v[92:93], v[26:27] op_sel_hi:[1,0]
    v_pk_mul_f32 v[94:95], v[94:95], v[26:27] op_sel_hi:[1,0]
    v_pk_mul_f32 v[96:97], v[96:97], v[26:27] op_sel_hi:[1,0]
    v_pk_mul_f32 v[98:99], v[98:99], v[26:27] op_sel_hi:[1,0]
    v_cvt_pk_bf16_f32 v22, v92, v96
    v_cvt_pk_bf16_f32 v23, v93, v97
    v_cvt_pk_bf16_f32 v24, v94, v98
    v_cvt_pk_bf16_f32 v25, v95, v99
    s_waitcnt lgkmcnt(0)
    ds_write_b128 v15, v[22:25]
    v_smfmac_f32_16x16x64_bf16 v[56:59], v[22:25], v[28:35], v6
    s_add_u32 s9, s9, 8192
    s_mov_b32 m0, s15
    v_xor_b32 v26, 1024, v15
    v_smfmac_f32_16x16x64_bf16 v[60:63], v[22:25], v[36:43], v6
    s_mov_b32 s10, s73
    v_xor_b32 v27, 1536, v15
    v_smfmac_f32_16x16x64_bf16 v[64:67], v[22:25], v[68:75], v6
    buffer_load_dwordx4 v4, s[60:63], s9 offen sc1 lds
    s_add_u32 s9, s9, 4096
    v_smfmac_f32_16x16x64_bf16 v[48:51], v[22:25], v[76:83], v6
    s_add_u32 m0, s15, 4096
    s_waitcnt lgkmcnt(0)
    s_barrier
    ds_read_b128 v[116:119], v14 offset:0
    ds_read_b128 v[120:123], v26 offset:0
    ds_read_b128 v[100:103], v27 offset:0
    buffer_load_dwordx4 v4, s[60:63], s9 offen sc1 lds
    s_add_u32 s69, s69, 524288
    ds_read_b128 v[28:31], v12 offset:24576
    ds_read_b128 v[32:35], v12 offset:25600
    s_waitcnt lgkmcnt(4)
    v_smfmac_f32_16x16x64_bf16 v[56:59], v[116:119], a[0:7], v6
    ds_read_b128 v[36:39], v12 offset:26624
    s_waitcnt lgkmcnt(4)
    v_smfmac_f32_16x16x64_bf16 v[56:59], v[120:123], a[8:15], v6
    ds_read_b128 v[40:43], v12 offset:27648
    s_waitcnt lgkmcnt(4)
    v_smfmac_f32_16x16x64_bf16 v[56:59], v[100:103], a[64:71], v6
    ds_read_b128 v[68:71], v12 offset:28672
    s_nop 0
    s_nop 0
    v_smfmac_f32_16x16x64_bf16 v[60:63], v[116:119], a[72:79], v6
    ds_read_b128 v[72:75], v12 offset:29696
    s_nop 0
    s_nop 0
    v_smfmac_f32_16x16x64_bf16 v[60:63], v[120:123], a[128:135], v6
    ds_read_b128 v[76:79], v12 offset:30720
    v_cvt_pk_bf16_f32 v108, v56, v58
    v_smfmac_f32_16x16x64_bf16 v[60:63], v[100:103], a[136:143], v6
    ds_read_b128 v[80:83], v12 offset:31744
    v_cvt_pk_bf16_f32 v109, v57, v59
    v_and_or_b32 v108, v108, -2, s13
    v_smfmac_f32_16x16x64_bf16 v[64:67], v[116:119], a[192:199], v6
    buffer_store_dwordx2 v[108:109], v8, s[60:63], s10 offen
    s_add_u32 s10, s10, 0x10000
    s_nop 0
    v_smfmac_f32_16x16x64_bf16 v[64:67], v[120:123], a[200:207], v6
    s_nop 0
    v_cvt_pk_bf16_f32 v110, v60, v62
    s_waitcnt lgkmcnt(6)
    v_smfmac_f32_16x16x64_bf16 v[64:67], v[100:103], v[28:35], v6
    v_cvt_pk_bf16_f32 v111, v61, v63
    v_and_or_b32 v110, v110, -2, s13
    s_waitcnt lgkmcnt(4)
    v_smfmac_f32_16x16x64_bf16 v[48:51], v[116:119], v[36:43], v6
    buffer_store_dwordx2 v[110:111], v8, s[60:63], s10 offen
    s_add_u32 s10, s10, 0x10000
    s_nop 0
    s_waitcnt lgkmcnt(2)
    v_smfmac_f32_16x16x64_bf16 v[48:51], v[120:123], v[68:75], v6
    s_nop 0
    v_cvt_pk_bf16_f32 v112, v64, v66
    s_waitcnt lgkmcnt(0)
    v_smfmac_f32_16x16x64_bf16 v[48:51], v[100:103], v[76:83], v6
    v_cvt_pk_bf16_f32 v113, v65, v67
    v_and_or_b32 v112, v112, -2, s13
    buffer_store_dwordx2 v[112:113], v8, s[60:63], s10 offen
    s_add_u32 s10, s10, 0x10000
    s_nop 3
    v_cvt_pk_bf16_f32 v114, v48, v50
    v_cvt_pk_bf16_f32 v115, v49, v51
    v_and_or_b32 v114, v114, -2, s13
    buffer_store_dwordx2 v[114:115], v8, s[60:63], s10 offen
L_R_comm_near:
    ds_read_b128 v[44:47], v12 offset:8192
    ds_read_b128 v[48:51], v12 offset:9216
    ds_read_b128 v[52:55], v12 offset:10240
    ds_read_b128 v[56:59], v12 offset:11264
    ds_read_b128 v[60:63], v12 offset:12288
    ds_read_b128 v[64:67], v12 offset:13312
    ds_read_b128 v[36:39], v12 offset:14336
    ds_read_b128 v[40:43], v12 offset:15360
    s_nop 15
    s_nop 15
    buffer_load_dword v100, v9, s[60:63], s73 offen offset:0 sc1
    buffer_load_dword v101, v9, s[60:63], s73 offen offset:256 sc1
    buffer_load_dword v102, v9, s[60:63], s73 offen offset:512 sc1
    buffer_load_dword v103, v9, s[60:63], s73 offen offset:768 sc1
    buffer_load_dword v104, v9, s[60:63], s73 offen offset:1024 sc1
    buffer_load_dword v105, v9, s[60:63], s73 offen offset:1280 sc1
    buffer_load_dword v106, v9, s[60:63], s73 offen offset:1536 sc1
    buffer_load_dword v107, v9, s[60:63], s73 offen offset:1792 sc1
    s_waitcnt lgkmcnt(6)
    ds_read_b128 v[68:71], v12 offset:16384
    ds_read_b128 v[72:75], v12 offset:17408
    ds_read_b128 v[76:79], v12 offset:18432
    ds_read_b128 v[80:83], v12 offset:19456
    ds_read_b128 v[84:87], v12 offset:20480
    ds_read_b128 v[88:91], v12 offset:21504
    ds_read_b128 v[92:95], v12 offset:22528
    ds_read_b128 v[96:99], v12 offset:23552
h1_18:
    s_waitcnt vmcnt(4)
    v_mfma_f32_16x16x32_bf16 v[108:111], v[0:3], v[100:103], 0
    v_bitop3_b32 v22, v100, v101, s13 bitop3:0x7e
    v_bitop3_b32 v23, v102, v103, s13 bitop3:0x7e
    s_waitcnt vmcnt(0)
    v_mfma_f32_16x16x32_bf16 v[108:111], v[0:3], v[104:107], v[108:111]
    v_bitop3_b32 v24, v104, v105, s13 bitop3:0x7e
    v_bitop3_b32 v25, v106, v107, s13 bitop3:0x7e
    v_or3_b32 v22, v22, v23, v24
    v_bitop3_b32 v22, v22, v25, 1 bitop3:0xa8
    v_cmp_ne_u32 vcc, 0, v22
    s_and_b64 vcc, vcc, s[64:65]
    s_cbranch_scc1 L_R_h1fail_near
L_R_h1go_near:
    s_nop 0
    v_cvt_pk_bf16_f32 v108, v108, v109
    buffer_store_dword v108, v10, s[60:63], s74 offen
    s_barrier
    s_nop 15
    s_nop 1
    buffer_load_dwordx4 v[28:31], v4, s[60:63], s11 offen sc1
    buffer_load_dwordx4 v[32:35], v4, s[60:63], s14 offen sc1
    s_add_u32 s68, s68, 1
    s_nop 15
    s_nop 3
    buffer_load_dwordx4 v[28:31], v4, s[60:63], s11 offen sc1
    buffer_load_dwordx4 v[32:35], v4, s[60:63], s14 offen sc1
    v_mov_b64 v[100:101], 0
    v_mov_b64 v[102:103], 0
    v_mov_b64 v[104:105], 0
    v_mov_b64 v[106:107], 0
    v_mov_b64 v[108:109], 0
    v_mov_b64 v[110:111], 0
    v_mov_b64 v[112:113], 0
    v_mov_b64 v[114:115], 0
    v_mov_b64 v[116:117], 0
    v_mov_b64 v[118:119], 0
    v_mov_b64 v[120:121], 0
    v_mov_b64 v[122:123], 0
    s_branch L_R_w_near
L_R_h2fail_near:
    s_mov_b64 exec, vcc
    buffer_load_dwordx4 v[28:31], v4, s[60:63], s11 offen sc1
    buffer_load_dwordx4 v[32:35], v4, s[60:63], s14 offen sc1
    s_mov_b64 exec, -1
    s_sub_u32 s8, s8, 1
    s_cbranch_scc0 L_R_w_near
    s_mov_b32 s8, 0
    s_waitcnt vmcnt(0)
    s_branch L_R_near
L_R_h1fail_near:
    s_lshl_b64 exec, vcc, 1
    s_or_b64 exec, vcc, exec
    buffer_load_dword v100, v9, s[60:63], s73 offen offset:0 sc1
    buffer_load_dword v101, v9, s[60:63], s73 offen offset:256 sc1
    buffer_load_dword v102, v9, s[60:63], s73 offen offset:512 sc1
    buffer_load_dword v103, v9, s[60:63], s73 offen offset:768 sc1
    buffer_load_dword v104, v9, s[60:63], s73 offen offset:1024 sc1
    buffer_load_dword v105, v9, s[60:63], s73 offen offset:1280 sc1
    buffer_load_dword v106, v9, s[60:63], s73 offen offset:1536 sc1
    buffer_load_dword v107, v9, s[60:63], s73 offen offset:1792 sc1
    s_mov_b64 exec, -1
    s_sub_u32 s8, s8, 1
    s_cbranch_scc0 h1_18
    s_mov_b32 s8, 0
    s_waitcnt vmcnt(0)
    s_branch L_R_h1go_near
L_R_qfail_near:
    s_waitcnt lgkmcnt(0)
    ds_read_b128 v[28:31], v13 offset:0
    ds_read_b128 v[36:39], v13 offset:1024
    ds_read_b128 v[32:35], v13 offset:512
    ds_read_b128 v[40:43], v13 offset:1536
    s_waitcnt lgkmcnt(0)
    s_sub_u32 s8, s8, 1
    s_cbranch_scc0 L_R_qgo_near
    s_mov_b32 s8, 0
    s_branch L_R_qok_near
L_R_kfail_near:
    s_waitcnt lgkmcnt(0)
    ds_read_b128 v[68:71], v13 offset:2048
    ds_read_b128 v[76:79], v13 offset:3072
    ds_read_b128 v[72:75], v13 offset:2560
    ds_read_b128 v[80:83], v13 offset:3584
    s_waitcnt lgkmcnt(0)
    s_sub_u32 s8, s8, 1
    s_cbranch_scc0 L_R_kgo_near
    s_mov_b32 s8, 0
    s_branch L_R_kok_near
L_R_kvslow_near:
wf_19:
    buffer_load_dword v21, v20, s[60:63], 0 offen sc1
    s_waitcnt vmcnt(0)
    v_cmp_gt_u32 vcc, s10, v21
    s_cbranch_vccz wfd_20
    s_sub_u32 s8, s8, 1
    s_cbranch_scc0 wf_19
    s_mov_b32 s8, 0
wfd_20:
    s_branch L_R_kvok_near
L_R_resc_near:
    v_max3_f32 v26, v100, v101, v102
    v_max3_f32 v27, v103, v104, v105
    v_max3_f32 v26, v26, v106, v107
    v_max3_f32 v27, v27, v108, v109
    v_max_f32 v26, v26, v27
    v_mov_b32 v27, v26
    s_nop 1
    v_permlane16_swap_b32 v26, v27
    v_max_f32 v26, v26, v27
    v_mov_b32 v27, v26
    s_nop 1
    v_permlane32_swap_b32 v26, v27
    v_max_f32 v26, v26, v27
    v_sub_f32 v100, v100, v26
    v_sub_f32 v101, v101, v26
    v_sub_f32 v102, v102, v26
    v_sub_f32 v103, v103, v26
    v_sub_f32 v104, v104, v26
    v_sub_f32 v105, v105, v26
    v_sub_f32 v106, v106, v26
    v_sub_f32 v107, v107, v26
    v_sub_f32 v108, v108, v26
    v_sub_f32 v109, v109, v26
    v_exp_f32 v100, v100
    v_exp_f32 v101, v101
    v_exp_f32 v102, v102
    v_exp_f32 v103, v103
    v_exp_f32 v104, v104
    v_exp_f32 v105, v105
    v_exp_f32 v106, v106
    v_exp_f32 v107, v107
    v_exp_f32 v108, v108
    v_exp_f32 v109, v109
    v_cvt_pk_bf16_f32 v112, v100, v101
    v_cvt_pk_bf16_f32 v113, v102, v103
    v_cvt_pk_bf16_f32 v114, v104, v105
    v_cvt_pk_bf16_f32 v115, v106, v107
    v_cvt_pk_bf16_f32 v22, v108, v109
    v_cvt_pk_bf16_f32 v25, v108, v109
    v_mfma_f32_16x16x32_bf16 v[52:55], v[44:47], v[112:115], 0
    v_mfma_f32_16x16x32_bf16 v[92:95], v[84:87], v[112:115], 0
    v_mfma_f32_16x16x32_bf16 v[96:99], v[88:91], v[112:115], 0
    s_nop 3
    v_mfma_f32_16x16x16_bf16 v[52:55], v[44:45], v[22:23], v[52:55]
    v_mfma_f32_16x16x16_bf16 v[92:95], v[126:127], v[22:23], v[92:95]
    v_mfma_f32_16x16x16_bf16 v[96:99], v[126:127], v[24:25], v[96:99]
    s_nop 7
    v_rcp_f32 v26, v52
    s_branch L_R_rescdone_near
L_R_w_far:
    s_waitcnt vmcnt(2) lgkmcnt(0)
    v_max3_u32 v22, v28, v29, v30
    v_max3_u32 v23, v31, v32, v33
    v_max3_u32 v22, v22, v34, v35
    v_max_u32 v22, v22, v23
    v_cmp_eq_u32 vcc, -1, v22
    s_cbranch_vccnz L_R_h2fail_far
L_R_far:
    ds_write_b128 v16, v[28:31]
    v_smfmac_f32_16x16x64_bf16 v[100:103], v[28:31], v[44:51], v6
    ds_write_b128 v16, v[32:35] offset:4096
    v_smfmac_f32_16x16x64_bf16 v[104:107], v[28:31], v[52:59], v6
    s_add_u32 s10, s68, 2
    v_cmp_gt_u32 vcc, s10, v21
    v_smfmac_f32_16x16x64_bf16 v[100:103], v[32:35], v[60:67], v6
    s_cbranch_vccnz L_R_kvslow_far
L_R_kvok_far:
    v_smfmac_f32_16x16x64_bf16 v[104:107], v[32:35], v[36:43], v6
    s_lshl_b32 s10, s67, 2
    s_add_u32 s10, s10, s69
    v_lshlrev_b32 v22, 2, v4
    v_smfmac_f32_16x16x64_bf16 v[108:111], v[28:31], v[68:75], v6
    v_smfmac_f32_16x16x64_bf16 v[112:115], v[28:31], v[76:83], v6
    s_waitcnt lgkmcnt(0)
    s_barrier
    ds_read_b128 v[44:47], v17 offset:0
    v_smfmac_f32_16x16x64_bf16 v[108:111], v[32:35], v[84:91], v6
    ds_read_b128 v[48:51], v18 offset:0
    buffer_load_dword v21, v22, s[60:63], s10 offen sc1
    v_smfmac_f32_16x16x64_bf16 v[112:115], v[32:35], v[92:99], v6
    ds_read_b128 v[52:55], v19 offset:0
    buffer_load_dword v21, v20, s[60:63], 0 offen sc1
    v_smfmac_f32_16x16x64_bf16 v[116:119], v[28:31], v[128:135], v6
    ds_read_b128 v[56:59], v17 offset:4096
    buffer_store_dwordx4 v[124:127], v4, s[60:63], s70 offen sc1
    s_mov_b32 s70, s72
    v_smfmac_f32_16x16x64_bf16 v[120:123], v[28:31], v[136:143], v6
    s_and_b32 s9, s68, 3
    s_xor_b32 s73, s73, 0x80000
    ds_read_b128 v[64:67], v19 offset:4096
    v_smfmac_f32_16x16x64_bf16 v[116:119], v[32:35], v[192:199], v6
    s_lshl_b32 s74, s9, 13
    s_add_u32 s74, s74, 6291456
    ds_read_b128 v[60:63], v18 offset:4096
    v_smfmac_f32_16x16x64_bf16 v[120:123], v[32:35], v[200:207], v6
    s_cmp_eq_u32 s68, 63
    s_cbranch_scc1 L_R_done
    s_waitcnt lgkmcnt(4)
    v_smfmac_f32_16x16x64_bf16 v[100:103], v[44:47], a[16:23], v6
    s_xor_b32 s75, s74, 0x4000
    ds_read_b128 v[68:71], v7 offset:14336
    v_smfmac_f32_16x16x64_bf16 v[100:103], v[48:51], a[32:39], v6
    s_add_u32 s72, s72, 0x20000
    ds_read_b128 v[72:75], v7 offset:15360
    s_waitcnt lgkmcnt(4)
    v_smfmac_f32_16x16x64_bf16 v[100:103], v[52:55], a[48:55], v6
    s_add_u32 s11, s74, s67
    ds_read_b128 v[76:79], v7 offset:16384
    v_smfmac_f32_16x16x64_bf16 v[100:103], v[56:59], a[80:87], v6
    ds_read_b128 v[80:83], v7 offset:17408
    s_waitcnt lgkmcnt(4)
    v_smfmac_f32_16x16x64_bf16 v[100:103], v[64:67], a[112:119], v6
    s_add_u32 s14, s11, 4096
    ds_read_b128 v[84:87], v7 offset:18432
    v_mov_b32 v22, -1
    v_smfmac_f32_16x16x64_bf16 v[100:103], v[60:63], a[96:103], v6
    s_bfe_u32 s13, s68, 0x10001
    ds_read_b128 v[88:91], v7 offset:19456
    v_smfmac_f32_16x16x64_bf16 v[104:107], v[44:47], a[24:31], v6
    buffer_store_dword v22, v10, s[60:63], s75 offen sc1
    v_smfmac_f32_16x16x64_bf16 v[104:107], v[48:51], a[40:47], v6
    ds_read_b128 v[92:95], v7 offset:20480
    v_mov_b32 v23, 0
    v_smfmac_f32_16x16x64_bf16 v[104:107], v[52:55], a[56:63], v6
    ds_read_b128 v[96:99], v7 offset:21504
    v_add_f32 v100, v100, v102
    v_smfmac_f32_16x16x64_bf16 v[104:107], v[56:59], a[88:95], v6
    v_add_f32 v101, v101, v103
    v_smfmac_f32_16x16x64_bf16 v[104:107], v[64:67], a[120:127], v6
    s_and_b32 s12, s68, 1
    v_mov_b32 v24, 0
    v_smfmac_f32_16x16x64_bf16 v[104:107], v[60:63], a[104:111], v6
    s_lshl_b32 s9, s67, 1
    s_add_u32 s9, s9, s69
    s_mov_b32 m0, s66
    v_smfmac_f32_16x16x64_bf16 v[108:111], v[44:47], a[144:151], v6
    s_waitcnt vmcnt(4)
    s_nop 0
    v_smfmac_f32_16x16x64_bf16 v[108:111], v[48:51], a[160:167], v6
    s_nop 0
    v_add_f32 v104, v104, v106
    v_add_f32 v105, v105, v107
    v_smfmac_f32_16x16x64_bf16 v[108:111], v[52:55], a[176:183], v6
    v_cvt_pk_bf16_f32 v100, v100, v104
    v_cvt_pk_bf16_f32 v101, v101, v105
    v_smfmac_f32_16x16x64_bf16 v[108:111], v[56:59], a[208:215], v6
    v_and_or_b32 v100, v100, -2, s12
    v_and_or_b32 v101, v101, -2, s12
    ds_write2_b32 v11, v100, v101 offset0:0 offset1:4
    v_smfmac_f32_16x16x64_bf16 v[108:111], v[60:63], a[224:231], v6
    v_smfmac_f32_16x16x64_bf16 v[108:111], v[64:67], a[240:247], v6
    v_smfmac_f32_16x16x64_bf16 v[112:115], v[44:47], a[152:159], v6
    v_smfmac_f32_16x16x64_bf16 v[112:115], v[48:51], a[168:175], v6
    s_nop 0
    s_nop 0
    v_smfmac_f32_16x16x64_bf16 v[112:115], v[52:55], a[184:191], v6
    ds_read_b128 v[28:31], v13 offset:0
    s_nop 0
    v_smfmac_f32_16x16x64_bf16 v[112:115], v[56:59], a[216:223], v6
    ds_read_b128 v[32:35], v13 offset:512
    v_add_f32 v108, v108, v110
    v_smfmac_f32_16x16x64_bf16 v[112:115], v[60:63], a[232:239], v6
    ds_read_b128 v[36:39], v13 offset:1024
    v_add_f32 v109, v109, v111
    v_smfmac_f32_16x16x64_bf16 v[112:115], v[64:67], a[248:255], v6
    ds_read_b128 v[40:43], v13 offset:1536
    s_nop 0
    s_nop 0
    v_smfmac_f32_16x16x64_bf16 v[116:119], v[44:47], v[144:151], v6
    s_nop 0
    s_nop 0
    v_smfmac_f32_16x16x64_bf16 v[120:123], v[44:47], v[152:159], v6
    s_nop 0
    v_add_f32 v112, v112, v114
    v_add_f32 v113, v113, v115
    v_smfmac_f32_16x16x64_bf16 v[116:119], v[48:51], v[160:167], v6
    ds_read_b128 v[44:47], v7 offset:31744
    v_cvt_pk_bf16_f32 v124, v108, v112
    v_cvt_pk_bf16_f32 v125, v109, v113
    v_smfmac_f32_16x16x64_bf16 v[120:123], v[48:51], v[168:175], v6
    v_and_or_b32 v22, v124, -2, s12
    v_and_or_b32 v27, v125, -2, s12
    ds_write2_b32 v5, v22, v27 offset0:0 offset1:4
    s_waitcnt lgkmcnt(2)
L_R_qgo_far:
    v_mfma_f32_16x16x32_bf16 v[100:103], v[68:71], v[28:31], 0
    v_bitop3_b32 v26, v28, v32, s12 bitop3:0x7e
    v_bitop3_b32 v22, v36, v40, s12 bitop3:0x7e
    v_mfma_f32_16x16x32_bf16 v[100:103], v[72:75], v[32:35], v[100:103]
    v_bitop3_b32 v26, v26, v22, 1 bitop3:0xa8
    v_cmp_ne_u32 vcc, 0, v26
    v_mfma_f32_16x16x32_bf16 v[100:103], v[76:79], v[36:39], v[100:103]
    s_cbranch_vccnz L_R_qfail_far
L_R_qok_far:
    buffer_load_dwordx4 v4, s[60:63], s9 offen sc1 lds
    v_mfma_f32_16x16x32_bf16 v[100:103], v[80:83], v[40:43], v[100:103]
    buffer_load_dwordx4 v4, s[60:63], s9 offen offset:1024 sc1 lds
    v_mfma_f32_16x16x32_bf16 v[104:107], v[84:87], v[28:31], 0
    ds_read_b128 v[68:71], v13 offset:2048
    s_nop 0
    v_mfma_f32_16x16x32_bf16 v[104:107], v[88:91], v[32:35], v[104:107]
    ds_read_b128 v[72:75], v13 offset:2560
    s_nop 0
    v_mfma_f32_16x16x32_bf16 v[104:107], v[92:95], v[36:39], v[104:107]
    ds_read_b128 v[76:79], v13 offset:3072
    v_exp_f32 v48, v100
    v_mfma_f32_16x16x32_bf16 v[104:107], v[96:99], v[40:43], v[104:107]
    ds_read_b128 v[80:83], v13 offset:3584
    v_exp_f32 v49, v101
    v_smfmac_f32_16x16x64_bf16 v[116:119], v[52:55], v[176:183], v6
    ds_read_b128 v[84:87], v16 offset:22528
    v_exp_f32 v50, v102
    v_smfmac_f32_16x16x64_bf16 v[120:123], v[52:55], v[184:191], v6
    ds_read_b128 v[88:91], v16 offset:26624
    v_exp_f32 v51, v103
    v_smfmac_f32_16x16x64_bf16 v[116:119], v[56:59], v[208:215], v6
    v_cvt_pk_bf16_f32 v112, v48, v49
    s_waitcnt lgkmcnt(2)
L_R_kgo_far:
    v_mfma_f32_16x16x32_bf16 v[108:111], v[68:71], v[28:31], 0
    v_bitop3_b32 v26, v68, v72, s12 bitop3:0x7e
    v_bitop3_b32 v22, v76, v80, s12 bitop3:0x7e
    v_mfma_f32_16x16x32_bf16 v[108:111], v[72:75], v[32:35], v[108:111]
    v_bitop3_b32 v26, v26, v22, 1 bitop3:0xa8
    v_cmp_ne_u32 vcc, 0, v26
    v_mfma_f32_16x16x32_bf16 v[108:111], v[76:79], v[36:39], v[108:111]
    s_cbranch_vccnz L_R_kfail_far
L_R_kok_far:
    v_exp_f32 v48, v104
    v_mfma_f32_16x16x32_bf16 v[108:111], v[80:83], v[40:43], v[108:111]
    v_exp_f32 v49, v105
    v_smfmac_f32_16x16x64_bf16 v[116:119], v[60:63], v[224:231], v6
    ds_read_b128 v[28:31], v12 offset:0
    v_cvt_pk_bf16_f32 v113, v50, v51
    v_smfmac_f32_16x16x64_bf16 v[116:119], v[64:67], v[240:247], v6
    ds_read_b128 v[32:35], v12 offset:1024
    v_exp_f32 v26, v106
    v_smfmac_f32_16x16x64_bf16 v[120:123], v[56:59], v[216:223], v6
    ds_read_b128 v[36:39], v12 offset:2048
    v_exp_f32 v27, v107
    v_smfmac_f32_16x16x64_bf16 v[120:123], v[60:63], v[232:239], v6
    ds_read_b128 v[40:43], v12 offset:3072
    v_exp_f32 v50, v108
    v_smfmac_f32_16x16x64_bf16 v[120:123], v[64:67], v[248:255], v6
    ds_read_b128 v[68:71], v12 offset:4096
    v_exp_f32 v51, v109
    v_cvt_pk_bf16_f32 v114, v48, v49
    v_cvt_pk_bf16_f32 v115, v26, v27
    v_add_f32 v116, v116, v118
    s_waitcnt lgkmcnt(5)
    v_mfma_f32_16x16x32_bf16 v[52:55], v[44:47], v[112:115], 0
    ds_read_b128 v[72:75], v12 offset:5120
    v_cvt_pk_bf16_f32 v22, v50, v51
    v_add_f32 v117, v117, v119
    v_mfma_f32_16x16x32_bf16 v[92:95], v[84:87], v[112:115], 0
    ds_read_b128 v[56:59], v7 offset:30720
    v_cvt_pk_bf16_f32 v25, v50, v51
    v_cvt_pk_bf16_f32 v126, v116, v117
    v_mfma_f32_16x16x32_bf16 v[96:99], v[88:91], v[112:115], 0
    ds_read_b128 v[60:63], v7 offset:30720
    v_add_f32 v120, v120, v122
    v_add_f32 v121, v121, v123
    v_mfma_f32_16x16x16_bf16 v[52:55], v[44:45], v[22:23], v[52:55]
    v_cvt_pk_bf16_f32 v127, v120, v121
    s_nop 0
    s_nop 0
    v_mfma_f32_16x16x16_bf16 v[92:95], v[126:127], v[22:23], v[92:95]
    ds_read_b128 v[64:67], v7 offset:30720
    ds_read_b128 v[76:79], v12 offset:6144
    s_add_u32 s9, s69, s67
    v_mfma_f32_16x16x16_bf16 v[96:99], v[126:127], v[24:25], v[96:99]
    ds_read_b128 v[80:83], v12 offset:7168
    v_rcp_f32 v26, v52
    ds_read_b128 v[48:51], v7 offset:30720
    v_max_f32 v27, v26, v52
    v_cmp_nge_f32 vcc, s71, v27
    s_cbranch_vccnz L_R_resc_far
L_R_rescdone_far:
    v_pk_mul_f32 v[92:93], v[92:93], v[26:27] op_sel_hi:[1,0]
    v_pk_mul_f32 v[94:95], v[94:95], v[26:27] op_sel_hi:[1,0]
    v_pk_mul_f32 v[96:97], v[96:97], v[26:27] op_sel_hi:[1,0]
    v_pk_mul_f32 v[98:99], v[98:99], v[26:27] op_sel_hi:[1,0]
    v_cvt_pk_bf16_f32 v22, v92, v96
    v_cvt_pk_bf16_f32 v23, v93, v97
    v_cvt_pk_bf16_f32 v24, v94, v98
    v_cvt_pk_bf16_f32 v25, v95, v99
    s_waitcnt lgkmcnt(0)
    ds_write_b128 v15, v[22:25]
    v_smfmac_f32_16x16x64_bf16 v[56:59], v[22:25], v[28:35], v6
    s_add_u32 s9, s9, 8192
    s_mov_b32 m0, s15
    v_xor_b32 v26, 1024, v15
    v_smfmac_f32_16x16x64_bf16 v[60:63], v[22:25], v[36:43], v6
    s_mov_b32 s10, s73
    v_xor_b32 v27, 1536, v15
    v_smfmac_f32_16x16x64_bf16 v[64:67], v[22:25], v[68:75], v6
    buffer_load_dwordx4 v4, s[60:63], s9 offen sc1 lds
    s_add_u32 s9, s9, 4096
    v_smfmac_f32_16x16x64_bf16 v[48:51], v[22:25], v[76:83], v6
    s_add_u32 m0, s15, 4096
    s_waitcnt lgkmcnt(0)
    s_barrier
    ds_read_b128 v[116:119], v14 offset:0
    ds_read_b128 v[120:123], v26 offset:0
    ds_read_b128 v[100:103], v27 offset:0
    buffer_load_dwordx4 v4, s[60:63], s9 offen sc1 lds
    s_add_u32 s69, s69, 524288
    ds_read_b128 v[28:31], v12 offset:24576
    ds_read_b128 v[32:35], v12 offset:25600
    s_waitcnt lgkmcnt(4)
    v_smfmac_f32_16x16x64_bf16 v[56:59], v[116:119], a[0:7], v6
    ds_read_b128 v[36:39], v12 offset:26624
    s_waitcnt lgkmcnt(4)
    v_smfmac_f32_16x16x64_bf16 v[56:59], v[120:123], a[8:15], v6
    ds_read_b128 v[40:43], v12 offset:27648
    s_waitcnt lgkmcnt(4)
    v_smfmac_f32_16x16x64_bf16 v[56:59], v[100:103], a[64:71], v6
    ds_read_b128 v[68:71], v12 offset:28672
    s_nop 0
    s_nop 0
    v_smfmac_f32_16x16x64_bf16 v[60:63], v[116:119], a[72:79], v6
    ds_read_b128 v[72:75], v12 offset:29696
    s_nop 0
    s_nop 0
    v_smfmac_f32_16x16x64_bf16 v[60:63], v[120:123], a[128:135], v6
    ds_read_b128 v[76:79], v12 offset:30720
    v_cvt_pk_bf16_f32 v108, v56, v58
    v_smfmac_f32_16x16x64_bf16 v[60:63], v[100:103], a[136:143], v6
    ds_read_b128 v[80:83], v12 offset:31744
    v_cvt_pk_bf16_f32 v109, v57, v59
    v_and_or_b32 v108, v108, -2, s13
    v_smfmac_f32_16x16x64_bf16 v[64:67], v[116:119], a[192:199], v6
    buffer_store_dwordx2 v[108:109], v8, s[60:63], s10 offen sc1
    s_add_u32 s10, s10, 0x10000
    s_nop 0
    v_smfmac_f32_16x16x64_bf16 v[64:67], v[120:123], a[200:207], v6
    s_nop 0
    v_cvt_pk_bf16_f32 v110, v60, v62
    s_waitcnt lgkmcnt(6)
    v_smfmac_f32_16x16x64_bf16 v[64:67], v[100:103], v[28:35], v6
    v_cvt_pk_bf16_f32 v111, v61, v63
    v_and_or_b32 v110, v110, -2, s13
    s_waitcnt lgkmcnt(4)
    v_smfmac_f32_16x16x64_bf16 v[48:51], v[116:119], v[36:43], v6
    buffer_store_dwordx2 v[110:111], v8, s[60:63], s10 offen sc1
    s_add_u32 s10, s10, 0x10000
    s_nop 0
    s_waitcnt lgkmcnt(2)
    v_smfmac_f32_16x16x64_bf16 v[48:51], v[120:123], v[68:75], v6
    s_nop 0
    v_cvt_pk_bf16_f32 v112, v64, v66
    s_waitcnt lgkmcnt(0)
    v_smfmac_f32_16x16x64_bf16 v[48:51], v[100:103], v[76:83], v6
    v_cvt_pk_bf16_f32 v113, v65, v67
    v_and_or_b32 v112, v112, -2, s13
    buffer_store_dwordx2 v[112:113], v8, s[60:63], s10 offen sc1
    s_add_u32 s10, s10, 0x10000
    s_nop 3
    v_cvt_pk_bf16_f32 v114, v48, v50
    v_cvt_pk_bf16_f32 v115, v49, v51
    v_and_or_b32 v114, v114, -2, s13
    buffer_store_dwordx2 v[114:115], v8, s[60:63], s10 offen sc1
L_R_comm_far:
    ds_read_b128 v[44:47], v12 offset:8192
    ds_read_b128 v[48:51], v12 offset:9216
    ds_read_b128 v[52:55], v12 offset:10240
    ds_read_b128 v[56:59], v12 offset:11264
    ds_read_b128 v[60:63], v12 offset:12288
    ds_read_b128 v[64:67], v12 offset:13312
    ds_read_b128 v[36:39], v12 offset:14336
    ds_read_b128 v[40:43], v12 offset:15360
    s_nop 15
    s_nop 15
    buffer_load_dword v100, v9, s[60:63], s73 offen offset:0 sc1
    buffer_load_dword v101, v9, s[60:63], s73 offen offset:256 sc1
    buffer_load_dword v102, v9, s[60:63], s73 offen offset:512 sc1
    buffer_load_dword v103, v9, s[60:63], s73 offen offset:768 sc1
    buffer_load_dword v104, v9, s[60:63], s73 offen offset:1024 sc1
    buffer_load_dword v105, v9, s[60:63], s73 offen offset:1280 sc1
    buffer_load_dword v106, v9, s[60:63], s73 offen offset:1536 sc1
    buffer_load_dword v107, v9, s[60:63], s73 offen offset:1792 sc1
    s_waitcnt lgkmcnt(6)
    ds_read_b128 v[68:71], v12 offset:16384
    ds_read_b128 v[72:75], v12 offset:17408
    ds_read_b128 v[76:79], v12 offset:18432
    ds_read_b128 v[80:83], v12 offset:19456
    ds_read_b128 v[84:87], v12 offset:20480
    ds_read_b128 v[88:91], v12 offset:21504
    ds_read_b128 v[92:95], v12 offset:22528
    ds_read_b128 v[96:99], v12 offset:23552
h1_21:
    s_waitcnt vmcnt(4)
    v_mfma_f32_16x16x32_bf16 v[108:111], v[0:3], v[100:103], 0
    v_bitop3_b32 v22, v100, v101, s13 bitop3:0x7e
    v_bitop3_b32 v23, v102, v103, s13 bitop3:0x7e
    s_waitcnt vmcnt(0)
    v_mfma_f32_16x16x32_bf16 v[108:111], v[0:3], v[104:107], v[108:111]
    v_bitop3_b32 v24, v104, v105, s13 bitop3:0x7e
    v_bitop3_b32 v25, v106, v107, s13 bitop3:0x7e
    v_or3_b32 v22, v22, v23, v24
    v_bitop3_b32 v22, v22, v25, 1 bitop3:0xa8
    v_cmp_ne_u32 vcc, 0, v22
    s_and_b64 vcc, vcc, s[64:65]
    s_cbranch_scc1 L_R_h1fail_far
L_R_h1go_far:
    s_nop 0
    v_cvt_pk_bf16_f32 v108, v108, v109
    buffer_store_dword v108, v10, s[60:63], s74 offen sc1
    s_barrier
    s_nop 15
    s_nop 1
    buffer_load_dwordx4 v[28:31], v4, s[60:63], s11 offen sc1
    buffer_load_dwordx4 v[32:35], v4, s[60:63], s14 offen sc1
    s_add_u32 s68, s68, 1
    s_nop 15
    s_nop 3
    buffer_load_dwordx4 v[28:31], v4, s[60:63], s11 offen sc1
    buffer_load_dwordx4 v[32:35], v4, s[60:63], s14 offen sc1
    v_mov_b64 v[100:101], 0
    v_mov_b64 v[102:103], 0
    v_mov_b64 v[104:105], 0
    v_mov_b64 v[106:107], 0
    v_mov_b64 v[108:109], 0
    v_mov_b64 v[110:111], 0
    v_mov_b64 v[112:113], 0
    v_mov_b64 v[114:115], 0
    v_mov_b64 v[116:117], 0
    v_mov_b64 v[118:119], 0
    v_mov_b64 v[120:121], 0
    v_mov_b64 v[122:123], 0
    s_branch L_R_w_far
L_R_h2fail_far:
    s_mov_b64 exec, vcc
    buffer_load_dwordx4 v[28:31], v4, s[60:63], s11 offen sc1
    buffer_load_dwordx4 v[32:35], v4, s[60:63], s14 offen sc1
    s_mov_b64 exec, -1
    s_sub_u32 s8, s8, 1
    s_cbranch_scc0 L_R_w_far
    s_mov_b32 s8, 0
    s_waitcnt vmcnt(0)
    s_branch L_R_far
L_R_h1fail_far:
    s_lshl_b64 exec, vcc, 1
    s_or_b64 exec, vcc, exec
    buffer_load_dword v100, v9, s[60:63], s73 offen offset:0 sc1
    buffer_load_dword v101, v9, s[60:63], s73 offen offset:256 sc1
    buffer_load_dword v102, v9, s[60:63], s73 offen offset:512 sc1
    buffer_load_dword v103, v9, s[60:63], s73 offen offset:768 sc1
    buffer_load_dword v104, v9, s[60:63], s73 offen offset:1024 sc1
    buffer_load_dword v105, v9, s[60:63], s73 offen offset:1280 sc1
    buffer_load_dword v106, v9, s[60:63], s73 offen offset:1536 sc1
    buffer_load_dword v107, v9, s[60:63], s73 offen offset:1792 sc1
    s_mov_b64 exec, -1
    s_sub_u32 s8, s8, 1
    s_cbranch_scc0 h1_21
    s_mov_b32 s8, 0
    s_waitcnt vmcnt(0)
    s_branch L_R_h1go_far
L_R_qfail_far:
    s_waitcnt lgkmcnt(0)
    ds_read_b128 v[28:31], v13 offset:0
    ds_read_b128 v[36:39], v13 offset:1024
    ds_read_b128 v[32:35], v13 offset:512
    ds_read_b128 v[40:43], v13 offset:1536
    s_waitcnt lgkmcnt(0)
    s_sub_u32 s8, s8, 1
    s_cbranch_scc0 L_R_qgo_far
    s_mov_b32 s8, 0
    s_branch L_R_qok_far
L_R_kfail_far:
    s_waitcnt lgkmcnt(0)
    ds_read_b128 v[68:71], v13 offset:2048
    ds_read_b128 v[76:79], v13 offset:3072
    ds_read_b128 v[72:75], v13 offset:2560
    ds_read_b128 v[80:83], v13 offset:3584
    s_waitcnt lgkmcnt(0)
    s_sub_u32 s8, s8, 1
    s_cbranch_scc0 L_R_kgo_far
    s_mov_b32 s8, 0
    s_branch L_R_kok_far
L_R_kvslow_far:
wf_22:
    buffer_load_dword v21, v20, s[60:63], 0 offen sc1
    s_waitcnt vmcnt(0)
    v_cmp_gt_u32 vcc, s10, v21
    s_cbranch_vccz wfd_23
    s_sub_u32 s8, s8, 1
    s_cbranch_scc0 wf_22
    s_mov_b32 s8, 0
wfd_23:
    s_branch L_R_kvok_far
L_R_resc_far:
    v_max3_f32 v26, v100, v101, v102
    v_max3_f32 v27, v103, v104, v105
    v_max3_f32 v26, v26, v106, v107
    v_max3_f32 v27, v27, v108, v109
    v_max_f32 v26, v26, v27
    v_mov_b32 v27, v26
    s_nop 1
    v_permlane16_swap_b32 v26, v27
    v_max_f32 v26, v26, v27
    v_mov_b32 v27, v26
    s_nop 1
    v_permlane32_swap_b32 v26, v27
    v_max_f32 v26, v26, v27
    v_sub_f32 v100, v100, v26
    v_sub_f32 v101, v101, v26
    v_sub_f32 v102, v102, v26
    v_sub_f32 v103, v103, v26
    v_sub_f32 v104, v104, v26
    v_sub_f32 v105, v105, v26
    v_sub_f32 v106, v106, v26
    v_sub_f32 v107, v107, v26
    v_sub_f32 v108, v108, v26
    v_sub_f32 v109, v109, v26
    v_exp_f32 v100, v100
    v_exp_f32 v101, v101
    v_exp_f32 v102, v102
    v_exp_f32 v103, v103
    v_exp_f32 v104, v104
    v_exp_f32 v105, v105
    v_exp_f32 v106, v106
    v_exp_f32 v107, v107
    v_exp_f32 v108, v108
    v_exp_f32 v109, v109
    v_cvt_pk_bf16_f32 v112, v100, v101
    v_cvt_pk_bf16_f32 v113, v102, v103
    v_cvt_pk_bf16_f32 v114, v104, v105
    v_cvt_pk_bf16_f32 v115, v106, v107
    v_cvt_pk_bf16_f32 v22, v108, v109
    v_cvt_pk_bf16_f32 v25, v108, v109
    v_mfma_f32_16x16x32_bf16 v[52:55], v[44:47], v[112:115], 0
    v_mfma_f32_16x16x32_bf16 v[92:95], v[84:87], v[112:115], 0
    v_mfma_f32_16x16x32_bf16 v[96:99], v[88:91], v[112:115], 0
    s_nop 3
    v_mfma_f32_16x16x16_bf16 v[52:55], v[44:45], v[22:23], v[52:55]
    v_mfma_f32_16x16x16_bf16 v[92:95], v[126:127], v[22:23], v[92:95]
    v_mfma_f32_16x16x16_bf16 v[96:99], v[126:127], v[24:25], v[96:99]
    s_nop 7
    v_rcp_f32 v26, v52
    s_branch L_R_rescdone_far
L_R_done:
    s_waitcnt lgkmcnt(0)
    v_smfmac_f32_16x16x64_bf16 v[108:111], v[44:47], a[144:151], v6
    v_smfmac_f32_16x16x64_bf16 v[112:115], v[44:47], a[152:159], v6
    v_smfmac_f32_16x16x64_bf16 v[108:111], v[48:51], a[160:167], v6
    v_smfmac_f32_16x16x64_bf16 v[112:115], v[48:51], a[168:175], v6
    v_smfmac_f32_16x16x64_bf16 v[108:111], v[52:55], a[176:183], v6
    v_smfmac_f32_16x16x64_bf16 v[112:115], v[52:55], a[184:191], v6
    v_smfmac_f32_16x16x64_bf16 v[108:111], v[56:59], a[208:215], v6
    v_smfmac_f32_16x16x64_bf16 v[112:115], v[56:59], a[216:223], v6
    v_smfmac_f32_16x16x64_bf16 v[108:111], v[60:63], a[224:231], v6
    v_smfmac_f32_16x16x64_bf16 v[112:115], v[60:63], a[232:239], v6
    v_smfmac_f32_16x16x64_bf16 v[108:111], v[64:67], a[240:247], v6
    v_smfmac_f32_16x16x64_bf16 v[112:115], v[64:67], a[248:255], v6
    v_smfmac_f32_16x16x64_bf16 v[116:119], v[44:47], v[144:151], v6
    v_smfmac_f32_16x16x64_bf16 v[120:123], v[44:47], v[152:159], v6
    v_smfmac_f32_16x16x64_bf16 v[116:119], v[48:51], v[160:167], v6
    v_smfmac_f32_16x16x64_bf16 v[120:123], v[48:51], v[168:175], v6
    v_smfmac_f32_16x16x64_bf16 v[116:119], v[52:55], v[176:183], v6
    v_smfmac_f32_16x16x64_bf16 v[120:123], v[52:55], v[184:191], v6
    v_smfmac_f32_16x16x64_bf16 v[116:119], v[56:59], v[208:215], v6
    v_smfmac_f32_16x16x64_bf16 v[120:123], v[56:59], v[216:223], v6
    v_smfmac_f32_16x16x64_bf16 v[116:119], v[60:63], v[224:231], v6
    v_smfmac_f32_16x16x64_bf16 v[120:123], v[60:63], v[232:239], v6
    v_smfmac_f32_16x16x64_bf16 v[116:119], v[64:67], v[240:247], v6
    v_smfmac_f32_16x16x64_bf16 v[120:123], v[64:67], v[248:255], v6
    v_add_f32 v108, v108, v110
    v_add_f32 v109, v109, v111
    v_add_f32 v112, v112, v114
    v_add_f32 v113, v113, v115
    s_nop 2
    v_add_f32 v116, v116, v118
    v_add_f32 v117, v117, v119
    v_add_f32 v120, v120, v122
    v_add_f32 v121, v121, v123
    v_cvt_pk_bf16_f32 v124, v108, v112
    v_cvt_pk_bf16_f32 v125, v109, v113
    v_cvt_pk_bf16_f32 v126, v116, v117
    v_cvt_pk_bf16_f32 v127, v120, v121
    buffer_store_dwordx4 v[124:127], v4, s[60:63], s70 offen sc1
    s_endpgm
L_role_AT:
    s_waitcnt vmcnt(0)
    s_barrier
    s_cmp_lg_u32 s3, 0
    s_cbranch_scc1 pt_24
    s_or_b32 s9, s6, 128
    s_and_b32 s10, s5, 3
    s_lshl_b32 s10, s10, 3
    s_lshl_b32 s9, s9, s10
    v_mov_b32 v6, s9
    s_lshl_b32 s10, s4, 5
    s_and_b32 s11, s5, 0x1c
    s_add_u32 s10, s10, s11
    s_mov_b64 exec, 1
    buffer_atomic_or v6, off, s[56:59], s10 sc1
    s_mov_b64 exec, -1
pt_24:
    s_sub_u32 s64, s4, 3
    s_lshl_b32 s65, s64, 9
    s_lshl_b32 s9, s5, 4
    s_add_u32 s65, s65, s9
    s_lshl_b32 s9, s3, 2
    s_add_u32 s65, s65, s9
    s_add_u32 s65, s65, 6889472
    v_mov_b32 v6, 0
    s_mov_b64 exec, 1
    buffer_store_dword v6, off, s[60:63], s65 sc1
    s_mov_b64 exec, -1
    s_lshl_b32 s66, s5, 7
    s_lshl_b32 s10, s64, 4
    s_add_u32 s66, s66, s10
    s_add_u32 s66, s66, s9
    s_add_u32 s66, s66, 6881312
    v_mov_b32 v6, 20
    s_mov_b64 exec, 1
    buffer_store_dword v6, off, s[60:63], s66 sc1
    s_mov_b64 exec, -1
    v_mov_b32 v8, -1
    v_mov_b32 v9, -1
    v_mov_b32 v10, -1
    v_mov_b32 v11, -1
    s_lshl_b32 s9, s64, 5
    s_add_u32 s9, s9, s5
    s_lshl_b32 s70, s9, 12
    s_lshl_b32 s11, s3, 10
    s_add_u32 s70, s70, s11
    s_add_u32 s70, s70, 44040192
    s_mov_b32 s15, s9
    s_add_u32 s10, s70, 0
    buffer_store_dwordx4 v[8:11], v4, s[60:63], s10 offen sc1
    s_add_u32 s10, s10, 0x60000
    buffer_store_dwordx4 v[8:11], v4, s[60:63], s10 offen sc1
    s_add_u32 s10, s10, 0x60000
    buffer_store_dwordx4 v[8:11], v4, s[60:63], s10 offen sc1
    s_add_u32 s10, s10, 0x60000
    buffer_store_dwordx4 v[8:11], v4, s[60:63], s10 offen sc1
    s_add_u32 s10, s10, 0x60000
    buffer_store_dwordx4 v[8:11], v4, s[60:63], s10 offen sc1
    s_add_u32 s10, s10, 0x60000
    buffer_store_dwordx4 v[8:11], v4, s[60:63], s10 offen sc1
    s_add_u32 s10, s10, 0x60000
    buffer_store_dwordx4 v[8:11], v4, s[60:63], s10 offen sc1
    s_add_u32 s10, s10, 0x60000
    buffer_store_dwordx4 v[8:11], v4, s[60:63], s10 offen sc1
    s_add_u32 s10, s10, 0x60000
    s_mul_i32 s10, s3, 96
    s_add_u32 s10, s10, s15
    s_add_u32 s10, s10, 0
    s_cmp_ge_u32 s10, 2048
    s_cbranch_scc1 atc_25
    s_lshl_b32 s11, s10, 10
    s_add_u32 s9, s11, 54525952
    buffer_store_dwordx4 v[8:11], v4, s[60:63], s9 offen sc1
    s_add_u32 s9, s11, 4194304
    buffer_store_dwordx4 v[8:11], v4, s[60:63], s9 offen sc1
atc_25:
    s_add_u32 s10, s10, 384
    s_cmp_ge_u32 s10, 2048
    s_cbranch_scc1 atc_26
    s_lshl_b32 s11, s10, 10
    s_add_u32 s9, s11, 54525952
    buffer_store_dwordx4 v[8:11], v4, s[60:63], s9 offen sc1
    s_add_u32 s9, s11, 4194304
    buffer_store_dwordx4 v[8:11], v4, s[60:63], s9 offen sc1
atc_26:
    s_add_u32 s10, s10, 384
    s_waitcnt vmcnt(0)
    s_barrier
    s_cmp_lg_u32 s3, 0
    s_cbranch_scc1 pt_27
    s_mov_b32 s9, 0x40
    s_and_b32 s10, s5, 3
    s_lshl_b32 s10, s10, 3
    s_lshl_b32 s9, s9, s10
    v_mov_b32 v6, s9
    s_lshl_b32 s10, s4, 5
    s_and_b32 s11, s5, 0x1c
    s_add_u32 s10, s10, s11
    s_mov_b64 exec, 1
    buffer_atomic_or v6, off, s[56:59], s10 sc1
    s_mov_b64 exec, -1
pt_27:
    v_lshlrev_b32 v6, 16, v2
    v_lshl_add_u32 v6, v3, 2, v6
    s_lshl_b32 s9, s5, 8
    s_lshl_b32 s10, s3, 6
    s_add_u32 s9, s9, s10
    v_add_u32 v6, s9, v6
    v_lshlrev_b32 v7, 13, v2
    v_lshl_add_u32 v7, v3, 4, v7
    s_lshl_b32 s9, s5, 17
    s_lshl_b32 s10, s3, 8
    s_add_u32 s9, s9, s10
    v_add_u32 v7, s9, v7
    s_mov_b32 s12, 84148480
    s_mov_b32 s13, 117834498
    s_mov_b32 s14, 0
    buffer_load_dword v16, v6, s[24:27], s14 offen
    s_mov_b32 s14, 8192
    buffer_load_dword v17, v6, s[24:27], s14 offen
    s_mov_b32 s14, 16384
    buffer_load_dword v18, v6, s[24:27], s14 offen
    s_mov_b32 s14, 24576
    buffer_load_dword v19, v6, s[24:27], s14 offen
    s_mov_b32 s14, 32768
    buffer_load_dword v20, v6, s[24:27], s14 offen
    s_mov_b32 s14, 40960
    buffer_load_dword v21, v6, s[24:27], s14 offen
    s_mov_b32 s14, 49152
    buffer_load_dword v22, v6, s[24:27], s14 offen
    s_mov_b32 s14, 57344
    buffer_load_dword v23, v6, s[24:27], s14 offen
    s_mov_b32 s14, 262144
    buffer_load_dword v24, v6, s[24:27], s14 offen
    s_mov_b32 s14, 270336
    buffer_load_dword v25, v6, s[24:27], s14 offen
    s_mov_b32 s14, 278528
    buffer_load_dword v26, v6, s[24:27], s14 offen
    s_mov_b32 s14, 286720
    buffer_load_dword v27, v6, s[24:27], s14 offen
    s_mov_b32 s14, 294912
    buffer_load_dword v28, v6, s[24:27], s14 offen
    s_mov_b32 s14, 303104
    buffer_load_dword v29, v6, s[24:27], s14 offen
    s_mov_b32 s14, 311296
    buffer_load_dword v30, v6, s[24:27], s14 offen
    s_mov_b32 s14, 319488
    buffer_load_dword v31, v6, s[24:27], s14 offen
    s_mov_b32 s14, 524288
    buffer_load_dword v32, v6, s[24:27], s14 offen
    s_mov_b32 s14, 532480
    buffer_load_dword v33, v6, s[24:27], s14 offen
    s_mov_b32 s14, 540672
    buffer_load_dword v34, v6, s[24:27], s14 offen
    s_mov_b32 s14, 548864
    buffer_load_dword v35, v6, s[24:27], s14 offen
    s_mov_b32 s14, 557056
    buffer_load_dword v36, v6, s[24:27], s14 offen
    s_mov_b32 s14, 565248
    buffer_load_dword v37, v6, s[24:27], s14 offen
    s_mov_b32 s14, 573440
    buffer_load_dword v38, v6, s[24:27], s14 offen
    s_mov_b32 s14, 581632
    buffer_load_dword v39, v6, s[24:27], s14 offen
    s_mov_b32 s14, 786432
    buffer_load_dword v40, v6, s[24:27], s14 offen
    s_mov_b32 s14, 794624
    buffer_load_dword v41, v6, s[24:27], s14 offen
    s_mov_b32 s14, 802816
    buffer_load_dword v42, v6, s[24:27], s14 offen
    s_mov_b32 s14, 811008
    buffer_load_dword v43, v6, s[24:27], s14 offen
    s_mov_b32 s14, 819200
    buffer_load_dword v44, v6, s[24:27], s14 offen
    s_mov_b32 s14, 827392
    buffer_load_dword v45, v6, s[24:27], s14 offen
    s_mov_b32 s14, 835584
    buffer_load_dword v46, v6, s[24:27], s14 offen
    s_mov_b32 s14, 843776
    buffer_load_dword v47, v6, s[24:27], s14 offen
    s_mov_b32 s14, 1048576
    buffer_load_dword v48, v6, s[24:27], s14 offen
    s_mov_b32 s14, 1056768
    buffer_load_dword v49, v6, s[24:27], s14 offen
    s_mov_b32 s14, 1064960
    buffer_load_dword v50, v6, s[24:27], s14 offen
    s_mov_b32 s14, 1073152
    buffer_load_dword v51, v6, s[24:27], s14 offen
    s_mov_b32 s14, 1081344
    buffer_load_dword v52, v6, s[24:27], s14 offen
    s_mov_b32 s14, 1089536
    buffer_load_dword v53, v6, s[24:27], s14 offen
    s_mov_b32 s14, 1097728
    buffer_load_dword v54, v6, s[24:27], s14 offen
    s_mov_b32 s14, 1105920
    buffer_load_dword v55, v6, s[24:27], s14 offen
    s_mov_b32 s14, 1310720
    buffer_load_dword v56, v6, s[24:27], s14 offen
    s_mov_b32 s14, 1318912
    buffer_load_dword v57, v6, s[24:27], s14 offen
    s_mov_b32 s14, 1327104
    buffer_load_dword v58, v6, s[24:27], s14 offen
    s_mov_b32 s14, 1335296
    buffer_load_dword v59, v6, s[24:27], s14 offen
    s_mov_b32 s14, 1343488
    buffer_load_dword v60, v6, s[24:27], s14 offen
    s_mov_b32 s14, 1351680
    buffer_load_dword v61, v6, s[24:27], s14 offen
    s_mov_b32 s14, 1359872
    buffer_load_dword v62, v6, s[24:27], s14 offen
    s_mov_b32 s14, 1368064
    buffer_load_dword v63, v6, s[24:27], s14 offen
    s_mov_b32 s14, 1572864
    buffer_load_dword v64, v6, s[24:27], s14 offen
    s_mov_b32 s14, 1581056
    buffer_load_dword v65, v6, s[24:27], s14 offen
    s_mov_b32 s14, 1589248
    buffer_load_dword v66, v6, s[24:27], s14 offen
    s_mov_b32 s14, 1597440
    buffer_load_dword v67, v6, s[24:27], s14 offen
    s_mov_b32 s14, 1605632
    buffer_load_dword v68, v6, s[24:27], s14 offen
    s_mov_b32 s14, 1613824
    buffer_load_dword v69, v6, s[24:27], s14 offen
    s_mov_b32 s14, 1622016
    buffer_load_dword v70, v6, s[24:27], s14 offen
    s_mov_b32 s14, 1630208
    buffer_load_dword v71, v6, s[24:27], s14 offen
    s_mov_b32 s14, 1835008
    buffer_load_dword v72, v6, s[24:27], s14 offen
    s_mov_b32 s14, 1843200
    buffer_load_dword v73, v6, s[24:27], s14 offen
    s_mov_b32 s14, 1851392
    buffer_load_dword v74, v6, s[24:27], s14 offen
    s_mov_b32 s14, 1859584
    buffer_load_dword v75, v6, s[24:27], s14 offen
    s_mov_b32 s14, 1867776
    buffer_load_dword v76, v6, s[24:27], s14 offen
    s_mov_b32 s14, 1875968
    buffer_load_dword v77, v6, s[24:27], s14 offen
    s_mov_b32 s14, 1884160
    buffer_load_dword v78, v6, s[24:27], s14 offen
    s_mov_b32 s14, 1892352
    buffer_load_dword v79, v6, s[24:27], s14 offen
    s_waitcnt vmcnt(48)
    v_perm_b32 v80, v17, v16, s12
    v_accvgpr_write_b32 a0, v80
    v_perm_b32 v81, v19, v18, s12
    v_accvgpr_write_b32 a1, v81
    v_perm_b32 v80, v21, v20, s12
    v_accvgpr_write_b32 a2, v80
    v_perm_b32 v81, v23, v22, s12
    v_accvgpr_write_b32 a3, v81
    v_perm_b32 v80, v17, v16, s13
    v_accvgpr_write_b32 a4, v80
    v_perm_b32 v81, v19, v18, s13
    v_accvgpr_write_b32 a5, v81
    v_perm_b32 v80, v21, v20, s13
    v_accvgpr_write_b32 a6, v80
    v_perm_b32 v81, v23, v22, s13
    v_accvgpr_write_b32 a7, v81
    v_perm_b32 v80, v25, v24, s12
    v_accvgpr_write_b32 a8, v80
    v_perm_b32 v81, v27, v26, s12
    v_accvgpr_write_b32 a9, v81
    v_perm_b32 v80, v29, v28, s12
    v_accvgpr_write_b32 a10, v80
    v_perm_b32 v81, v31, v30, s12
    v_accvgpr_write_b32 a11, v81
    v_perm_b32 v80, v25, v24, s13
    v_accvgpr_write_b32 a12, v80
    v_perm_b32 v81, v27, v26, s13
    v_accvgpr_write_b32 a13, v81
    v_perm_b32 v80, v29, v28, s13
    v_accvgpr_write_b32 a14, v80
    v_perm_b32 v81, v31, v30, s13
    v_accvgpr_write_b32 a15, v81
    s_mov_b32 s14, 2097152
    buffer_load_dword v16, v6, s[24:27], s14 offen
    s_mov_b32 s14, 2105344
    buffer_load_dword v17, v6, s[24:27], s14 offen
    s_mov_b32 s14, 2113536
    buffer_load_dword v18, v6, s[24:27], s14 offen
    s_mov_b32 s14, 2121728
    buffer_load_dword v19, v6, s[24:27], s14 offen
    s_mov_b32 s14, 2129920
    buffer_load_dword v20, v6, s[24:27], s14 offen
    s_mov_b32 s14, 2138112
    buffer_load_dword v21, v6, s[24:27], s14 offen
    s_mov_b32 s14, 2146304
    buffer_load_dword v22, v6, s[24:27], s14 offen
    s_mov_b32 s14, 2154496
    buffer_load_dword v23, v6, s[24:27], s14 offen
    s_mov_b32 s14, 2359296
    buffer_load_dword v24, v6, s[24:27], s14 offen
    s_mov_b32 s14, 2367488
    buffer_load_dword v25, v6, s[24:27], s14 offen
    s_mov_b32 s14, 2375680
    buffer_load_dword v26, v6, s[24:27], s14 offen
    s_mov_b32 s14, 2383872
    buffer_load_dword v27, v6, s[24:27], s14 offen
    s_mov_b32 s14, 2392064
    buffer_load_dword v28, v6, s[24:27], s14 offen
    s_mov_b32 s14, 2400256
    buffer_load_dword v29, v6, s[24:27], s14 offen
    s_mov_b32 s14, 2408448
    buffer_load_dword v30, v6, s[24:27], s14 offen
    s_mov_b32 s14, 2416640
    buffer_load_dword v31, v6, s[24:27], s14 offen
    s_waitcnt vmcnt(48)
    v_perm_b32 v80, v33, v32, s12
    v_accvgpr_write_b32 a16, v80
    v_perm_b32 v81, v35, v34, s12
    v_accvgpr_write_b32 a17, v81
    v_perm_b32 v80, v37, v36, s12
    v_accvgpr_write_b32 a18, v80
    v_perm_b32 v81, v39, v38, s12
    v_accvgpr_write_b32 a19, v81
    v_perm_b32 v80, v33, v32, s13
    v_accvgpr_write_b32 a20, v80
    v_perm_b32 v81, v35, v34, s13
    v_accvgpr_write_b32 a21, v81
    v_perm_b32 v80, v37, v36, s13
    v_accvgpr_write_b32 a22, v80
    v_perm_b32 v81, v39, v38, s13
    v_accvgpr_write_b32 a23, v81
    v_perm_b32 v80, v41, v40, s12
    v_accvgpr_write_b32 a24, v80
    v_perm_b32 v81, v43, v42, s12
    v_accvgpr_write_b32 a25, v81
    v_perm_b32 v80, v45, v44, s12
    v_accvgpr_write_b32 a26, v80
    v_perm_b32 v81, v47, v46, s12
    v_accvgpr_write_b32 a27, v81
    v_perm_b32 v80, v41, v40, s13
    v_accvgpr_write_b32 a28, v80
    v_perm_b32 v81, v43, v42, s13
    v_accvgpr_write_b32 a29, v81
    v_perm_b32 v80, v45, v44, s13
    v_accvgpr_write_b32 a30, v80
    v_perm_b32 v81, v47, v46, s13
    v_accvgpr_write_b32 a31, v81
    s_mov_b32 s14, 2621440
    buffer_load_dword v32, v6, s[24:27], s14 offen
    s_mov_b32 s14, 2629632
    buffer_load_dword v33, v6, s[24:27], s14 offen
    s_mov_b32 s14, 2637824
    buffer_load_dword v34, v6, s[24:27], s14 offen
    s_mov_b32 s14, 2646016
    buffer_load_dword v35, v6, s[24:27], s14 offen
    s_mov_b32 s14, 2654208
    buffer_load_dword v36, v6, s[24:27], s14 offen
    s_mov_b32 s14, 2662400
    buffer_load_dword v37, v6, s[24:27], s14 offen
    s_mov_b32 s14, 2670592
    buffer_load_dword v38, v6, s[24:27], s14 offen
    s_mov_b32 s14, 2678784
    buffer_load_dword v39, v6, s[24:27], s14 offen
    s_mov_b32 s14, 2883584
    buffer_load_dword v40, v6, s[24:27], s14 offen
    s_mov_b32 s14, 2891776
    buffer_load_dword v41, v6, s[24:27], s14 offen
    s_mov_b32 s14, 2899968
    buffer_load_dword v42, v6, s[24:27], s14 offen
    s_mov_b32 s14, 2908160
    buffer_load_dword v43, v6, s[24:27], s14 offen
    s_mov_b32 s14, 2916352
    buffer_load_dword v44, v6, s[24:27], s14 offen
    s_mov_b32 s14, 2924544
    buffer_load_dword v45, v6, s[24:27], s14 offen
    s_mov_b32 s14, 2932736
    buffer_load_dword v46, v6, s[24:27], s14 offen
    s_mov_b32 s14, 2940928
    buffer_load_dword v47, v6, s[24:27], s14 offen
    s_waitcnt vmcnt(48)
    v_perm_b32 v80, v49, v48, s12
    v_accvgpr_write_b32 a32, v80
    v_perm_b32 v81, v51, v50, s12
    v_accvgpr_write_b32 a33, v81
    v_perm_b32 v80, v53, v52, s12
    v_accvgpr_write_b32 a34, v80
    v_perm_b32 v81, v55, v54, s12
    v_accvgpr_write_b32 a35, v81
    v_perm_b32 v80, v49, v48, s13
    v_accvgpr_write_b32 a36, v80
    v_perm_b32 v81, v51, v50, s13
    v_accvgpr_write_b32 a37, v81
    v_perm_b32 v80, v53, v52, s13
    v_accvgpr_write_b32 a38, v80
    v_perm_b32 v81, v55, v54, s13
    v_accvgpr_write_b32 a39, v81
    v_perm_b32 v80, v57, v56, s12
    v_accvgpr_write_b32 a40, v80
    v_perm_b32 v81, v59, v58, s12
    v_accvgpr_write_b32 a41, v81
    v_perm_b32 v80, v61, v60, s12
    v_accvgpr_write_b32 a42, v80
    v_perm_b32 v81, v63, v62, s12
    v_accvgpr_write_b32 a43, v81
    v_perm_b32 v80, v57, v56, s13
    v_accvgpr_write_b32 a44, v80
    v_perm_b32 v81, v59, v58, s13
    v_accvgpr_write_b32 a45, v81
    v_perm_b32 v80, v61, v60, s13
    v_accvgpr_write_b32 a46, v80
    v_perm_b32 v81, v63, v62, s13
    v_accvgpr_write_b32 a47, v81
    s_mov_b32 s14, 3145728
    buffer_load_dword v48, v6, s[24:27], s14 offen
    s_mov_b32 s14, 3153920
    buffer_load_dword v49, v6, s[24:27], s14 offen
    s_mov_b32 s14, 3162112
    buffer_load_dword v50, v6, s[24:27], s14 offen
    s_mov_b32 s14, 3170304
    buffer_load_dword v51, v6, s[24:27], s14 offen
    s_mov_b32 s14, 3178496
    buffer_load_dword v52, v6, s[24:27], s14 offen
    s_mov_b32 s14, 3186688
    buffer_load_dword v53, v6, s[24:27], s14 offen
    s_mov_b32 s14, 3194880
    buffer_load_dword v54, v6, s[24:27], s14 offen
    s_mov_b32 s14, 3203072
    buffer_load_dword v55, v6, s[24:27], s14 offen
    s_mov_b32 s14, 3407872
    buffer_load_dword v56, v6, s[24:27], s14 offen
    s_mov_b32 s14, 3416064
    buffer_load_dword v57, v6, s[24:27], s14 offen
    s_mov_b32 s14, 3424256
    buffer_load_dword v58, v6, s[24:27], s14 offen
    s_mov_b32 s14, 3432448
    buffer_load_dword v59, v6, s[24:27], s14 offen
    s_mov_b32 s14, 3440640
    buffer_load_dword v60, v6, s[24:27], s14 offen
    s_mov_b32 s14, 3448832
    buffer_load_dword v61, v6, s[24:27], s14 offen
    s_mov_b32 s14, 3457024
    buffer_load_dword v62, v6, s[24:27], s14 offen
    s_mov_b32 s14, 3465216
    buffer_load_dword v63, v6, s[24:27], s14 offen
    s_waitcnt vmcnt(48)
    v_perm_b32 v80, v65, v64, s12
    v_accvgpr_write_b32 a48, v80
    v_perm_b32 v81, v67, v66, s12
    v_accvgpr_write_b32 a49, v81
    v_perm_b32 v80, v69, v68, s12
    v_accvgpr_write_b32 a50, v80
    v_perm_b32 v81, v71, v70, s12
    v_accvgpr_write_b32 a51, v81
    v_perm_b32 v80, v65, v64, s13
    v_accvgpr_write_b32 a52, v80
    v_perm_b32 v81, v67, v66, s13
    v_accvgpr_write_b32 a53, v81
    v_perm_b32 v80, v69, v68, s13
    v_accvgpr_write_b32 a54, v80
    v_perm_b32 v81, v71, v70, s13
    v_accvgpr_write_b32 a55, v81
    v_perm_b32 v80, v73, v72, s12
    v_accvgpr_write_b32 a56, v80
    v_perm_b32 v81, v75, v74, s12
    v_accvgpr_write_b32 a57, v81
    v_perm_b32 v80, v77, v76, s12
    v_accvgpr_write_b32 a58, v80
    v_perm_b32 v81, v79, v78, s12
    v_accvgpr_write_b32 a59, v81
    v_perm_b32 v80, v73, v72, s13
    v_accvgpr_write_b32 a60, v80
    v_perm_b32 v81, v75, v74, s13
    v_accvgpr_write_b32 a61, v81
    v_perm_b32 v80, v77, v76, s13
    v_accvgpr_write_b32 a62, v80
    v_perm_b32 v81, v79, v78, s13
    v_accvgpr_write_b32 a63, v81
    s_mov_b32 s14, 3670016
    buffer_load_dword v64, v6, s[24:27], s14 offen
    s_mov_b32 s14, 3678208
    buffer_load_dword v65, v6, s[24:27], s14 offen
    s_mov_b32 s14, 3686400
    buffer_load_dword v66, v6, s[24:27], s14 offen
    s_mov_b32 s14, 3694592
    buffer_load_dword v67, v6, s[24:27], s14 offen
    s_mov_b32 s14, 3702784
    buffer_load_dword v68, v6, s[24:27], s14 offen
    s_mov_b32 s14, 3710976
    buffer_load_dword v69, v6, s[24:27], s14 offen
    s_mov_b32 s14, 3719168
    buffer_load_dword v70, v6, s[24:27], s14 offen
    s_mov_b32 s14, 3727360
    buffer_load_dword v71, v6, s[24:27], s14 offen
    s_mov_b32 s14, 3932160
    buffer_load_dword v72, v6, s[24:27], s14 offen
    s_mov_b32 s14, 3940352
    buffer_load_dword v73, v6, s[24:27], s14 offen
    s_mov_b32 s14, 3948544
    buffer_load_dword v74, v6, s[24:27], s14 offen
    s_mov_b32 s14, 3956736
    buffer_load_dword v75, v6, s[24:27], s14 offen
    s_mov_b32 s14, 3964928
    buffer_load_dword v76, v6, s[24:27], s14 offen
    s_mov_b32 s14, 3973120
    buffer_load_dword v77, v6, s[24:27], s14 offen
    s_mov_b32 s14, 3981312
    buffer_load_dword v78, v6, s[24:27], s14 offen
    s_mov_b32 s14, 3989504
    buffer_load_dword v79, v6, s[24:27], s14 offen
    s_waitcnt vmcnt(48)
    v_perm_b32 v80, v17, v16, s12
    v_accvgpr_write_b32 a64, v80
    v_perm_b32 v81, v19, v18, s12
    v_accvgpr_write_b32 a65, v81
    v_perm_b32 v80, v21, v20, s12
    v_accvgpr_write_b32 a66, v80
    v_perm_b32 v81, v23, v22, s12
    v_accvgpr_write_b32 a67, v81
    v_perm_b32 v80, v17, v16, s13
    v_accvgpr_write_b32 a68, v80
    v_perm_b32 v81, v19, v18, s13
    v_accvgpr_write_b32 a69, v81
    v_perm_b32 v80, v21, v20, s13
    v_accvgpr_write_b32 a70, v80
    v_perm_b32 v81, v23, v22, s13
    v_accvgpr_write_b32 a71, v81
    v_perm_b32 v80, v25, v24, s12
    v_accvgpr_write_b32 a72, v80
    v_perm_b32 v81, v27, v26, s12
    v_accvgpr_write_b32 a73, v81
    v_perm_b32 v80, v29, v28, s12
    v_accvgpr_write_b32 a74, v80
    v_perm_b32 v81, v31, v30, s12
    v_accvgpr_write_b32 a75, v81
    v_perm_b32 v80, v25, v24, s13
    v_accvgpr_write_b32 a76, v80
    v_perm_b32 v81, v27, v26, s13
    v_accvgpr_write_b32 a77, v81
    v_perm_b32 v80, v29, v28, s13
    v_accvgpr_write_b32 a78, v80
    v_perm_b32 v81, v31, v30, s13
    v_accvgpr_write_b32 a79, v81
    s_waitcnt vmcnt(32)
    v_perm_b32 v80, v33, v32, s12
    v_accvgpr_write_b32 a80, v80
    v_perm_b32 v81, v35, v34, s12
    v_accvgpr_write_b32 a81, v81
    v_perm_b32 v80, v37, v36, s12
    v_accvgpr_write_b32 a82, v80
    v_perm_b32 v81, v39, v38, s12
    v_accvgpr_write_b32 a83, v81
    v_perm_b32 v80, v33, v32, s13
    v_accvgpr_write_b32 a84, v80
    v_perm_b32 v81, v35, v34, s13
    v_accvgpr_write_b32 a85, v81
    v_perm_b32 v80, v37, v36, s13
    v_accvgpr_write_b32 a86, v80
    v_perm_b32 v81, v39, v38, s13
    v_accvgpr_write_b32 a87, v81
    v_perm_b32 v80, v41, v40, s12
    v_accvgpr_write_b32 a88, v80
    v_perm_b32 v81, v43, v42, s12
    v_accvgpr_write_b32 a89, v81
    v_perm_b32 v80, v45, v44, s12
    v_accvgpr_write_b32 a90, v80
    v_perm_b32 v81, v47, v46, s12
    v_accvgpr_write_b32 a91, v81
    v_perm_b32 v80, v41, v40, s13
    v_accvgpr_write_b32 a92, v80
    v_perm_b32 v81, v43, v42, s13
    v_accvgpr_write_b32 a93, v81
    v_perm_b32 v80, v45, v44, s13
    v_accvgpr_write_b32 a94, v80
    v_perm_b32 v81, v47, v46, s13
    v_accvgpr_write_b32 a95, v81
    s_waitcnt vmcnt(16)
    v_perm_b32 v80, v49, v48, s12
    v_accvgpr_write_b32 a96, v80
    v_perm_b32 v81, v51, v50, s12
    v_accvgpr_write_b32 a97, v81
    v_perm_b32 v80, v53, v52, s12
    v_accvgpr_write_b32 a98, v80
    v_perm_b32 v81, v55, v54, s12
    v_accvgpr_write_b32 a99, v81
    v_perm_b32 v80, v49, v48, s13
    v_accvgpr_write_b32 a100, v80
    v_perm_b32 v81, v51, v50, s13
    v_accvgpr_write_b32 a101, v81
    v_perm_b32 v80, v53, v52, s13
    v_accvgpr_write_b32 a102, v80
    v_perm_b32 v81, v55, v54, s13
    v_accvgpr_write_b32 a103, v81
    v_perm_b32 v80, v57, v56, s12
    v_accvgpr_write_b32 a104, v80
    v_perm_b32 v81, v59, v58, s12
    v_accvgpr_write_b32 a105, v81
    v_perm_b32 v80, v61, v60, s12
    v_accvgpr_write_b32 a106, v80
    v_perm_b32 v81, v63, v62, s12
    v_accvgpr_write_b32 a107, v81
    v_perm_b32 v80, v57, v56, s13
    v_accvgpr_write_b32 a108, v80
    v_perm_b32 v81, v59, v58, s13
    v_accvgpr_write_b32 a109, v81
    v_perm_b32 v80, v61, v60, s13
    v_accvgpr_write_b32 a110, v80
    v_perm_b32 v81, v63, v62, s13
    v_accvgpr_write_b32 a111, v81
    s_waitcnt vmcnt(0)
    v_perm_b32 v80, v65, v64, s12
    v_accvgpr_write_b32 a112, v80
    v_perm_b32 v81, v67, v66, s12
    v_accvgpr_write_b32 a113, v81
    v_perm_b32 v80, v69, v68, s12
    v_accvgpr_write_b32 a114, v80
    v_perm_b32 v81, v71, v70, s12
    v_accvgpr_write_b32 a115, v81
    v_perm_b32 v80, v65, v64, s13
    v_accvgpr_write_b32 a116, v80
    v_perm_b32 v81, v67, v66, s13
    v_accvgpr_write_b32 a117, v81
    v_perm_b32 v80, v69, v68, s13
    v_accvgpr_write_b32 a118, v80
    v_perm_b32 v81, v71, v70, s13
    v_accvgpr_write_b32 a119, v81
    v_perm_b32 v80, v73, v72, s12
    v_accvgpr_write_b32 a120, v80
    v_perm_b32 v81, v75, v74, s12
    v_accvgpr_write_b32 a121, v81
    v_perm_b32 v80, v77, v76, s12
    v_accvgpr_write_b32 a122, v80
    v_perm_b32 v81, v79, v78, s12
    v_accvgpr_write_b32 a123, v81
    v_perm_b32 v80, v73, v72, s13
    v_accvgpr_write_b32 a124, v80
    v_perm_b32 v81, v75, v74, s13
    v_accvgpr_write_b32 a125, v81
    v_perm_b32 v80, v77, v76, s13
    v_accvgpr_write_b32 a126, v80
    v_perm_b32 v81, v79, v78, s13
    v_accvgpr_write_b32 a127, v81
    s_mov_b32 s12, 84148480
    s_mov_b32 s13, 117834498
    s_mov_b32 s14, 0
    buffer_load_dwordx4 v[16:19], v7, s[36:39], s14 offen
    s_mov_b32 s14, 1024
    buffer_load_dwordx4 v[20:23], v7, s[36:39], s14 offen
    s_mov_b32 s14, 2048
    buffer_load_dwordx4 v[24:27], v7, s[36:39], s14 offen
    s_mov_b32 s14, 3072
    buffer_load_dwordx4 v[28:31], v7, s[36:39], s14 offen
    s_mov_b32 s14, 4096
    buffer_load_dwordx4 v[32:35], v7, s[36:39], s14 offen
    s_mov_b32 s14, 5120
    buffer_load_dwordx4 v[36:39], v7, s[36:39], s14 offen
    s_mov_b32 s14, 6144
    buffer_load_dwordx4 v[40:43], v7, s[36:39], s14 offen
    s_mov_b32 s14, 7168
    buffer_load_dwordx4 v[44:47], v7, s[36:39], s14 offen
    s_mov_b32 s14, 32768
    buffer_load_dwordx4 v[48:51], v7, s[36:39], s14 offen
    s_mov_b32 s14, 33792
    buffer_load_dwordx4 v[52:55], v7, s[36:39], s14 offen
    s_mov_b32 s14, 34816
    buffer_load_dwordx4 v[56:59], v7, s[36:39], s14 offen
    s_mov_b32 s14, 35840
    buffer_load_dwordx4 v[60:63], v7, s[36:39], s14 offen
    s_mov_b32 s14, 36864
    buffer_load_dwordx4 v[64:67], v7, s[36:39], s14 offen
    s_mov_b32 s14, 37888
    buffer_load_dwordx4 v[68:71], v7, s[36:39], s14 offen
    s_mov_b32 s14, 38912
    buffer_load_dwordx4 v[72:75], v7, s[36:39], s14 offen
    s_mov_b32 s14, 39936
    buffer_load_dwordx4 v[76:79], v7, s[36:39], s14 offen
    s_mov_b32 s14, 65536
    buffer_load_dwordx4 v[80:83], v7, s[36:39], s14 offen
    s_mov_b32 s14, 66560
    buffer_load_dwordx4 v[84:87], v7, s[36:39], s14 offen
    s_mov_b32 s14, 67584
    buffer_load_dwordx4 v[88:91], v7, s[36:39], s14 offen
    s_mov_b32 s14, 68608
    buffer_load_dwordx4 v[92:95], v7, s[36:39], s14 offen
    s_mov_b32 s14, 69632
    buffer_load_dwordx4 v[96:99], v7, s[36:39], s14 offen
    s_mov_b32 s14, 70656
    buffer_load_dwordx4 v[100:103], v7, s[36:39], s14 offen
    s_mov_b32 s14, 71680
    buffer_load_dwordx4 v[104:107], v7, s[36:39], s14 offen
    s_mov_b32 s14, 72704
    buffer_load_dwordx4 v[108:111], v7, s[36:39], s14 offen
    s_mov_b32 s14, 98304
    buffer_load_dwordx4 v[112:115], v7, s[36:39], s14 offen
    s_mov_b32 s14, 99328
    buffer_load_dwordx4 v[116:119], v7, s[36:39], s14 offen
    s_mov_b32 s14, 100352
    buffer_load_dwordx4 v[120:123], v7, s[36:39], s14 offen
    s_mov_b32 s14, 101376
    buffer_load_dwordx4 v[124:127], v7, s[36:39], s14 offen
    s_mov_b32 s14, 102400
    buffer_load_dwordx4 v[128:131], v7, s[36:39], s14 offen
    s_mov_b32 s14, 103424
    buffer_load_dwordx4 v[132:135], v7, s[36:39], s14 offen
    s_mov_b32 s14, 104448
    buffer_load_dwordx4 v[136:139], v7, s[36:39], s14 offen
    s_mov_b32 s14, 105472
    buffer_load_dwordx4 v[140:143], v7, s[36:39], s14 offen
    s_waitcnt vmcnt(24)
    v_perm_b32 v14, v20, v16, s12
    v_accvgpr_write_b32 a128, v14
    v_perm_b32 v15, v28, v24, s12
    v_accvgpr_write_b32 a129, v15
    v_perm_b32 v14, v36, v32, s12
    v_accvgpr_write_b32 a130, v14
    v_perm_b32 v15, v44, v40, s12
    v_accvgpr_write_b32 a131, v15
    v_perm_b32 v14, v20, v16, s13
    v_accvgpr_write_b32 a132, v14
    v_perm_b32 v15, v28, v24, s13
    v_accvgpr_write_b32 a133, v15
    v_perm_b32 v14, v36, v32, s13
    v_accvgpr_write_b32 a134, v14
    v_perm_b32 v15, v44, v40, s13
    v_accvgpr_write_b32 a135, v15
    v_perm_b32 v14, v21, v17, s12
    v_accvgpr_write_b32 a136, v14
    v_perm_b32 v15, v29, v25, s12
    v_accvgpr_write_b32 a137, v15
    v_perm_b32 v14, v37, v33, s12
    v_accvgpr_write_b32 a138, v14
    v_perm_b32 v15, v45, v41, s12
    v_accvgpr_write_b32 a139, v15
    v_perm_b32 v14, v21, v17, s13
    v_accvgpr_write_b32 a140, v14
    v_perm_b32 v15, v29, v25, s13
    v_accvgpr_write_b32 a141, v15
    v_perm_b32 v14, v37, v33, s13
    v_accvgpr_write_b32 a142, v14
    v_perm_b32 v15, v45, v41, s13
    v_accvgpr_write_b32 a143, v15
    v_perm_b32 v14, v22, v18, s12
    v_accvgpr_write_b32 a144, v14
    v_perm_b32 v15, v30, v26, s12
    v_accvgpr_write_b32 a145, v15
    v_perm_b32 v14, v38, v34, s12
    v_accvgpr_write_b32 a146, v14
    v_perm_b32 v15, v46, v42, s12
    v_accvgpr_write_b32 a147, v15
    v_perm_b32 v14, v22, v18, s13
    v_accvgpr_write_b32 a148, v14
    v_perm_b32 v15, v30, v26, s13
    v_accvgpr_write_b32 a149, v15
    v_perm_b32 v14, v38, v34, s13
    v_accvgpr_write_b32 a150, v14
    v_perm_b32 v15, v46, v42, s13
    v_accvgpr_write_b32 a151, v15
    v_perm_b32 v14, v23, v19, s12
    v_accvgpr_write_b32 a152, v14
    v_perm_b32 v15, v31, v27, s12
    v_accvgpr_write_b32 a153, v15
    v_perm_b32 v14, v39, v35, s12
    v_accvgpr_write_b32 a154, v14
    v_perm_b32 v15, v47, v43, s12
    v_accvgpr_write_b32 a155, v15
    v_perm_b32 v14, v23, v19, s13
    v_accvgpr_write_b32 a156, v14
    v_perm_b32 v15, v31, v27, s13
    v_accvgpr_write_b32 a157, v15
    v_perm_b32 v14, v39, v35, s13
    v_accvgpr_write_b32 a158, v14
    v_perm_b32 v15, v47, v43, s13
    v_accvgpr_write_b32 a159, v15
    s_waitcnt vmcnt(16)
    v_perm_b32 v14, v52, v48, s12
    v_accvgpr_write_b32 a160, v14
    v_perm_b32 v15, v60, v56, s12
    v_accvgpr_write_b32 a161, v15
    v_perm_b32 v14, v68, v64, s12
    v_accvgpr_write_b32 a162, v14
    v_perm_b32 v15, v76, v72, s12
    v_accvgpr_write_b32 a163, v15
    v_perm_b32 v14, v52, v48, s13
    v_accvgpr_write_b32 a164, v14
    v_perm_b32 v15, v60, v56, s13
    v_accvgpr_write_b32 a165, v15
    v_perm_b32 v14, v68, v64, s13
    v_accvgpr_write_b32 a166, v14
    v_perm_b32 v15, v76, v72, s13
    v_accvgpr_write_b32 a167, v15
    v_perm_b32 v14, v53, v49, s12
    v_accvgpr_write_b32 a168, v14
    v_perm_b32 v15, v61, v57, s12
    v_accvgpr_write_b32 a169, v15
    v_perm_b32 v14, v69, v65, s12
    v_accvgpr_write_b32 a170, v14
    v_perm_b32 v15, v77, v73, s12
    v_accvgpr_write_b32 a171, v15
    v_perm_b32 v14, v53, v49, s13
    v_accvgpr_write_b32 a172, v14
    v_perm_b32 v15, v61, v57, s13
    v_accvgpr_write_b32 a173, v15
    v_perm_b32 v14, v69, v65, s13
    v_accvgpr_write_b32 a174, v14
    v_perm_b32 v15, v77, v73, s13
    v_accvgpr_write_b32 a175, v15
    v_perm_b32 v14, v54, v50, s12
    v_accvgpr_write_b32 a176, v14
    v_perm_b32 v15, v62, v58, s12
    v_accvgpr_write_b32 a177, v15
    v_perm_b32 v14, v70, v66, s12
    v_accvgpr_write_b32 a178, v14
    v_perm_b32 v15, v78, v74, s12
    v_accvgpr_write_b32 a179, v15
    v_perm_b32 v14, v54, v50, s13
    v_accvgpr_write_b32 a180, v14
    v_perm_b32 v15, v62, v58, s13
    v_accvgpr_write_b32 a181, v15
    v_perm_b32 v14, v70, v66, s13
    v_accvgpr_write_b32 a182, v14
    v_perm_b32 v15, v78, v74, s13
    v_accvgpr_write_b32 a183, v15
    v_perm_b32 v14, v55, v51, s12
    v_accvgpr_write_b32 a184, v14
    v_perm_b32 v15, v63, v59, s12
    v_accvgpr_write_b32 a185, v15
    v_perm_b32 v14, v71, v67, s12
    v_accvgpr_write_b32 a186, v14
    v_perm_b32 v15, v79, v75, s12
    v_accvgpr_write_b32 a187, v15
    v_perm_b32 v14, v55, v51, s13
    v_accvgpr_write_b32 a188, v14
    v_perm_b32 v15, v63, v59, s13
    v_accvgpr_write_b32 a189, v15
    v_perm_b32 v14, v71, v67, s13
    v_accvgpr_write_b32 a190, v14
    v_perm_b32 v15, v79, v75, s13
    v_accvgpr_write_b32 a191, v15
    s_waitcnt vmcnt(8)
    v_perm_b32 v14, v84, v80, s12
    v_accvgpr_write_b32 a192, v14
    v_perm_b32 v15, v92, v88, s12
    v_accvgpr_write_b32 a193, v15
    v_perm_b32 v14, v100, v96, s12
    v_accvgpr_write_b32 a194, v14
    v_perm_b32 v15, v108, v104, s12
    v_accvgpr_write_b32 a195, v15
    v_perm_b32 v14, v84, v80, s13
    v_accvgpr_write_b32 a196, v14
    v_perm_b32 v15, v92, v88, s13
    v_accvgpr_write_b32 a197, v15
    v_perm_b32 v14, v100, v96, s13
    v_accvgpr_write_b32 a198, v14
    v_perm_b32 v15, v108, v104, s13
    v_accvgpr_write_b32 a199, v15
    v_perm_b32 v14, v85, v81, s12
    v_accvgpr_write_b32 a200, v14
    v_perm_b32 v15, v93, v89, s12
    v_accvgpr_write_b32 a201, v15
    v_perm_b32 v14, v101, v97, s12
    v_accvgpr_write_b32 a202, v14
    v_perm_b32 v15, v109, v105, s12
    v_accvgpr_write_b32 a203, v15
    v_perm_b32 v14, v85, v81, s13
    v_accvgpr_write_b32 a204, v14
    v_perm_b32 v15, v93, v89, s13
    v_accvgpr_write_b32 a205, v15
    v_perm_b32 v14, v101, v97, s13
    v_accvgpr_write_b32 a206, v14
    v_perm_b32 v15, v109, v105, s13
    v_accvgpr_write_b32 a207, v15
    v_perm_b32 v14, v86, v82, s12
    v_accvgpr_write_b32 a208, v14
    v_perm_b32 v15, v94, v90, s12
    v_accvgpr_write_b32 a209, v15
    v_perm_b32 v14, v102, v98, s12
    v_accvgpr_write_b32 a210, v14
    v_perm_b32 v15, v110, v106, s12
    v_accvgpr_write_b32 a211, v15
    v_perm_b32 v14, v86, v82, s13
    v_accvgpr_write_b32 a212, v14
    v_perm_b32 v15, v94, v90, s13
    v_accvgpr_write_b32 a213, v15
    v_perm_b32 v14, v102, v98, s13
    v_accvgpr_write_b32 a214, v14
    v_perm_b32 v15, v110, v106, s13
    v_accvgpr_write_b32 a215, v15
    v_perm_b32 v14, v87, v83, s12
    v_accvgpr_write_b32 a216, v14
    v_perm_b32 v15, v95, v91, s12
    v_accvgpr_write_b32 a217, v15
    v_perm_b32 v14, v103, v99, s12
    v_accvgpr_write_b32 a218, v14
    v_perm_b32 v15, v111, v107, s12
    v_accvgpr_write_b32 a219, v15
    v_perm_b32 v14, v87, v83, s13
    v_accvgpr_write_b32 a220, v14
    v_perm_b32 v15, v95, v91, s13
    v_accvgpr_write_b32 a221, v15
    v_perm_b32 v14, v103, v99, s13
    v_accvgpr_write_b32 a222, v14
    v_perm_b32 v15, v111, v107, s13
    v_accvgpr_write_b32 a223, v15
    s_waitcnt vmcnt(0)
    v_perm_b32 v14, v116, v112, s12
    v_accvgpr_write_b32 a224, v14
    v_perm_b32 v15, v124, v120, s12
    v_accvgpr_write_b32 a225, v15
    v_perm_b32 v14, v132, v128, s12
    v_accvgpr_write_b32 a226, v14
    v_perm_b32 v15, v140, v136, s12
    v_accvgpr_write_b32 a227, v15
    v_perm_b32 v14, v116, v112, s13
    v_accvgpr_write_b32 a228, v14
    v_perm_b32 v15, v124, v120, s13
    v_accvgpr_write_b32 a229, v15
    v_perm_b32 v14, v132, v128, s13
    v_accvgpr_write_b32 a230, v14
    v_perm_b32 v15, v140, v136, s13
    v_accvgpr_write_b32 a231, v15
    v_perm_b32 v14, v117, v113, s12
    v_accvgpr_write_b32 a232, v14
    v_perm_b32 v15, v125, v121, s12
    v_accvgpr_write_b32 a233, v15
    v_perm_b32 v14, v133, v129, s12
    v_accvgpr_write_b32 a234, v14
    v_perm_b32 v15, v141, v137, s12
    v_accvgpr_write_b32 a235, v15
    v_perm_b32 v14, v117, v113, s13
    v_accvgpr_write_b32 a236, v14
    v_perm_b32 v15, v125, v121, s13
    v_accvgpr_write_b32 a237, v15
    v_perm_b32 v14, v133, v129, s13
    v_accvgpr_write_b32 a238, v14
    v_perm_b32 v15, v141, v137, s13
    v_accvgpr_write_b32 a239, v15
    v_perm_b32 v14, v118, v114, s12
    v_accvgpr_write_b32 a240, v14
    v_perm_b32 v15, v126, v122, s12
    v_accvgpr_write_b32 a241, v15
    v_perm_b32 v14, v134, v130, s12
    v_accvgpr_write_b32 a242, v14
    v_perm_b32 v15, v142, v138, s12
    v_accvgpr_write_b32 a243, v15
    v_perm_b32 v14, v118, v114, s13
    v_accvgpr_write_b32 a244, v14
    v_perm_b32 v15, v126, v122, s13
    v_accvgpr_write_b32 a245, v15
    v_perm_b32 v14, v134, v130, s13
    v_accvgpr_write_b32 a246, v14
    v_perm_b32 v15, v142, v138, s13
    v_accvgpr_write_b32 a247, v15
    v_perm_b32 v14, v119, v115, s12
    v_accvgpr_write_b32 a248, v14
    v_perm_b32 v15, v127, v123, s12
    v_accvgpr_write_b32 a249, v15
    v_perm_b32 v14, v135, v131, s12
    v_accvgpr_write_b32 a250, v14
    v_perm_b32 v15, v143, v139, s12
    v_accvgpr_write_b32 a251, v15
    v_perm_b32 v14, v119, v115, s13
    v_accvgpr_write_b32 a252, v14
    v_perm_b32 v15, v127, v123, s13
    v_accvgpr_write_b32 a253, v15
    v_perm_b32 v14, v135, v131, s13
    v_accvgpr_write_b32 a254, v14
    v_perm_b32 v15, v143, v139, s13
    v_accvgpr_write_b32 a255, v15
    v_mov_b32 v184, 0x3f803f80
    v_mov_b32 v188, -1
    v_mov_b32 v185, 0x3f803f80
    v_mov_b32 v189, -1
    v_mov_b32 v186, 0x3f803f80
    v_mov_b32 v190, -1
    v_mov_b32 v187, 0x3f803f80
    v_mov_b32 v191, -1
    v_mul_u32_u24 v28, 132096, v2
    v_lshl_add_u32 v28, v3, 4, v28
    s_lshl_b32 s9, s5, 10
    s_lshl_b32 s10, s3, 8
    s_add_u32 s9, s9, s10
    v_add_u32 v6, s9, v28
    v_lshlrev_b32 v28, 10, v2
    v_lshl_add_u32 v28, v3, 4, v28
    s_mul_i32 s9, s5, 33024
    s_add_u32 s9, s9, s10
    v_add_u32 v7, s9, v28
    v_lshlrev_b32 v28, 4, v3
    v_and_b32 v29, 1, v2
    v_lshl_add_u32 v28, v29, 3, v28
    v_add_u32 v8, s10, v28
    v_mov_b32 v28, 0x3f80
    v_mov_b32 v29, 0x3f800000
    v_cmp_eq_u32 vcc, 0, v3
    s_nop 1
    v_cndmask_b32 v24, 0, v28, vcc
    v_cmp_eq_u32 vcc, 1, v3
    s_nop 1
    v_cndmask_b32 v24, v24, v29, vcc
    v_mov_b32 v28, 0x3f80
    v_mov_b32 v29, 0x3f800000
    v_cmp_eq_u32 vcc, 2, v3
    s_nop 1
    v_cndmask_b32 v25, 0, v28, vcc
    v_cmp_eq_u32 vcc, 3, v3
    s_nop 1
    v_cndmask_b32 v25, v25, v29, vcc
    v_mov_b32 v28, 0x3f80
    v_mov_b32 v29, 0x3f800000
    v_cmp_eq_u32 vcc, 4, v3
    s_nop 1
    v_cndmask_b32 v26, 0, v28, vcc
    v_cmp_eq_u32 vcc, 5, v3
    s_nop 1
    v_cndmask_b32 v26, v26, v29, vcc
    v_mov_b32 v28, 0x3f80
    v_mov_b32 v29, 0x3f800000
    v_cmp_eq_u32 vcc, 6, v3
    s_nop 1
    v_cndmask_b32 v27, 0, v28, vcc
    v_cmp_eq_u32 vcc, 7, v3
    s_nop 1
    v_cndmask_b32 v27, v27, v29, vcc
    s_lshl_b32 s9, s3, 4
    s_add_u32 s9, s9, 49152
    v_lshlrev_b32 v28, 3, v2
    v_add_u32 v20, s9, v28
    s_lshr_b32 s9, s3, 1
    s_lshl_b32 s9, s9, 11
    s_and_b32 s10, s3, 1
    s_lshl_b32 s11, s10, 9
    s_add_u32 s9, s9, s11
    s_add_u32 s9, s9, 32768
    v_and_b32 v28, 1, v2
    v_lshlrev_b32 v28, 10, v28
    v_lshrrev_b32 v29, 1, v2
    v_lshl_add_u32 v28, v29, 8, v28
    v_lshl_add_u32 v28, v3, 4, v28
    v_add_u32 v9, s9, v28
    s_lshl_b32 s11, s10, 12
    s_add_u32 s9, s11, 32768
    v_add_u32 v10, s9, v4
    s_lshr_b32 s9, s3, 1
    s_lshl_b32 s9, s9, 11
    s_add_u32 s9, s9, s11
    s_add_u32 s9, s9, 40960
    v_add_u32 v11, s9, v4
    s_lshl_b32 s67, s3, 13
    v_add_u32 v12, s67, v4
    v_add_u32 v13, 4096, v12
    v_and_b32 v28, 7, v1
    v_lshlrev_b32 v28, 2, v28
    s_lshl_b32 s9, s5, 7
    s_add_u32 s9, s9, 6881280
    v_add_u32 v14, s9, v28
    s_lshl_b32 s9, s64, 9
    s_add_u32 s9, s9, 6889472
    v_lshlrev_b32 v28, 3, v1
    v_add_u32 v16, s9, v28
    s_lshl_b32 s9, s3, 9
    s_add_u32 s9, s9, 52224
    v_add_u32 v18, s9, v28
    s_lshr_b32 s9, s3, 1
    s_lshl_b32 s11, s9, 10
    s_add_u32 s11, s11, 52224
    v_add_u32 v23, s11, v28
    s_lshl_b32 s11, s9, 11
    s_add_u32 s11, s11, 8192
    v_add_u32 v17, s11, v4
    s_lshr_b32 s9, s3, 1
    s_lshl_b32 s9, s9, 10
    s_lshl_b32 s11, s10, 8
    s_add_u32 s9, s9, s11
    s_add_u32 s9, s9, 50176
    v_bfe_u32 v28, v3, 2, 1
    v_lshlrev_b32 v28, 9, v28
    v_lshrrev_b32 v29, 3, v3
    v_lshl_add_u32 v28, v29, 7, v28
    v_lshl_add_u32 v28, v2, 5, v28
    v_and_b32 v29, 3, v3
    v_lshl_add_u32 v28, v29, 2, v28
    v_add_u32 v15, s9, v28
    v_lshlrev_b32 v28, 7, v2
    v_lshrrev_b32 v29, 2, v3
    v_lshl_add_u32 v28, v29, 5, v28
    v_and_b32 v29, 1, v3
    v_lshl_add_u32 v28, v29, 4, v28
    v_add_u32 v22, 50176, v28
    s_lshl_b32 s9, s10, 4
    v_add_u32 v28, s9, v3
    v_lshlrev_b32 v29, 2, v2
    v_sub_u32 v21, v28, v29
wt_28:
    buffer_load_dword v28, v5, s[56:59], 0 offen sc1
    s_waitcnt vmcnt(0)
    s_mov_b32 s9, 3233857728
    v_and_b32 v29, s9, v28
    v_cmp_ne_u32 vcc, s9, v29
    s_and_b32 vcc_lo, vcc_lo, 4294967040
    s_and_b32 vcc_hi, vcc_hi, 4294967295
    s_cmp_eq_u64 vcc, 0
    s_cbranch_scc1 wtd_29
    s_sleep 100
    s_sub_u32 s8, s8, 1
    s_cbranch_scc0 wt_28
    s_mov_b32 s8, 0
wtd_29:
    s_mul_i32 s9, s6, 0x01010101
    v_and_b32 v28, 0x0f0f0f0f, v28
    v_cmp_ne_u32 vcc, s9, v28
    s_lshl_b32 s10, s4, 3
    s_lshr_b64 s[10:11], vcc, s10
    s_and_b32 s10, s10, 0xff
    s_cmp_lg_u32 s10, 0
    s_cselect_b32 s7, 1, 0
    s_mov_b32 s68, s64
    s_mov_b32 s69, 0
    s_mov_b32 s71, 0x3e0293ee
    s_mov_b32 s73, s70
    s_lshl_b32 s9, s68, 15
    s_mov_b32 m0, s67
    s_nop 0
    buffer_load_dwordx4 v12, s[60:63], s9 offen offset:0 sc1 lds
    buffer_load_dwordx4 v12, s[60:63], s9 offen offset:1024 sc1 lds
    buffer_load_dwordx4 v12, s[60:63], s9 offen offset:2048 sc1 lds
    buffer_load_dwordx4 v12, s[60:63], s9 offen offset:3072 sc1 lds
    s_add_u32 s10, s67, 4096
    s_mov_b32 m0, s10
    s_nop 0
    buffer_load_dwordx4 v13, s[60:63], s9 offen offset:0 sc1 lds
    buffer_load_dwordx4 v13, s[60:63], s9 offen offset:1024 sc1 lds
    buffer_load_dwordx4 v13, s[60:63], s9 offen offset:2048 sc1 lds
    buffer_load_dwordx4 v13, s[60:63], s9 offen offset:3072 sc1 lds
    s_add_u32 s9, s68, 1
wf_31:
    buffer_load_dword v19, v14, s[60:63], 0 offen sc1
    s_waitcnt vmcnt(0)
    v_cmp_gt_u32 vcc, s9, v19
    s_cbranch_vccz wfd_32
    s_sleep 1
    s_sub_u32 s8, s8, 1
    s_cbranch_scc0 wf_31
    s_mov_b32 s8, 0
wfd_32:
    s_mul_i32 s9, s5, 16384
    s_mul_i32 s10, s68, 524288
    s_add_u32 s9, s9, s10
    s_add_u32 s9, s9, 8388608
    s_add_u32 s10, s9, 4096
    buffer_load_dwordx4 v[128:131], v4, s[60:63], s9 offen offset:0 sc1
    buffer_load_dwordx4 v[132:135], v4, s[60:63], s9 offen offset:1024 sc1
    buffer_load_dwordx4 v[136:139], v4, s[60:63], s9 offen offset:2048 sc1
    buffer_load_dwordx4 v[140:143], v4, s[60:63], s9 offen offset:3072 sc1
    buffer_load_dwordx4 v[144:147], v4, s[60:63], s10 offen offset:0 sc1
    buffer_load_dwordx4 v[148:151], v4, s[60:63], s10 offen offset:1024 sc1
    buffer_load_dwordx4 v[152:155], v4, s[60:63], s10 offen offset:2048 sc1
    buffer_load_dwordx4 v[156:159], v4, s[60:63], s10 offen offset:3072 sc1
    buffer_load_dwordx4 v[160:163], v17, s[60:63], s9 offen offset:0 sc1
    buffer_load_dwordx4 v[164:167], v17, s[60:63], s10 offen offset:0 sc1
    buffer_load_dwordx4 v[168:171], v17, s[60:63], s9 offen offset:1024 sc1
    buffer_load_dwordx4 v[172:175], v17, s[60:63], s10 offen offset:1024 sc1
    buffer_load_dword v19, v14, s[60:63], 0 offen sc1
    s_waitcnt vmcnt(0)
    s_barrier
    s_cmp_lg_u32 s7, 0
    s_cbranch_scc1 L_AT_far
L_AT_near:
    s_lshl_b32 s75, s68, 5
    s_add_u32 s75, s75, s5
    s_lshl_b32 s75, s75, 10
    buffer_load_dwordx2 v[176:177], v8, s[16:19], s75 offen
    ds_read_b128 v[32:35], v4 offset:0
    ds_read_b128 v[36:39], v4 offset:16384
    ds_read_b128 v[40:43], v4 offset:1024
    ds_read_b128 v[44:47], v4 offset:17408
    ds_read_b128 v[48:51], v4 offset:2048
    ds_read_b128 v[52:55], v4 offset:18432
    ds_read_b128 v[56:59], v4 offset:3072
    ds_read_b128 v[60:63], v4 offset:19456
    s_waitcnt lgkmcnt(6)
    v_mfma_f32_16x16x32_bf16 v[64:67], a[0:3], v[32:35], 0
    v_mfma_f32_16x16x32_bf16 v[68:71], a[0:3], v[36:39], 0
    v_mfma_f32_16x16x32_bf16 v[72:75], a[4:7], v[32:35], 0
    v_mfma_f32_16x16x32_bf16 v[76:79], a[4:7], v[36:39], 0
    ds_read_b128 v[32:35], v4 offset:4096
    ds_read_b128 v[36:39], v4 offset:20480
    s_waitcnt lgkmcnt(6)
    v_mfma_f32_16x16x32_bf16 v[64:67], a[8:11], v[40:43], v[64:67]
    v_mfma_f32_16x16x32_bf16 v[68:71], a[8:11], v[44:47], v[68:71]
    v_mfma_f32_16x16x32_bf16 v[72:75], a[12:15], v[40:43], v[72:75]
    v_mfma_f32_16x16x32_bf16 v[76:79], a[12:15], v[44:47], v[76:79]
    ds_read_b128 v[40:43], v4 offset:5120
    ds_read_b128 v[44:47], v4 offset:21504
    s_waitcnt lgkmcnt(6)
    v_mfma_f32_16x16x32_bf16 v[64:67], a[16:19], v[48:51], v[64:67]
    v_mfma_f32_16x16x32_bf16 v[68:71], a[16:19], v[52:55], v[68:71]
    v_mfma_f32_16x16x32_bf16 v[72:75], a[20:23], v[48:51], v[72:75]
    v_mfma_f32_16x16x32_bf16 v[76:79], a[20:23], v[52:55], v[76:79]
    ds_read_b128 v[48:51], v4 offset:6144
    ds_read_b128 v[52:55], v4 offset:22528
    s_waitcnt lgkmcnt(6)
    v_mfma_f32_16x16x32_bf16 v[64:67], a[24:27], v[56:59], v[64:67]
    v_mfma_f32_16x16x32_bf16 v[68:71], a[24:27], v[60:63], v[68:71]
    v_mfma_f32_16x16x32_bf16 v[72:75], a[28:31], v[56:59], v[72:75]
    v_mfma_f32_16x16x32_bf16 v[76:79], a[28:31], v[60:63], v[76:79]
    ds_read_b128 v[56:59], v4 offset:7168
    ds_read_b128 v[60:63], v4 offset:23552
    s_waitcnt lgkmcnt(6)
    v_mfma_f32_16x16x32_bf16 v[64:67], a[32:35], v[32:35], v[64:67]
    v_mfma_f32_16x16x32_bf16 v[68:71], a[32:35], v[36:39], v[68:71]
    v_mfma_f32_16x16x32_bf16 v[72:75], a[36:39], v[32:35], v[72:75]
    v_mfma_f32_16x16x32_bf16 v[76:79], a[36:39], v[36:39], v[76:79]
    ds_read_b128 v[32:35], v4 offset:8192
    ds_read_b128 v[36:39], v4 offset:24576
    s_waitcnt lgkmcnt(6)
    v_mfma_f32_16x16x32_bf16 v[64:67], a[40:43], v[40:43], v[64:67]
    v_mfma_f32_16x16x32_bf16 v[68:71], a[40:43], v[44:47], v[68:71]
    v_mfma_f32_16x16x32_bf16 v[72:75], a[44:47], v[40:43], v[72:75]
    v_mfma_f32_16x16x32_bf16 v[76:79], a[44:47], v[44:47], v[76:79]
    ds_read_b128 v[40:43], v4 offset:9216
    ds_read_b128 v[44:47], v4 offset:25600
    s_waitcnt lgkmcnt(6)
    v_mfma_f32_16x16x32_bf16 v[64:67], a[48:51], v[48:51], v[64:67]
    v_mfma_f32_16x16x32_bf16 v[68:71], a[48:51], v[52:55], v[68:71]
    v_mfma_f32_16x16x32_bf16 v[72:75], a[52:55], v[48:51], v[72:75]
    v_mfma_f32_16x16x32_bf16 v[76:79], a[52:55], v[52:55], v[76:79]
    ds_read_b128 v[48:51], v4 offset:10240
    ds_read_b128 v[52:55], v4 offset:26624
    s_waitcnt lgkmcnt(6)
    v_mfma_f32_16x16x32_bf16 v[64:67], a[56:59], v[56:59], v[64:67]
    v_mfma_f32_16x16x32_bf16 v[68:71], a[56:59], v[60:63], v[68:71]
    v_mfma_f32_16x16x32_bf16 v[72:75], a[60:63], v[56:59], v[72:75]
    v_mfma_f32_16x16x32_bf16 v[76:79], a[60:63], v[60:63], v[76:79]
    ds_read_b128 v[56:59], v4 offset:11264
    ds_read_b128 v[60:63], v4 offset:27648
    s_waitcnt lgkmcnt(6)
    v_mfma_f32_16x16x32_bf16 v[64:67], a[64:67], v[32:35], v[64:67]
    v_mfma_f32_16x16x32_bf16 v[68:71], a[64:67], v[36:39], v[68:71]
    v_mfma_f32_16x16x32_bf16 v[72:75], a[68:71], v[32:35], v[72:75]
    v_mfma_f32_16x16x32_bf16 v[76:79], a[68:71], v[36:39], v[76:79]
    ds_read_b128 v[32:35], v4 offset:12288
    ds_read_b128 v[36:39], v4 offset:28672
    s_waitcnt lgkmcnt(6)
    v_mfma_f32_16x16x32_bf16 v[64:67], a[72:75], v[40:43], v[64:67]
    v_mfma_f32_16x16x32_bf16 v[68:71], a[72:75], v[44:47], v[68:71]
    v_mfma_f32_16x16x32_bf16 v[72:75], a[76:79], v[40:43], v[72:75]
    v_mfma_f32_16x16x32_bf16 v[76:79], a[76:79], v[44:47], v[76:79]
    ds_read_b128 v[40:43], v4 offset:13312
    ds_read_b128 v[44:47], v4 offset:29696
    s_waitcnt lgkmcnt(6)
    v_mfma_f32_16x16x32_bf16 v[64:67], a[80:83], v[48:51], v[64:67]
    v_mfma_f32_16x16x32_bf16 v[68:71], a[80:83], v[52:55], v[68:71]
    v_mfma_f32_16x16x32_bf16 v[72:75], a[84:87], v[48:51], v[72:75]
    v_mfma_f32_16x16x32_bf16 v[76:79], a[84:87], v[52:55], v[76:79]
    ds_read_b128 v[48:51], v4 offset:14336
    ds_read_b128 v[52:55], v4 offset:30720
    s_waitcnt lgkmcnt(6)
    v_mfma_f32_16x16x32_bf16 v[64:67], a[88:91], v[56:59], v[64:67]
    v_mfma_f32_16x16x32_bf16 v[68:71], a[88:91], v[60:63], v[68:71]
    v_mfma_f32_16x16x32_bf16 v[72:75], a[92:95], v[56:59], v[72:75]
    v_mfma_f32_16x16x32_bf16 v[76:79], a[92:95], v[60:63], v[76:79]
    ds_read_b128 v[56:59], v4 offset:15360
    ds_read_b128 v[60:63], v4 offset:31744
    s_waitcnt lgkmcnt(6)
    v_mfma_f32_16x16x32_bf16 v[64:67], a[96:99], v[32:35], v[64:67]
    v_mfma_f32_16x16x32_bf16 v[68:71], a[96:99], v[36:39], v[68:71]
    v_mfma_f32_16x16x32_bf16 v[72:75], a[100:103], v[32:35], v[72:75]
    v_mfma_f32_16x16x32_bf16 v[76:79], a[100:103], v[36:39], v[76:79]
    s_waitcnt lgkmcnt(4)
    v_mfma_f32_16x16x32_bf16 v[64:67], a[104:107], v[40:43], v[64:67]
    v_mfma_f32_16x16x32_bf16 v[68:71], a[104:107], v[44:47], v[68:71]
    v_mfma_f32_16x16x32_bf16 v[72:75], a[108:111], v[40:43], v[72:75]
    v_mfma_f32_16x16x32_bf16 v[76:79], a[108:111], v[44:47], v[76:79]
    s_waitcnt lgkmcnt(2)
    v_mfma_f32_16x16x32_bf16 v[64:67], a[112:115], v[48:51], v[64:67]
    v_mfma_f32_16x16x32_bf16 v[68:71], a[112:115], v[52:55], v[68:71]
    v_mfma_f32_16x16x32_bf16 v[72:75], a[116:119], v[48:51], v[72:75]
    v_mfma_f32_16x16x32_bf16 v[76:79], a[116:119], v[52:55], v[76:79]
    s_waitcnt lgkmcnt(0)
    v_mfma_f32_16x16x32_bf16 v[64:67], a[120:123], v[56:59], v[64:67]
    v_mfma_f32_16x16x32_bf16 v[68:71], a[120:123], v[60:63], v[68:71]
    v_mfma_f32_16x16x32_bf16 v[72:75], a[124:127], v[56:59], v[72:75]
    v_mfma_f32_16x16x32_bf16 v[76:79], a[124:127], v[60:63], v[76:79]
    s_nop 6
    v_cvt_pk_bf16_f32 v80, v64, v72
    v_cvt_pk_bf16_f32 v81, v65, v73
    v_cvt_pk_bf16_f32 v82, v66, v74
    v_cvt_pk_bf16_f32 v83, v67, v75
    ds_write_b128 v9, v[80:83] offset:0
    v_cvt_pk_bf16_f32 v84, v68, v76
    v_cvt_pk_bf16_f32 v85, v69, v77
    v_cvt_pk_bf16_f32 v86, v70, v78
    v_cvt_pk_bf16_f32 v87, v71, v79
    ds_write_b128 v9, v[84:87] offset:4096
    s_waitcnt lgkmcnt(0)
    s_barrier
    ds_read_b128 v[32:35], v10 offset:0
    ds_read_b128 v[36:39], v10 offset:1024
    ds_read_b128 v[40:43], v10 offset:2048
    ds_read_b128 v[44:47], v10 offset:3072
    s_waitcnt lgkmcnt(0)
    v_mfma_f32_16x16x32_bf16 v[116:119], v[128:131], v[32:35], 0
    v_mfma_f32_16x16x32_bf16 v[120:123], v[144:147], v[32:35], 0
    v_mfma_f32_16x16x32_bf16 v[116:119], v[132:135], v[36:39], v[116:119]
    v_mfma_f32_16x16x32_bf16 v[120:123], v[148:151], v[36:39], v[120:123]
    v_mfma_f32_16x16x32_bf16 v[116:119], v[136:139], v[40:43], v[116:119]
    v_mfma_f32_16x16x32_bf16 v[120:123], v[152:155], v[40:43], v[120:123]
    v_mfma_f32_16x16x32_bf16 v[116:119], v[140:143], v[44:47], v[116:119]
    v_mfma_f32_16x16x32_bf16 v[120:123], v[156:159], v[44:47], v[120:123]
    v_mov_b32 v29, 0xf149f2ca
    v_cmp_le_i32 vcc, 0, v21
    s_nop 4
    v_cndmask_b32 v116, v29, v116, vcc
    v_cmp_le_i32 vcc, 1, v21
    s_nop 1
    v_cndmask_b32 v117, v29, v117, vcc
    v_cmp_le_i32 vcc, 2, v21
    s_nop 1
    v_cndmask_b32 v118, v29, v118, vcc
    v_cmp_le_i32 vcc, 3, v21
    s_nop 1
    v_cndmask_b32 v119, v29, v119, vcc
    v_cmp_le_i32 vcc, 16, v21
    s_nop 1
    v_cndmask_b32 v120, v29, v120, vcc
    v_cmp_le_i32 vcc, 17, v21
    s_nop 1
    v_cndmask_b32 v121, v29, v121, vcc
    v_cmp_le_i32 vcc, 18, v21
    s_nop 1
    v_cndmask_b32 v122, v29, v122, vcc
    v_cmp_le_i32 vcc, 19, v21
    s_nop 1
    v_cndmask_b32 v123, v29, v123, vcc
    v_max3_f32 v30, v116, v117, v118
    v_max3_f32 v29, v119, v120, v121
    v_max3_f32 v30, v30, v122, v123
    v_max_f32 v30, v30, v29
    v_mov_b32 v29, v30
    s_nop 1
    v_permlane16_swap_b32 v30, v29
    v_max_f32 v30, v30, v29
    v_mov_b32 v29, v30
    s_nop 1
    v_permlane32_swap_b32 v30, v29
    v_max_f32 v30, v30, v29
    v_mul_f32 v30, s71, v30
    v_fma_f32 v116, v116, s71, -v30
    v_fma_f32 v117, v117, s71, -v30
    v_fma_f32 v118, v118, s71, -v30
    v_fma_f32 v119, v119, s71, -v30
    v_fma_f32 v120, v120, s71, -v30
    v_fma_f32 v121, v121, s71, -v30
    v_fma_f32 v122, v122, s71, -v30
    v_fma_f32 v123, v123, s71, -v30
    v_exp_f32 v116, v116
    v_exp_f32 v117, v117
    v_exp_f32 v118, v118
    v_exp_f32 v119, v119
    v_exp_f32 v120, v120
    v_exp_f32 v121, v121
    v_exp_f32 v122, v122
    v_exp_f32 v123, v123
    v_cvt_pk_bf16_f32 v64, v116, v117
    v_cvt_pk_bf16_f32 v65, v118, v119
    v_cvt_pk_bf16_f32 v66, v120, v121
    v_cvt_pk_bf16_f32 v67, v122, v123
    s_nop 1
    v_mfma_f32_16x16x32_bf16 v[48:51], v[160:163], v[64:67], 0
    v_mfma_f32_16x16x32_bf16 v[52:55], v[164:167], v[64:67], 0
    v_mfma_f32_16x16x32_bf16 v[56:59], v[168:171], v[64:67], 0
    v_mfma_f32_16x16x32_bf16 v[60:63], v[172:175], v[64:67], 0
    v_mfma_f32_16x16x32_bf16 v[76:79], v[184:187], v[64:67], 0
    v_mov_b32 v73, 0
    v_mov_b32 v74, 0
    s_mov_b32 s72, 0x41c00000
    s_add_u32 s74, s68, 3
    s_cmp_ge_u32 s74, 64
    s_cbranch_scc1 atnp_33
    s_lshl_b32 s9, s74, 15
    s_mov_b32 m0, s67
    s_nop 0
    buffer_load_dwordx4 v12, s[60:63], s9 offen offset:0 sc1 lds
    buffer_load_dwordx4 v12, s[60:63], s9 offen offset:1024 sc1 lds
    buffer_load_dwordx4 v12, s[60:63], s9 offen offset:2048 sc1 lds
    buffer_load_dwordx4 v12, s[60:63], s9 offen offset:3072 sc1 lds
    s_add_u32 s10, s67, 4096
    s_mov_b32 m0, s10
    s_nop 0
    buffer_load_dwordx4 v13, s[60:63], s9 offen offset:0 sc1 lds
    buffer_load_dwordx4 v13, s[60:63], s9 offen offset:1024 sc1 lds
    buffer_load_dwordx4 v13, s[60:63], s9 offen offset:2048 sc1 lds
    buffer_load_dwordx4 v13, s[60:63], s9 offen offset:3072 sc1 lds
    s_add_u32 s9, s74, 1
    v_cmp_gt_u32 vcc, s9, v19
    s_cbranch_vccz atk_34
wf_35:
    buffer_load_dword v19, v14, s[60:63], 0 offen sc1
    s_waitcnt vmcnt(0)
    v_cmp_gt_u32 vcc, s9, v19
    s_cbranch_vccz wfd_36
    s_sleep 1
    s_sub_u32 s8, s8, 1
    s_cbranch_scc0 wf_35
    s_mov_b32 s8, 0
wfd_36:
atk_34:
    s_mul_i32 s9, s5, 16384
    s_mul_i32 s10, s74, 524288
    s_add_u32 s9, s9, s10
    s_add_u32 s9, s9, 8388608
    s_add_u32 s10, s9, 4096
    buffer_load_dwordx4 v[128:131], v4, s[60:63], s9 offen offset:0 sc1
    buffer_load_dwordx4 v[132:135], v4, s[60:63], s9 offen offset:1024 sc1
    buffer_load_dwordx4 v[136:139], v4, s[60:63], s9 offen offset:2048 sc1
    buffer_load_dwordx4 v[140:143], v4, s[60:63], s9 offen offset:3072 sc1
    buffer_load_dwordx4 v[144:147], v4, s[60:63], s10 offen offset:0 sc1
    buffer_load_dwordx4 v[148:151], v4, s[60:63], s10 offen offset:1024 sc1
    buffer_load_dwordx4 v[152:155], v4, s[60:63], s10 offen offset:2048 sc1
    buffer_load_dwordx4 v[156:159], v4, s[60:63], s10 offen offset:3072 sc1
    buffer_load_dwordx4 v[160:163], v17, s[60:63], s9 offen offset:0 sc1
    buffer_load_dwordx4 v[164:167], v17, s[60:63], s10 offen offset:0 sc1
    buffer_load_dwordx4 v[168:171], v17, s[60:63], s9 offen offset:1024 sc1
    buffer_load_dwordx4 v[172:175], v17, s[60:63], s10 offen offset:1024 sc1
    buffer_load_dword v19, v14, s[60:63], 0 offen sc1
atnp_33:
    s_and_b32 s74, s69, 1
    s_lshl_b32 s9, s64, 1
    s_add_u32 s74, s74, s9
    s_mul_i32 s74, s74, 1310720
    s_add_u32 s74, s74, 58720256
    s_bfe_u32 s13, s69, 0x10001
    s_add_u32 s69, s69, 1
km_37:
    buffer_load_dwordx4 v[68:71], v4, s[60:63], s73 offen sc1
    s_waitcnt vmcnt(0)
    v_max3_u32 v28, v68, v69, v70
    v_max_u32 v28, v28, v71
    v_cmp_eq_u32 vcc, -1, v28
    s_cbranch_vccz kmd_38
    s_sleep 1
    s_sub_u32 s8, s8, 1
    s_cbranch_scc0 km_37
    s_mov_b32 s8, 0
kmd_38:
    ds_write2_b32 v15, v68, v69 offset0:0 offset1:4
    ds_write_b64 v18, v[70:71]
    v_lshlrev_b32 v180, 16, v176
    v_and_b32 v181, 0xffff0000, v176
    v_lshlrev_b32 v182, 16, v177
    v_and_b32 v183, 0xffff0000, v177
    s_waitcnt lgkmcnt(0)
    s_barrier
    ds_read_b128 v[96:99], v22 offset:0
    ds_read_b128 v[100:103], v22 offset:512
    ds_read_b128 v[104:107], v22 offset:1024
    ds_read_b128 v[108:111], v22 offset:1536
    ds_read_b64 v[112:113], v23 offset:0
    ds_read_b64 v[114:115], v23 offset:512
    s_waitcnt lgkmcnt(5)
    v_mfma_f32_16x16x32_bf16 v[124:127], v[96:99], v[32:35], 0
    s_waitcnt lgkmcnt(4)
    v_mfma_f32_16x16x32_bf16 v[124:127], v[100:103], v[36:39], v[124:127]
    s_waitcnt lgkmcnt(3)
    v_mfma_f32_16x16x32_bf16 v[124:127], v[104:107], v[40:43], v[124:127]
    s_waitcnt lgkmcnt(2)
    v_mfma_f32_16x16x32_bf16 v[124:127], v[108:111], v[44:47], v[124:127]
    s_nop 7
    v_fma_f32 v124, v124, s71, -v30
    v_fma_f32 v125, v125, s71, -v30
    v_max_f32 v28, v124, v125
    v_cmp_nge_f32 vcc, s72, v28
    s_cbranch_vccnz L_AT_resc_near
L_AT_rescd_near:
    v_exp_f32 v124, v124
    v_exp_f32 v125, v125
    s_waitcnt lgkmcnt(0)
    v_cvt_pk_bf16_f32 v72, v124, v125
    v_cvt_pk_bf16_f32 v75, v124, v125
    s_nop 0
    v_mfma_f32_16x16x16_bf16 v[76:79], v[184:185], v[72:73], v[76:79]
    v_mfma_f32_16x16x16_bf16 v[48:51], v[112:113], v[72:73], v[48:51]
    v_mfma_f32_16x16x16_bf16 v[52:55], v[112:113], v[74:75], v[52:55]
    v_mfma_f32_16x16x16_bf16 v[56:59], v[114:115], v[72:73], v[56:59]
    v_mfma_f32_16x16x16_bf16 v[60:63], v[114:115], v[74:75], v[60:63]
    s_nop 3
    v_rcp_f32 v28, v76
    s_nop 0
    v_pk_mul_f32 v[48:49], v[48:49], v[28:29] op_sel_hi:[1,0]
    v_pk_mul_f32 v[50:51], v[50:51], v[28:29] op_sel_hi:[1,0]
    v_pk_mul_f32 v[52:53], v[52:53], v[28:29] op_sel_hi:[1,0]
    v_pk_mul_f32 v[54:55], v[54:55], v[28:29] op_sel_hi:[1,0]
    v_cvt_pk_bf16_f32 v64, v48, v52
    v_cvt_pk_bf16_f32 v65, v49, v53
    v_cvt_pk_bf16_f32 v66, v50, v54
    v_cvt_pk_bf16_f32 v67, v51, v55
    ds_write_b128 v11, v[64:67] offset:0
    v_pk_mul_f32 v[56:57], v[56:57], v[28:29] op_sel_hi:[1,0]
    v_pk_mul_f32 v[58:59], v[58:59], v[28:29] op_sel_hi:[1,0]
    v_pk_mul_f32 v[60:61], v[60:61], v[28:29] op_sel_hi:[1,0]
    v_pk_mul_f32 v[62:63], v[62:63], v[28:29] op_sel_hi:[1,0]
    v_cvt_pk_bf16_f32 v68, v56, v60
    v_cvt_pk_bf16_f32 v69, v57, v61
    v_cvt_pk_bf16_f32 v70, v58, v62
    v_cvt_pk_bf16_f32 v71, v59, v63
    ds_write_b128 v11, v[68:71] offset:1024
    s_waitcnt lgkmcnt(0)
    s_barrier
    ds_read_b128 v[32:35], v4 offset:40960
    ds_read_b128 v[36:39], v4 offset:41984
    ds_read_b128 v[40:43], v4 offset:43008
    ds_read_b128 v[44:47], v4 offset:44032
    ds_read_b128 v[48:51], v4 offset:45056
    ds_read_b128 v[52:55], v4 offset:46080
    ds_read_b128 v[56:59], v4 offset:47104
    ds_read_b128 v[60:63], v4 offset:48128
    s_waitcnt lgkmcnt(7)
    v_mfma_f32_16x16x32_bf16 v[64:67], v[32:35], a[128:131], 0
    v_mfma_f32_16x16x32_bf16 v[68:71], v[32:35], a[132:135], 0
    v_mfma_f32_16x16x32_bf16 v[72:75], v[32:35], a[136:139], 0
    v_mfma_f32_16x16x32_bf16 v[76:79], v[32:35], a[140:143], 0
    v_mfma_f32_16x16x32_bf16 v[80:83], v[32:35], a[144:147], 0
    v_mfma_f32_16x16x32_bf16 v[84:87], v[32:35], a[148:151], 0
    v_mfma_f32_16x16x32_bf16 v[88:91], v[32:35], a[152:155], 0
    v_mfma_f32_16x16x32_bf16 v[92:95], v[32:35], a[156:159], 0
    s_waitcnt lgkmcnt(6)
    v_mfma_f32_16x16x32_bf16 v[64:67], v[36:39], a[160:163], v[64:67]
    v_mfma_f32_16x16x32_bf16 v[68:71], v[36:39], a[164:167], v[68:71]
    v_mfma_f32_16x16x32_bf16 v[72:75], v[36:39], a[168:171], v[72:75]
    v_mfma_f32_16x16x32_bf16 v[76:79], v[36:39], a[172:175], v[76:79]
    v_mfma_f32_16x16x32_bf16 v[80:83], v[36:39], a[176:179], v[80:83]
    v_mfma_f32_16x16x32_bf16 v[84:87], v[36:39], a[180:183], v[84:87]
    v_mfma_f32_16x16x32_bf16 v[88:91], v[36:39], a[184:187], v[88:91]
    v_mfma_f32_16x16x32_bf16 v[92:95], v[36:39], a[188:191], v[92:95]
    s_waitcnt lgkmcnt(5)
    v_mfma_f32_16x16x32_bf16 v[64:67], v[40:43], a[192:195], v[64:67]
    v_mfma_f32_16x16x32_bf16 v[68:71], v[40:43], a[196:199], v[68:71]
    v_mfma_f32_16x16x32_bf16 v[72:75], v[40:43], a[200:203], v[72:75]
    v_mfma_f32_16x16x32_bf16 v[76:79], v[40:43], a[204:207], v[76:79]
    v_mfma_f32_16x16x32_bf16 v[80:83], v[40:43], a[208:211], v[80:83]
    v_mfma_f32_16x16x32_bf16 v[84:87], v[40:43], a[212:215], v[84:87]
    v_mfma_f32_16x16x32_bf16 v[88:91], v[40:43], a[216:219], v[88:91]
    v_mfma_f32_16x16x32_bf16 v[92:95], v[40:43], a[220:223], v[92:95]
    s_waitcnt lgkmcnt(4)
    v_mfma_f32_16x16x32_bf16 v[64:67], v[44:47], a[224:227], v[64:67]
    v_mfma_f32_16x16x32_bf16 v[68:71], v[44:47], a[228:231], v[68:71]
    v_mfma_f32_16x16x32_bf16 v[72:75], v[44:47], a[232:235], v[72:75]
    v_mfma_f32_16x16x32_bf16 v[76:79], v[44:47], a[236:239], v[76:79]
    v_mfma_f32_16x16x32_bf16 v[80:83], v[44:47], a[240:243], v[80:83]
    v_mfma_f32_16x16x32_bf16 v[84:87], v[44:47], a[244:247], v[84:87]
    v_mfma_f32_16x16x32_bf16 v[88:91], v[44:47], a[248:251], v[88:91]
    v_mfma_f32_16x16x32_bf16 v[92:95], v[44:47], a[252:255], v[92:95]
    s_waitcnt lgkmcnt(0)
    v_mfma_f32_16x16x32_bf16 v[96:99], v[48:51], a[128:131], 0
    v_mfma_f32_16x16x32_bf16 v[100:103], v[48:51], a[132:135], 0
    v_mfma_f32_16x16x32_bf16 v[104:107], v[48:51], a[136:139], 0
    v_mfma_f32_16x16x32_bf16 v[108:111], v[48:51], a[140:143], 0
    v_mfma_f32_16x16x32_bf16 v[112:115], v[48:51], a[144:147], 0
    v_cvt_pk_bf16_f32 v192, v64, v68
    v_mfma_f32_16x16x32_bf16 v[116:119], v[48:51], a[148:151], 0
    v_cvt_pk_bf16_f32 v193, v72, v76
    v_mfma_f32_16x16x32_bf16 v[120:123], v[48:51], a[152:155], 0
    v_cvt_pk_bf16_f32 v194, v80, v84
    v_mfma_f32_16x16x32_bf16 v[124:127], v[48:51], a[156:159], 0
    v_cvt_pk_bf16_f32 v195, v88, v92
    v_mfma_f32_16x16x32_bf16 v[96:99], v[52:55], a[160:163], v[96:99]
    v_and_or_b32 v192, v192, -2, s13
    v_mfma_f32_16x16x32_bf16 v[100:103], v[52:55], a[164:167], v[100:103]
    s_add_u32 s9, s74, 0
    buffer_store_dwordx4 v[192:195], v6, s[60:63], s9 offen
    v_mfma_f32_16x16x32_bf16 v[104:107], v[52:55], a[168:171], v[104:107]
    v_cvt_pk_bf16_f32 v196, v65, v69
    v_mfma_f32_16x16x32_bf16 v[108:111], v[52:55], a[172:175], v[108:111]
    v_cvt_pk_bf16_f32 v197, v73, v77
    v_mfma_f32_16x16x32_bf16 v[112:115], v[52:55], a[176:179], v[112:115]
    v_cvt_pk_bf16_f32 v198, v81, v85
    v_mfma_f32_16x16x32_bf16 v[116:119], v[52:55], a[180:183], v[116:119]
    v_cvt_pk_bf16_f32 v199, v89, v93
    v_mfma_f32_16x16x32_bf16 v[120:123], v[52:55], a[184:187], v[120:123]
    v_and_or_b32 v196, v196, -2, s13
    v_mfma_f32_16x16x32_bf16 v[124:127], v[52:55], a[188:191], v[124:127]
    s_add_u32 s9, s74, 33024
    buffer_store_dwordx4 v[196:199], v6, s[60:63], s9 offen
    v_mfma_f32_16x16x32_bf16 v[96:99], v[56:59], a[192:195], v[96:99]
    v_cvt_pk_bf16_f32 v200, v66, v70
    v_mfma_f32_16x16x32_bf16 v[100:103], v[56:59], a[196:199], v[100:103]
    v_cvt_pk_bf16_f32 v201, v74, v78
    v_mfma_f32_16x16x32_bf16 v[104:107], v[56:59], a[200:203], v[104:107]
    v_cvt_pk_bf16_f32 v202, v82, v86
    v_mfma_f32_16x16x32_bf16 v[108:111], v[56:59], a[204:207], v[108:111]
    v_cvt_pk_bf16_f32 v203, v90, v94
    v_mfma_f32_16x16x32_bf16 v[112:115], v[56:59], a[208:211], v[112:115]
    v_and_or_b32 v200, v200, -2, s13
    v_mfma_f32_16x16x32_bf16 v[116:119], v[56:59], a[212:215], v[116:119]
    s_add_u32 s9, s74, 66048
    buffer_store_dwordx4 v[200:203], v6, s[60:63], s9 offen
    v_mfma_f32_16x16x32_bf16 v[120:123], v[56:59], a[216:219], v[120:123]
    v_cvt_pk_bf16_f32 v204, v67, v71
    v_mfma_f32_16x16x32_bf16 v[124:127], v[56:59], a[220:223], v[124:127]
    v_cvt_pk_bf16_f32 v205, v75, v79
    v_mfma_f32_16x16x32_bf16 v[96:99], v[60:63], a[224:227], v[96:99]
    v_cvt_pk_bf16_f32 v206, v83, v87
    v_mfma_f32_16x16x32_bf16 v[100:103], v[60:63], a[228:231], v[100:103]
    v_cvt_pk_bf16_f32 v207, v91, v95
    v_mfma_f32_16x16x32_bf16 v[104:107], v[60:63], a[232:235], v[104:107]
    v_and_or_b32 v204, v204, -2, s13
    v_mfma_f32_16x16x32_bf16 v[108:111], v[60:63], a[236:239], v[108:111]
    s_add_u32 s9, s74, 99072
    buffer_store_dwordx4 v[204:207], v6, s[60:63], s9 offen
    v_mfma_f32_16x16x32_bf16 v[112:115], v[60:63], a[240:243], v[112:115]
    v_mfma_f32_16x16x32_bf16 v[116:119], v[60:63], a[244:247], v[116:119]
    v_mfma_f32_16x16x32_bf16 v[120:123], v[60:63], a[248:251], v[120:123]
    v_mfma_f32_16x16x32_bf16 v[124:127], v[60:63], a[252:255], v[124:127]
    v_cvt_pk_bf16_f32 v192, v96, v100
    s_nop 0
    v_cvt_pk_bf16_f32 v193, v104, v108
    s_nop 2
    v_cvt_pk_bf16_f32 v194, v112, v116
    s_nop 0
    v_cvt_pk_bf16_f32 v195, v120, v124
    v_and_or_b32 v192, v192, -2, s13
    s_add_u32 s9, s74, 528384
    buffer_store_dwordx4 v[192:195], v6, s[60:63], s9 offen
    v_cvt_pk_bf16_f32 v196, v97, v101
    v_cvt_pk_bf16_f32 v197, v105, v109
    v_cvt_pk_bf16_f32 v198, v113, v117
    v_cvt_pk_bf16_f32 v199, v121, v125
    v_and_or_b32 v196, v196, -2, s13
    s_add_u32 s9, s74, 561408
    buffer_store_dwordx4 v[196:199], v6, s[60:63], s9 offen
    v_cvt_pk_bf16_f32 v200, v98, v102
    v_cvt_pk_bf16_f32 v201, v106, v110
    v_cvt_pk_bf16_f32 v202, v114, v118
    v_cvt_pk_bf16_f32 v203, v122, v126
    v_and_or_b32 v200, v200, -2, s13
    s_add_u32 s9, s74, 594432
    buffer_store_dwordx4 v[200:203], v6, s[60:63], s9 offen
    v_cvt_pk_bf16_f32 v204, v99, v103
    v_cvt_pk_bf16_f32 v205, v107, v111
    v_cvt_pk_bf16_f32 v206, v115, v119
    v_cvt_pk_bf16_f32 v207, v123, v127
    v_and_or_b32 v204, v204, -2, s13
    s_add_u32 s9, s74, 627456
    buffer_store_dwordx4 v[204:207], v6, s[60:63], s9 offen
    s_cmp_gt_u32 s69, 2
    s_cbranch_scc1 att_39
    s_waitcnt vmcnt(0)
    v_mov_b32 v28, s69
    s_mov_b64 exec, 1
    buffer_store_dword v28, off, s[60:63], s65
    s_mov_b64 exec, -1
wf_40:
    buffer_load_dwordx2 v[28:29], v16, s[60:63], 0 offen sc1
    s_waitcnt vmcnt(0)
    v_min_u32 v28, v28, v29
    v_cmp_gt_u32 vcc, s69, v28
    s_cbranch_vccz wfd_41
    s_sub_u32 s8, s8, 1
    s_cbranch_scc0 wf_40
    s_mov_b32 s8, 0
wfd_41:
att_39:
    s_waitcnt vmcnt(0)
rs_42:
    s_add_u32 s9, s74, 0
    buffer_load_dwordx4 v[32:35], v7, s[60:63], s9 offen sc1
    s_add_u32 s9, s74, 4096
    buffer_load_dwordx4 v[36:39], v7, s[60:63], s9 offen sc1
    s_add_u32 s9, s74, 8192
    buffer_load_dwordx4 v[40:43], v7, s[60:63], s9 offen sc1
    s_add_u32 s9, s74, 12288
    buffer_load_dwordx4 v[44:47], v7, s[60:63], s9 offen sc1
    s_add_u32 s9, s74, 16384
    buffer_load_dwordx4 v[48:51], v7, s[60:63], s9 offen sc1
    s_add_u32 s9, s74, 20480
    buffer_load_dwordx4 v[52:55], v7, s[60:63], s9 offen sc1
    s_add_u32 s9, s74, 24576
    buffer_load_dwordx4 v[56:59], v7, s[60:63], s9 offen sc1
    s_add_u32 s9, s74, 28672
    buffer_load_dwordx4 v[60:63], v7, s[60:63], s9 offen sc1
    s_mov_b64 exec, -1
    s_waitcnt vmcnt(7)
    v_mfma_f32_16x16x32_bf16 v[64:67], v[24:27], v[32:35], 0
    v_xor_b32 v28, s13, v32
    s_waitcnt vmcnt(6)
    v_mfma_f32_16x16x32_bf16 v[64:67], v[24:27], v[36:39], v[64:67]
    v_bitop3_b32 v28, v28, v36, s13 bitop3:0xf6
    s_waitcnt vmcnt(5)
    v_mfma_f32_16x16x32_bf16 v[64:67], v[24:27], v[40:43], v[64:67]
    v_bitop3_b32 v28, v28, v40, s13 bitop3:0xf6
    s_waitcnt vmcnt(4)
    v_mfma_f32_16x16x32_bf16 v[64:67], v[24:27], v[44:47], v[64:67]
    v_bitop3_b32 v28, v28, v44, s13 bitop3:0xf6
    s_waitcnt vmcnt(3)
    v_mfma_f32_16x16x32_bf16 v[64:67], v[24:27], v[48:51], v[64:67]
    v_bitop3_b32 v28, v28, v48, s13 bitop3:0xf6
    s_waitcnt vmcnt(2)
    v_mfma_f32_16x16x32_bf16 v[64:67], v[24:27], v[52:55], v[64:67]
    v_bitop3_b32 v28, v28, v52, s13 bitop3:0xf6
    s_waitcnt vmcnt(1)
    v_mfma_f32_16x16x32_bf16 v[64:67], v[24:27], v[56:59], v[64:67]
    v_bitop3_b32 v28, v28, v56, s13 bitop3:0xf6
    s_waitcnt vmcnt(0)
    v_mfma_f32_16x16x32_bf16 v[64:67], v[24:27], v[60:63], v[64:67]
    v_bitop3_b32 v28, v28, v60, s13 bitop3:0xf6
    v_and_b32 v28, 1, v28
    v_cmp_ne_u32 vcc, 0, v28
    s_cbranch_vccz rsd_43
    s_mov_b64 exec, vcc
    s_sub_u32 s8, s8, 1
    s_cbranch_scc0 rs_42
    s_mov_b32 s8, 0
    s_mov_b64 exec, -1
rsd_43:
    s_nop 3
    v_cvt_pk_bf16_f32 v68, v64, v65
    v_cvt_pk_bf16_f32 v69, v66, v67
    v_lshlrev_b32 v64, 16, v68
    v_and_b32 v65, 0xffff0000, v68
    v_lshlrev_b32 v66, 16, v69
    v_and_b32 v67, 0xffff0000, v69
    v_pk_add_f32 v[64:65], v[64:65], v[180:181]
    v_pk_add_f32 v[66:67], v[66:67], v[182:183]
    v_cvt_pk_bf16_f32 v68, v64, v65
    v_cvt_pk_bf16_f32 v69, v66, v67
    v_lshlrev_b32 v64, 16, v68
    v_and_b32 v65, 0xffff0000, v68
    v_lshlrev_b32 v66, 16, v69
    v_and_b32 v67, 0xffff0000, v69
    v_mov_b64 v[44:45], v[68:69]
    v_pk_add_f32 v[70:71], v[64:65], v[66:67]
    v_pk_mul_f32 v[72:73], v[64:65], v[64:65]
    v_pk_fma_f32 v[72:73], v[66:67], v[66:67], v[72:73]
    v_add_f32 v70, v70, v71
    v_add_f32 v72, v72, v73
    s_nop 0
    v_add_f32_dpp v70, v70, v70 row_ror:8 row_mask:0xf bank_mask:0xf
    v_add_f32_dpp v72, v72, v72 row_ror:8 row_mask:0xf bank_mask:0xf
    s_nop 0
    v_add_f32_dpp v70, v70, v70 row_ror:4 row_mask:0xf bank_mask:0xf
    v_add_f32_dpp v72, v72, v72 row_ror:4 row_mask:0xf bank_mask:0xf
    s_nop 0
    v_add_f32_dpp v70, v70, v70 row_ror:2 row_mask:0xf bank_mask:0xf
    v_add_f32_dpp v72, v72, v72 row_ror:2 row_mask:0xf bank_mask:0xf
    s_nop 0
    v_add_f32_dpp v70, v70, v70 row_ror:1 row_mask:0xf bank_mask:0xf
    v_add_f32_dpp v72, v72, v72 row_ror:1 row_mask:0xf bank_mask:0xf
    v_mov_b32 v71, v72
    s_mov_b64 exec, 0x10001
    ds_write_b64 v20, v[70:71]
    s_mov_b64 exec, -1
    v_mov_b32 v28, 0
    s_add_u32 s9, s75, 4194304
    v_mov_b32 v46, v44
    v_mov_b32 v47, v45
    s_nop 0
    v_permlane16_swap_b32 v44, v46
    v_permlane16_swap_b32 v45, v47
    s_mov_b64 exec, 0xffff
    buffer_store_dwordx4 v[44:47], v8, s[60:63], s9 offen sc1
    s_mov_b64 exec, -1
    s_waitcnt lgkmcnt(0)
    s_barrier
    ds_read_b128 v[32:35], v28 offset:49152
    ds_read_b128 v[36:39], v28 offset:49168
    ds_read_b128 v[40:43], v28 offset:49184
    ds_read_b128 v[44:47], v28 offset:49200
    s_waitcnt lgkmcnt(2)
    v_pk_add_f32 v[32:33], v[32:33], v[34:35]
    v_pk_add_f32 v[36:37], v[36:37], v[38:39]
    s_waitcnt lgkmcnt(0)
    v_pk_add_f32 v[40:41], v[40:41], v[42:43]
    v_pk_add_f32 v[44:45], v[44:45], v[46:47]
    v_pk_add_f32 v[32:33], v[32:33], v[36:37]
    v_pk_add_f32 v[40:41], v[40:41], v[44:45]
    v_pk_add_f32 v[32:33], v[32:33], v[40:41]
    v_mul_f32 v72, 0x3b000000, v32
    v_mul_f32 v74, 0x3b000000, v33
    v_fma_f32 v74, -v72, v72, v74
    v_max_f32 v74, 0, v74
    v_cvt_pk_bf16_f32 v74, v74, v74
    v_lshlrev_b32 v74, 16, v74
    v_add_f32 v74, 0x3727c5ac, v74
    v_cvt_pk_bf16_f32 v72, v72, v72
    v_lshlrev_b32 v72, 16, v72
    v_cvt_pk_bf16_f32 v74, v74, v74
    v_lshlrev_b32 v74, 16, v74
    v_sqrt_f32 v74, v74
    v_pk_add_f32 v[64:65], v[64:65], v[72:73] op_sel_hi:[1,0] neg_lo:[0,1] neg_hi:[0,1]
    v_pk_add_f32 v[66:67], v[66:67], v[72:73] op_sel_hi:[1,0] neg_lo:[0,1] neg_hi:[0,1]
    v_cvt_pk_bf16_f32 v74, v74, v74
    v_lshlrev_b32 v74, 16, v74
    v_rcp_f32 v74, v74
    v_cvt_pk_bf16_f32 v70, v64, v65
    v_cvt_pk_bf16_f32 v71, v66, v67
    v_lshlrev_b32 v64, 16, v70
    v_and_b32 v65, 0xffff0000, v70
    v_lshlrev_b32 v66, 16, v71
    v_and_b32 v67, 0xffff0000, v71
    v_pk_mul_f32 v[64:65], v[64:65], v[74:75] op_sel_hi:[1,0]
    v_pk_mul_f32 v[66:67], v[66:67], v[74:75] op_sel_hi:[1,0]
    v_cvt_pk_bf16_f32 v68, v64, v65
    v_cvt_pk_bf16_f32 v69, v66, v67
    s_lshr_b32 s9, s75, 10
    s_mul_i32 s9, s9, 1024
    s_add_u32 s9, s9, 54525952
    v_mov_b32 v70, v68
    v_mov_b32 v71, v69
    s_nop 0
    v_permlane16_swap_b32 v68, v70
    v_permlane16_swap_b32 v69, v71
    s_mov_b64 exec, 0xffff
    buffer_store_dwordx4 v[68:71], v8, s[60:63], s9 offen sc1
    s_mov_b64 exec, -1
    s_add_u32 s9, s68, 66
    s_cmp_lg_u32 s69, 1
    s_cbranch_scc1 atl_44
    s_add_u32 s10, s70, 3145728
    buffer_store_dwordx4 v[188:191], v4, s[60:63], s10 offen sc1
    s_add_u32 s10, s10, 0x60000
    buffer_store_dwordx4 v[188:191], v4, s[60:63], s10 offen sc1
    s_add_u32 s10, s10, 0x60000
    buffer_store_dwordx4 v[188:191], v4, s[60:63], s10 offen sc1
    s_add_u32 s10, s10, 0x60000
    buffer_store_dwordx4 v[188:191], v4, s[60:63], s10 offen sc1
    s_add_u32 s10, s10, 0x60000
    s_mul_i32 s10, s3, 96
    s_add_u32 s10, s10, s15
    s_add_u32 s10, s10, 768
    s_cmp_ge_u32 s10, 2048
    s_cbranch_scc1 atc_45
    s_lshl_b32 s11, s10, 10
    s_add_u32 s9, s11, 54525952
    buffer_store_dwordx4 v[188:191], v4, s[60:63], s9 offen sc1
    s_add_u32 s9, s11, 4194304
    buffer_store_dwordx4 v[188:191], v4, s[60:63], s9 offen sc1
atc_45:
    s_add_u32 s10, s10, 384
atl_44:
    s_cmp_lg_u32 s69, 2
    s_cbranch_scc1 atl_46
    s_add_u32 s10, s70, 4718592
    buffer_store_dwordx4 v[188:191], v4, s[60:63], s10 offen sc1
    s_add_u32 s10, s10, 0x60000
    buffer_store_dwordx4 v[188:191], v4, s[60:63], s10 offen sc1
    s_add_u32 s10, s10, 0x60000
    buffer_store_dwordx4 v[188:191], v4, s[60:63], s10 offen sc1
    s_add_u32 s10, s10, 0x60000
    buffer_store_dwordx4 v[188:191], v4, s[60:63], s10 offen sc1
    s_add_u32 s10, s10, 0x60000
    s_mul_i32 s10, s3, 96
    s_add_u32 s10, s10, s15
    s_add_u32 s10, s10, 1152
    s_cmp_ge_u32 s10, 2048
    s_cbranch_scc1 atc_47
    s_lshl_b32 s11, s10, 10
    s_add_u32 s9, s11, 54525952
    buffer_store_dwordx4 v[188:191], v4, s[60:63], s9 offen sc1
    s_add_u32 s9, s11, 4194304
    buffer_store_dwordx4 v[188:191], v4, s[60:63], s9 offen sc1
atc_47:
    s_add_u32 s10, s10, 384
atl_46:
    s_cmp_lg_u32 s69, 3
    s_cbranch_scc1 atl_48
    s_add_u32 s10, s70, 6291456
    buffer_store_dwordx4 v[188:191], v4, s[60:63], s10 offen sc1
    s_add_u32 s10, s10, 0x60000
    buffer_store_dwordx4 v[188:191], v4, s[60:63], s10 offen sc1
    s_add_u32 s10, s10, 0x60000
    buffer_store_dwordx4 v[188:191], v4, s[60:63], s10 offen sc1
    s_add_u32 s10, s10, 0x60000
    buffer_store_dwordx4 v[188:191], v4, s[60:63], s10 offen sc1
    s_add_u32 s10, s10, 0x60000
    s_mul_i32 s10, s3, 96
    s_add_u32 s10, s10, s15
    s_add_u32 s10, s10, 1536
    s_cmp_ge_u32 s10, 2048
    s_cbranch_scc1 atc_49
    s_lshl_b32 s11, s10, 10
    s_add_u32 s9, s11, 54525952
    buffer_store_dwordx4 v[188:191], v4, s[60:63], s9 offen sc1
    s_add_u32 s9, s11, 4194304
    buffer_store_dwordx4 v[188:191], v4, s[60:63], s9 offen sc1
atc_49:
    s_add_u32 s10, s10, 384
atl_48:
    s_cmp_lg_u32 s69, 4
    s_cbranch_scc1 atl_50
    s_add_u32 s10, s70, 7864320
    buffer_store_dwordx4 v[188:191], v4, s[60:63], s10 offen sc1
    s_add_u32 s10, s10, 0x60000
    buffer_store_dwordx4 v[188:191], v4, s[60:63], s10 offen sc1
    s_add_u32 s10, s10, 0x60000
    s_mul_i32 s10, s3, 96
    s_add_u32 s10, s10, s15
    s_add_u32 s10, s10, 1920
    s_cmp_ge_u32 s10, 2048
    s_cbranch_scc1 atc_51
    s_lshl_b32 s11, s10, 10
    s_add_u32 s9, s11, 54525952
    buffer_store_dwordx4 v[188:191], v4, s[60:63], s9 offen sc1
    s_add_u32 s9, s11, 4194304
    buffer_store_dwordx4 v[188:191], v4, s[60:63], s9 offen sc1
atc_51:
    s_add_u32 s10, s10, 384
atl_50:
    s_cmp_lg_u32 s69, 5
    s_cbranch_scc1 atl_52
    v_mov_b32 v28, 100
    s_mov_b64 exec, 1
    buffer_store_dword v28, off, s[60:63], s66 sc1
    s_mov_b64 exec, -1
atl_52:
    s_add_u32 s73, s73, 0x60000
    s_add_u32 s9, s70, 8650752
    s_cmp_ge_u32 s73, s9
    s_cselect_b32 s73, s70, s73
    s_add_u32 s68, s68, 3
    s_cmp_lt_u32 s68, 64
    s_cbranch_scc1 L_AT_near
    s_endpgm
L_AT_resc_near:
    v_mov_b32 v29, v28
    s_nop 1
    v_permlane16_swap_b32 v28, v29
    v_max_f32 v28, v28, v29
    v_mov_b32 v29, v28
    s_nop 1
    v_permlane32_swap_b32 v28, v29
    v_max_f32 v28, v28, v29
    v_max_f32 v28, 0, v28
    v_sub_f32 v124, v124, v28
    v_sub_f32 v125, v125, v28
    v_sub_f32 v29, 0, v28
    v_exp_f32 v29, v29
    s_nop 0
    v_mul_f32 v48, v48, v29
    v_mul_f32 v49, v49, v29
    v_mul_f32 v50, v50, v29
    v_mul_f32 v51, v51, v29
    v_mul_f32 v52, v52, v29
    v_mul_f32 v53, v53, v29
    v_mul_f32 v54, v54, v29
    v_mul_f32 v55, v55, v29
    v_mul_f32 v56, v56, v29
    v_mul_f32 v57, v57, v29
    v_mul_f32 v58, v58, v29
    v_mul_f32 v59, v59, v29
    v_mul_f32 v60, v60, v29
    v_mul_f32 v61, v61, v29
    v_mul_f32 v62, v62, v29
    v_mul_f32 v63, v63, v29
    v_mul_f32 v76, v76, v29
    v_mul_f32 v77, v77, v29
    v_mul_f32 v78, v78, v29
    v_mul_f32 v79, v79, v29
    s_branch L_AT_rescd_near
L_AT_far:
    s_lshl_b32 s75, s68, 5
    s_add_u32 s75, s75, s5
    s_lshl_b32 s75, s75, 10
    buffer_load_dwordx2 v[176:177], v8, s[16:19], s75 offen
    ds_read_b128 v[32:35], v4 offset:0
    ds_read_b128 v[36:39], v4 offset:16384
    ds_read_b128 v[40:43], v4 offset:1024
    ds_read_b128 v[44:47], v4 offset:17408
    ds_read_b128 v[48:51], v4 offset:2048
    ds_read_b128 v[52:55], v4 offset:18432
    ds_read_b128 v[56:59], v4 offset:3072
    ds_read_b128 v[60:63], v4 offset:19456
    s_waitcnt lgkmcnt(6)
    v_mfma_f32_16x16x32_bf16 v[64:67], a[0:3], v[32:35], 0
    v_mfma_f32_16x16x32_bf16 v[68:71], a[0:3], v[36:39], 0
    v_mfma_f32_16x16x32_bf16 v[72:75], a[4:7], v[32:35], 0
    v_mfma_f32_16x16x32_bf16 v[76:79], a[4:7], v[36:39], 0
    ds_read_b128 v[32:35], v4 offset:4096
    ds_read_b128 v[36:39], v4 offset:20480
    s_waitcnt lgkmcnt(6)
    v_mfma_f32_16x16x32_bf16 v[64:67], a[8:11], v[40:43], v[64:67]
    v_mfma_f32_16x16x32_bf16 v[68:71], a[8:11], v[44:47], v[68:71]
    v_mfma_f32_16x16x32_bf16 v[72:75], a[12:15], v[40:43], v[72:75]
    v_mfma_f32_16x16x32_bf16 v[76:79], a[12:15], v[44:47], v[76:79]
    ds_read_b128 v[40:43], v4 offset:5120
    ds_read_b128 v[44:47], v4 offset:21504
    s_waitcnt lgkmcnt(6)
    v_mfma_f32_16x16x32_bf16 v[64:67], a[16:19], v[48:51], v[64:67]
    v_mfma_f32_16x16x32_bf16 v[68:71], a[16:19], v[52:55], v[68:71]
    v_mfma_f32_16x16x32_bf16 v[72:75], a[20:23], v[48:51], v[72:75]
    v_mfma_f32_16x16x32_bf16 v[76:79], a[20:23], v[52:55], v[76:79]
    ds_read_b128 v[48:51], v4 offset:6144
    ds_read_b128 v[52:55], v4 offset:22528
    s_waitcnt lgkmcnt(6)
    v_mfma_f32_16x16x32_bf16 v[64:67], a[24:27], v[56:59], v[64:67]
    v_mfma_f32_16x16x32_bf16 v[68:71], a[24:27], v[60:63], v[68:71]
    v_mfma_f32_16x16x32_bf16 v[72:75], a[28:31], v[56:59], v[72:75]
    v_mfma_f32_16x16x32_bf16 v[76:79], a[28:31], v[60:63], v[76:79]
    ds_read_b128 v[56:59], v4 offset:7168
    ds_read_b128 v[60:63], v4 offset:23552
    s_waitcnt lgkmcnt(6)
    v_mfma_f32_16x16x32_bf16 v[64:67], a[32:35], v[32:35], v[64:67]
    v_mfma_f32_16x16x32_bf16 v[68:71], a[32:35], v[36:39], v[68:71]
    v_mfma_f32_16x16x32_bf16 v[72:75], a[36:39], v[32:35], v[72:75]
    v_mfma_f32_16x16x32_bf16 v[76:79], a[36:39], v[36:39], v[76:79]
    ds_read_b128 v[32:35], v4 offset:8192
    ds_read_b128 v[36:39], v4 offset:24576
    s_waitcnt lgkmcnt(6)
    v_mfma_f32_16x16x32_bf16 v[64:67], a[40:43], v[40:43], v[64:67]
    v_mfma_f32_16x16x32_bf16 v[68:71], a[40:43], v[44:47], v[68:71]
    v_mfma_f32_16x16x32_bf16 v[72:75], a[44:47], v[40:43], v[72:75]
    v_mfma_f32_16x16x32_bf16 v[76:79], a[44:47], v[44:47], v[76:79]
    ds_read_b128 v[40:43], v4 offset:9216
    ds_read_b128 v[44:47], v4 offset:25600
    s_waitcnt lgkmcnt(6)
    v_mfma_f32_16x16x32_bf16 v[64:67], a[48:51], v[48:51], v[64:67]
    v_mfma_f32_16x16x32_bf16 v[68:71], a[48:51], v[52:55], v[68:71]
    v_mfma_f32_16x16x32_bf16 v[72:75], a[52:55], v[48:51], v[72:75]
    v_mfma_f32_16x16x32_bf16 v[76:79], a[52:55], v[52:55], v[76:79]
    ds_read_b128 v[48:51], v4 offset:10240
    ds_read_b128 v[52:55], v4 offset:26624
    s_waitcnt lgkmcnt(6)
    v_mfma_f32_16x16x32_bf16 v[64:67], a[56:59], v[56:59], v[64:67]
    v_mfma_f32_16x16x32_bf16 v[68:71], a[56:59], v[60:63], v[68:71]
    v_mfma_f32_16x16x32_bf16 v[72:75], a[60:63], v[56:59], v[72:75]
    v_mfma_f32_16x16x32_bf16 v[76:79], a[60:63], v[60:63], v[76:79]
    ds_read_b128 v[56:59], v4 offset:11264
    ds_read_b128 v[60:63], v4 offset:27648
    s_waitcnt lgkmcnt(6)
    v_mfma_f32_16x16x32_bf16 v[64:67], a[64:67], v[32:35], v[64:67]
    v_mfma_f32_16x16x32_bf16 v[68:71], a[64:67], v[36:39], v[68:71]
    v_mfma_f32_16x16x32_bf16 v[72:75], a[68:71], v[32:35], v[72:75]
    v_mfma_f32_16x16x32_bf16 v[76:79], a[68:71], v[36:39], v[76:79]
    ds_read_b128 v[32:35], v4 offset:12288
    ds_read_b128 v[36:39], v4 offset:28672
    s_waitcnt lgkmcnt(6)
    v_mfma_f32_16x16x32_bf16 v[64:67], a[72:75], v[40:43], v[64:67]
    v_mfma_f32_16x16x32_bf16 v[68:71], a[72:75], v[44:47], v[68:71]
    v_mfma_f32_16x16x32_bf16 v[72:75], a[76:79], v[40:43], v[72:75]
    v_mfma_f32_16x16x32_bf16 v[76:79], a[76:79], v[44:47], v[76:79]
    ds_read_b128 v[40:43], v4 offset:13312
    ds_read_b128 v[44:47], v4 offset:29696
    s_waitcnt lgkmcnt(6)
    v_mfma_f32_16x16x32_bf16 v[64:67], a[80:83], v[48:51], v[64:67]
    v_mfma_f32_16x16x32_bf16 v[68:71], a[80:83], v[52:55], v[68:71]
    v_mfma_f32_16x16x32_bf16 v[72:75], a[84:87], v[48:51], v[72:75]
    v_mfma_f32_16x16x32_bf16 v[76:79], a[84:87], v[52:55], v[76:79]
    ds_read_b128 v[48:51], v4 offset:14336
    ds_read_b128 v[52:55], v4 offset:30720
    s_waitcnt lgkmcnt(6)
    v_mfma_f32_16x16x32_bf16 v[64:67], a[88:91], v[56:59], v[64:67]
    v_mfma_f32_16x16x32_bf16 v[68:71], a[88:91], v[60:63], v[68:71]
    v_mfma_f32_16x16x32_bf16 v[72:75], a[92:95], v[56:59], v[72:75]
    v_mfma_f32_16x16x32_bf16 v[76:79], a[92:95], v[60:63], v[76:79]
    ds_read_b128 v[56:59], v4 offset:15360
    ds_read_b128 v[60:63], v4 offset:31744
    s_waitcnt lgkmcnt(6)
    v_mfma_f32_16x16x32_bf16 v[64:67], a[96:99], v[32:35], v[64:67]
    v_mfma_f32_16x16x32_bf16 v[68:71], a[96:99], v[36:39], v[68:71]
    v_mfma_f32_16x16x32_bf16 v[72:75], a[100:103], v[32:35], v[72:75]
    v_mfma_f32_16x16x32_bf16 v[76:79], a[100:103], v[36:39], v[76:79]
    s_waitcnt lgkmcnt(4)
    v_mfma_f32_16x16x32_bf16 v[64:67], a[104:107], v[40:43], v[64:67]
    v_mfma_f32_16x16x32_bf16 v[68:71], a[104:107], v[44:47], v[68:71]
    v_mfma_f32_16x16x32_bf16 v[72:75], a[108:111], v[40:43], v[72:75]
    v_mfma_f32_16x16x32_bf16 v[76:79], a[108:111], v[44:47], v[76:79]
    s_waitcnt lgkmcnt(2)
    v_mfma_f32_16x16x32_bf16 v[64:67], a[112:115], v[48:51], v[64:67]
    v_mfma_f32_16x16x32_bf16 v[68:71], a[112:115], v[52:55], v[68:71]
    v_mfma_f32_16x16x32_bf16 v[72:75], a[116:119], v[48:51], v[72:75]
    v_mfma_f32_16x16x32_bf16 v[76:79], a[116:119], v[52:55], v[76:79]
    s_waitcnt lgkmcnt(0)
    v_mfma_f32_16x16x32_bf16 v[64:67], a[120:123], v[56:59], v[64:67]
    v_mfma_f32_16x16x32_bf16 v[68:71], a[120:123], v[60:63], v[68:71]
    v_mfma_f32_16x16x32_bf16 v[72:75], a[124:127], v[56:59], v[72:75]
    v_mfma_f32_16x16x32_bf16 v[76:79], a[124:127], v[60:63], v[76:79]
    s_nop 6
    v_cvt_pk_bf16_f32 v80, v64, v72
    v_cvt_pk_bf16_f32 v81, v65, v73
    v_cvt_pk_bf16_f32 v82, v66, v74
    v_cvt_pk_bf16_f32 v83, v67, v75
    ds_write_b128 v9, v[80:83] offset:0
    v_cvt_pk_bf16_f32 v84, v68, v76
    v_cvt_pk_bf16_f32 v85, v69, v77
    v_cvt_pk_bf16_f32 v86, v70, v78
    v_cvt_pk_bf16_f32 v87, v71, v79
    ds_write_b128 v9, v[84:87] offset:4096
    s_waitcnt lgkmcnt(0)
    s_barrier
    ds_read_b128 v[32:35], v10 offset:0
    ds_read_b128 v[36:39], v10 offset:1024
    ds_read_b128 v[40:43], v10 offset:2048
    ds_read_b128 v[44:47], v10 offset:3072
    s_waitcnt lgkmcnt(0)
    v_mfma_f32_16x16x32_bf16 v[116:119], v[128:131], v[32:35], 0
    v_mfma_f32_16x16x32_bf16 v[120:123], v[144:147], v[32:35], 0
    v_mfma_f32_16x16x32_bf16 v[116:119], v[132:135], v[36:39], v[116:119]
    v_mfma_f32_16x16x32_bf16 v[120:123], v[148:151], v[36:39], v[120:123]
    v_mfma_f32_16x16x32_bf16 v[116:119], v[136:139], v[40:43], v[116:119]
    v_mfma_f32_16x16x32_bf16 v[120:123], v[152:155], v[40:43], v[120:123]
    v_mfma_f32_16x16x32_bf16 v[116:119], v[140:143], v[44:47], v[116:119]
    v_mfma_f32_16x16x32_bf16 v[120:123], v[156:159], v[44:47], v[120:123]
    v_mov_b32 v29, 0xf149f2ca
    v_cmp_le_i32 vcc, 0, v21
    s_nop 4
    v_cndmask_b32 v116, v29, v116, vcc
    v_cmp_le_i32 vcc, 1, v21
    s_nop 1
    v_cndmask_b32 v117, v29, v117, vcc
    v_cmp_le_i32 vcc, 2, v21
    s_nop 1
    v_cndmask_b32 v118, v29, v118, vcc
    v_cmp_le_i32 vcc, 3, v21
    s_nop 1
    v_cndmask_b32 v119, v29, v119, vcc
    v_cmp_le_i32 vcc, 16, v21
    s_nop 1
    v_cndmask_b32 v120, v29, v120, vcc
    v_cmp_le_i32 vcc, 17, v21
    s_nop 1
    v_cndmask_b32 v121, v29, v121, vcc
    v_cmp_le_i32 vcc, 18, v21
    s_nop 1
    v_cndmask_b32 v122, v29, v122, vcc
    v_cmp_le_i32 vcc, 19, v21
    s_nop 1
    v_cndmask_b32 v123, v29, v123, vcc
    v_max3_f32 v30, v116, v117, v118
    v_max3_f32 v29, v119, v120, v121
    v_max3_f32 v30, v30, v122, v123
    v_max_f32 v30, v30, v29
    v_mov_b32 v29, v30
    s_nop 1
    v_permlane16_swap_b32 v30, v29
    v_max_f32 v30, v30, v29
    v_mov_b32 v29, v30
    s_nop 1
    v_permlane32_swap_b32 v30, v29
    v_max_f32 v30, v30, v29
    v_mul_f32 v30, s71, v30
    v_fma_f32 v116, v116, s71, -v30
    v_fma_f32 v117, v117, s71, -v30
    v_fma_f32 v118, v118, s71, -v30
    v_fma_f32 v119, v119, s71, -v30
    v_fma_f32 v120, v120, s71, -v30
    v_fma_f32 v121, v121, s71, -v30
    v_fma_f32 v122, v122, s71, -v30
    v_fma_f32 v123, v123, s71, -v30
    v_exp_f32 v116, v116
    v_exp_f32 v117, v117
    v_exp_f32 v118, v118
    v_exp_f32 v119, v119
    v_exp_f32 v120, v120
    v_exp_f32 v121, v121
    v_exp_f32 v122, v122
    v_exp_f32 v123, v123
    v_cvt_pk_bf16_f32 v64, v116, v117
    v_cvt_pk_bf16_f32 v65, v118, v119
    v_cvt_pk_bf16_f32 v66, v120, v121
    v_cvt_pk_bf16_f32 v67, v122, v123
    s_nop 1
    v_mfma_f32_16x16x32_bf16 v[48:51], v[160:163], v[64:67], 0
    v_mfma_f32_16x16x32_bf16 v[52:55], v[164:167], v[64:67], 0
    v_mfma_f32_16x16x32_bf16 v[56:59], v[168:171], v[64:67], 0
    v_mfma_f32_16x16x32_bf16 v[60:63], v[172:175], v[64:67], 0
    v_mfma_f32_16x16x32_bf16 v[76:79], v[184:187], v[64:67], 0
    v_mov_b32 v73, 0
    v_mov_b32 v74, 0
    s_mov_b32 s72, 0x41c00000
    s_add_u32 s74, s68, 3
    s_cmp_ge_u32 s74, 64
    s_cbranch_scc1 atnp_53
    s_lshl_b32 s9, s74, 15
    s_mov_b32 m0, s67
    s_nop 0
    buffer_load_dwordx4 v12, s[60:63], s9 offen offset:0 sc1 lds
    buffer_load_dwordx4 v12, s[60:63], s9 offen offset:1024 sc1 lds
    buffer_load_dwordx4 v12, s[60:63], s9 offen offset:2048 sc1 lds
    buffer_load_dwordx4 v12, s[60:63], s9 offen offset:3072 sc1 lds
    s_add_u32 s10, s67, 4096
    s_mov_b32 m0, s10
    s_nop 0
    buffer_load_dwordx4 v13, s[60:63], s9 offen offset:0 sc1 lds
    buffer_load_dwordx4 v13, s[60:63], s9 offen offset:1024 sc1 lds
    buffer_load_dwordx4 v13, s[60:63], s9 offen offset:2048 sc1 lds
    buffer_load_dwordx4 v13, s[60:63], s9 offen offset:3072 sc1 lds
    s_add_u32 s9, s74, 1
    v_cmp_gt_u32 vcc, s9, v19
    s_cbranch_vccz atk_54
wf_55:
    buffer_load_dword v19, v14, s[60:63], 0 offen sc1
    s_waitcnt vmcnt(0)
    v_cmp_gt_u32 vcc, s9, v19
    s_cbranch_vccz wfd_56
    s_sleep 1
    s_sub_u32 s8, s8, 1
    s_cbranch_scc0 wf_55
    s_mov_b32 s8, 0
wfd_56:
atk_54:
    s_mul_i32 s9, s5, 16384
    s_mul_i32 s10, s74, 524288
    s_add_u32 s9, s9, s10
    s_add_u32 s9, s9, 8388608
    s_add_u32 s10, s9, 4096
    buffer_load_dwordx4 v[128:131], v4, s[60:63], s9 offen offset:0 sc1
    buffer_load_dwordx4 v[132:135], v4, s[60:63], s9 offen offset:1024 sc1
    buffer_load_dwordx4 v[136:139], v4, s[60:63], s9 offen offset:2048 sc1
    buffer_load_dwordx4 v[140:143], v4, s[60:63], s9 offen offset:3072 sc1
    buffer_load_dwordx4 v[144:147], v4, s[60:63], s10 offen offset:0 sc1
    buffer_load_dwordx4 v[148:151], v4, s[60:63], s10 offen offset:1024 sc1
    buffer_load_dwordx4 v[152:155], v4, s[60:63], s10 offen offset:2048 sc1
    buffer_load_dwordx4 v[156:159], v4, s[60:63], s10 offen offset:3072 sc1
    buffer_load_dwordx4 v[160:163], v17, s[60:63], s9 offen offset:0 sc1
    buffer_load_dwordx4 v[164:167], v17, s[60:63], s10 offen offset:0 sc1
    buffer_load_dwordx4 v[168:171], v17, s[60:63], s9 offen offset:1024 sc1
    buffer_load_dwordx4 v[172:175], v17, s[60:63], s10 offen offset:1024 sc1
    buffer_load_dword v19, v14, s[60:63], 0 offen sc1
atnp_53:
    s_and_b32 s74, s69, 1
    s_lshl_b32 s9, s64, 1
    s_add_u32 s74, s74, s9
    s_mul_i32 s74, s74, 1310720
    s_add_u32 s74, s74, 58720256
    s_bfe_u32 s13, s69, 0x10001
    s_add_u32 s69, s69, 1
km_57:
    buffer_load_dwordx4 v[68:71], v4, s[60:63], s73 offen sc1
    s_waitcnt vmcnt(0)
    v_max3_u32 v28, v68, v69, v70
    v_max_u32 v28, v28, v71
    v_cmp_eq_u32 vcc, -1, v28
    s_cbranch_vccz kmd_58
    s_sleep 1
    s_sub_u32 s8, s8, 1
    s_cbranch_scc0 km_57
    s_mov_b32 s8, 0
kmd_58:
    ds_write2_b32 v15, v68, v69 offset0:0 offset1:4
    ds_write_b64 v18, v[70:71]
    v_lshlrev_b32 v180, 16, v176
    v_and_b32 v181, 0xffff0000, v176
    v_lshlrev_b32 v182, 16, v177
    v_and_b32 v183, 0xffff0000, v177
    s_waitcnt lgkmcnt(0)
    s_barrier
    ds_read_b128 v[96:99], v22 offset:0
    ds_read_b128 v[100:103], v22 offset:512
    ds_read_b128 v[104:107], v22 offset:1024
    ds_read_b128 v[108:111], v22 offset:1536
    ds_read_b64 v[112:113], v23 offset:0
    ds_read_b64 v[114:115], v23 offset:512
    s_waitcnt lgkmcnt(5)
    v_mfma_f32_16x16x32_bf16 v[124:127], v[96:99], v[32:35], 0
    s_waitcnt lgkmcnt(4)
    v_mfma_f32_16x16x32_bf16 v[124:127], v[100:103], v[36:39], v[124:127]
    s_waitcnt lgkmcnt(3)
    v_mfma_f32_16x16x32_bf16 v[124:127], v[104:107], v[40:43], v[124:127]
    s_waitcnt lgkmcnt(2)
    v_mfma_f32_16x16x32_bf16 v[124:127], v[108:111], v[44:47], v[124:127]
    s_nop 7
    v_fma_f32 v124, v124, s71, -v30
    v_fma_f32 v125, v125, s71, -v30
    v_max_f32 v28, v124, v125
    v_cmp_nge_f32 vcc, s72, v28
    s_cbranch_vccnz L_AT_resc_far
L_AT_rescd_far:
    v_exp_f32 v124, v124
    v_exp_f32 v125, v125
    s_waitcnt lgkmcnt(0)
    v_cvt_pk_bf16_f32 v72, v124, v125
    v_cvt_pk_bf16_f32 v75, v124, v125
    s_nop 0
    v_mfma_f32_16x16x16_bf16 v[76:79], v[184:185], v[72:73], v[76:79]
    v_mfma_f32_16x16x16_bf16 v[48:51], v[112:113], v[72:73], v[48:51]
    v_mfma_f32_16x16x16_bf16 v[52:55], v[112:113], v[74:75], v[52:55]
    v_mfma_f32_16x16x16_bf16 v[56:59], v[114:115], v[72:73], v[56:59]
    v_mfma_f32_16x16x16_bf16 v[60:63], v[114:115], v[74:75], v[60:63]
    s_nop 3
    v_rcp_f32 v28, v76
    s_nop 0
    v_pk_mul_f32 v[48:49], v[48:49], v[28:29] op_sel_hi:[1,0]
    v_pk_mul_f32 v[50:51], v[50:51], v[28:29] op_sel_hi:[1,0]
    v_pk_mul_f32 v[52:53], v[52:53], v[28:29] op_sel_hi:[1,0]
    v_pk_mul_f32 v[54:55], v[54:55], v[28:29] op_sel_hi:[1,0]
    v_cvt_pk_bf16_f32 v64, v48, v52
    v_cvt_pk_bf16_f32 v65, v49, v53
    v_cvt_pk_bf16_f32 v66, v50, v54
    v_cvt_pk_bf16_f32 v67, v51, v55
    ds_write_b128 v11, v[64:67] offset:0
    v_pk_mul_f32 v[56:57], v[56:57], v[28:29] op_sel_hi:[1,0]
    v_pk_mul_f32 v[58:59], v[58:59], v[28:29] op_sel_hi:[1,0]
    v_pk_mul_f32 v[60:61], v[60:61], v[28:29] op_sel_hi:[1,0]
    v_pk_mul_f32 v[62:63], v[62:63], v[28:29] op_sel_hi:[1,0]
    v_cvt_pk_bf16_f32 v68, v56, v60
    v_cvt_pk_bf16_f32 v69, v57, v61
    v_cvt_pk_bf16_f32 v70, v58, v62
    v_cvt_pk_bf16_f32 v71, v59, v63
    ds_write_b128 v11, v[68:71] offset:1024
    s_waitcnt lgkmcnt(0)
    s_barrier
    ds_read_b128 v[32:35], v4 offset:40960
    ds_read_b128 v[36:39], v4 offset:41984
    ds_read_b128 v[40:43], v4 offset:43008
    ds_read_b128 v[44:47], v4 offset:44032
    ds_read_b128 v[48:51], v4 offset:45056
    ds_read_b128 v[52:55], v4 offset:46080
    ds_read_b128 v[56:59], v4 offset:47104
    ds_read_b128 v[60:63], v4 offset:48128
    s_waitcnt lgkmcnt(7)
    v_mfma_f32_16x16x32_bf16 v[64:67], v[32:35], a[128:131], 0
    v_mfma_f32_16x16x32_bf16 v[68:71], v[32:35], a[132:135], 0
    v_mfma_f32_16x16x32_bf16 v[72:75], v[32:35], a[136:139], 0
    v_mfma_f32_16x16x32_bf16 v[76:79], v[32:35], a[140:143], 0
    v_mfma_f32_16x16x32_bf16 v[80:83], v[32:35], a[144:147], 0
    v_mfma_f32_16x16x32_bf16 v[84:87], v[32:35], a[148:151], 0
    v_mfma_f32_16x16x32_bf16 v[88:91], v[32:35], a[152:155], 0
    v_mfma_f32_16x16x32_bf16 v[92:95], v[32:35], a[156:159], 0
    s_waitcnt lgkmcnt(6)
    v_mfma_f32_16x16x32_bf16 v[64:67], v[36:39], a[160:163], v[64:67]
    v_mfma_f32_16x16x32_bf16 v[68:71], v[36:39], a[164:167], v[68:71]
    v_mfma_f32_16x16x32_bf16 v[72:75], v[36:39], a[168:171], v[72:75]
    v_mfma_f32_16x16x32_bf16 v[76:79], v[36:39], a[172:175], v[76:79]
    v_mfma_f32_16x16x32_bf16 v[80:83], v[36:39], a[176:179], v[80:83]
    v_mfma_f32_16x16x32_bf16 v[84:87], v[36:39], a[180:183], v[84:87]
    v_mfma_f32_16x16x32_bf16 v[88:91], v[36:39], a[184:187], v[88:91]
    v_mfma_f32_16x16x32_bf16 v[92:95], v[36:39], a[188:191], v[92:95]
    s_waitcnt lgkmcnt(5)
    v_mfma_f32_16x16x32_bf16 v[64:67], v[40:43], a[192:195], v[64:67]
    v_mfma_f32_16x16x32_bf16 v[68:71], v[40:43], a[196:199], v[68:71]
    v_mfma_f32_16x16x32_bf16 v[72:75], v[40:43], a[200:203], v[72:75]
    v_mfma_f32_16x16x32_bf16 v[76:79], v[40:43], a[204:207], v[76:79]
    v_mfma_f32_16x16x32_bf16 v[80:83], v[40:43], a[208:211], v[80:83]
    v_mfma_f32_16x16x32_bf16 v[84:87], v[40:43], a[212:215], v[84:87]
    v_mfma_f32_16x16x32_bf16 v[88:91], v[40:43], a[216:219], v[88:91]
    v_mfma_f32_16x16x32_bf16 v[92:95], v[40:43], a[220:223], v[92:95]
    s_waitcnt lgkmcnt(4)
    v_mfma_f32_16x16x32_bf16 v[64:67], v[44:47], a[224:227], v[64:67]
    v_mfma_f32_16x16x32_bf16 v[68:71], v[44:47], a[228:231], v[68:71]
    v_mfma_f32_16x16x32_bf16 v[72:75], v[44:47], a[232:235], v[72:75]
    v_mfma_f32_16x16x32_bf16 v[76:79], v[44:47], a[236:239], v[76:79]
    v_mfma_f32_16x16x32_bf16 v[80:83], v[44:47], a[240:243], v[80:83]
    v_mfma_f32_16x16x32_bf16 v[84:87], v[44:47], a[244:247], v[84:87]
    v_mfma_f32_16x16x32_bf16 v[88:91], v[44:47], a[248:251], v[88:91]
    v_mfma_f32_16x16x32_bf16 v[92:95], v[44:47], a[252:255], v[92:95]
    s_waitcnt lgkmcnt(0)
    v_mfma_f32_16x16x32_bf16 v[96:99], v[48:51], a[128:131], 0
    v_mfma_f32_16x16x32_bf16 v[100:103], v[48:51], a[132:135], 0
    v_mfma_f32_16x16x32_bf16 v[104:107], v[48:51], a[136:139], 0
    v_mfma_f32_16x16x32_bf16 v[108:111], v[48:51], a[140:143], 0
    v_mfma_f32_16x16x32_bf16 v[112:115], v[48:51], a[144:147], 0
    v_cvt_pk_bf16_f32 v192, v64, v68
    v_mfma_f32_16x16x32_bf16 v[116:119], v[48:51], a[148:151], 0
    v_cvt_pk_bf16_f32 v193, v72, v76
    v_mfma_f32_16x16x32_bf16 v[120:123], v[48:51], a[152:155], 0
    v_cvt_pk_bf16_f32 v194, v80, v84
    v_mfma_f32_16x16x32_bf16 v[124:127], v[48:51], a[156:159], 0
    v_cvt_pk_bf16_f32 v195, v88, v92
    v_mfma_f32_16x16x32_bf16 v[96:99], v[52:55], a[160:163], v[96:99]
    v_and_or_b32 v192, v192, -2, s13
    v_mfma_f32_16x16x32_bf16 v[100:103], v[52:55], a[164:167], v[100:103]
    s_add_u32 s9, s74, 0
    buffer_store_dwordx4 v[192:195], v6, s[60:63], s9 offen sc1
    v_mfma_f32_16x16x32_bf16 v[104:107], v[52:55], a[168:171], v[104:107]
    v_cvt_pk_bf16_f32 v196, v65, v69
    v_mfma_f32_16x16x32_bf16 v[108:111], v[52:55], a[172:175], v[108:111]
    v_cvt_pk_bf16_f32 v197, v73, v77
    v_mfma_f32_16x16x32_bf16 v[112:115], v[52:55], a[176:179], v[112:115]
    v_cvt_pk_bf16_f32 v198, v81, v85
    v_mfma_f32_16x16x32_bf16 v[116:119], v[52:55], a[180:183], v[116:119]
    v_cvt_pk_bf16_f32 v199, v89, v93
    v_mfma_f32_16x16x32_bf16 v[120:123], v[52:55], a[184:187], v[120:123]
    v_and_or_b32 v196, v196, -2, s13
    v_mfma_f32_16x16x32_bf16 v[124:127], v[52:55], a[188:191], v[124:127]
    s_add_u32 s9, s74, 33024
    buffer_store_dwordx4 v[196:199], v6, s[60:63], s9 offen sc1
    v_mfma_f32_16x16x32_bf16 v[96:99], v[56:59], a[192:195], v[96:99]
    v_cvt_pk_bf16_f32 v200, v66, v70
    v_mfma_f32_16x16x32_bf16 v[100:103], v[56:59], a[196:199], v[100:103]
    v_cvt_pk_bf16_f32 v201, v74, v78
    v_mfma_f32_16x16x32_bf16 v[104:107], v[56:59], a[200:203], v[104:107]
    v_cvt_pk_bf16_f32 v202, v82, v86
    v_mfma_f32_16x16x32_bf16 v[108:111], v[56:59], a[204:207], v[108:111]
    v_cvt_pk_bf16_f32 v203, v90, v94
    v_mfma_f32_16x16x32_bf16 v[112:115], v[56:59], a[208:211], v[112:115]
    v_and_or_b32 v200, v200, -2, s13
    v_mfma_f32_16x16x32_bf16 v[116:119], v[56:59], a[212:215], v[116:119]
    s_add_u32 s9, s74, 66048
    buffer_store_dwordx4 v[200:203], v6, s[60:63], s9 offen sc1
    v_mfma_f32_16x16x32_bf16 v[120:123], v[56:59], a[216:219], v[120:123]
    v_cvt_pk_bf16_f32 v204, v67, v71
    v_mfma_f32_16x16x32_bf16 v[124:127], v[56:59], a[220:223], v[124:127]
    v_cvt_pk_bf16_f32 v205, v75, v79
    v_mfma_f32_16x16x32_bf16 v[96:99], v[60:63], a[224:227], v[96:99]
    v_cvt_pk_bf16_f32 v206, v83, v87
    v_mfma_f32_16x16x32_bf16 v[100:103], v[60:63], a[228:231], v[100:103]
    v_cvt_pk_bf16_f32 v207, v91, v95
    v_mfma_f32_16x16x32_bf16 v[104:107], v[60:63], a[232:235], v[104:107]
    v_and_or_b32 v204, v204, -2, s13
    v_mfma_f32_16x16x32_bf16 v[108:111], v[60:63], a[236:239], v[108:111]
    s_add_u32 s9, s74, 99072
    buffer_store_dwordx4 v[204:207], v6, s[60:63], s9 offen sc1
    v_mfma_f32_16x16x32_bf16 v[112:115], v[60:63], a[240:243], v[112:115]
    v_mfma_f32_16x16x32_bf16 v[116:119], v[60:63], a[244:247], v[116:119]
    v_mfma_f32_16x16x32_bf16 v[120:123], v[60:63], a[248:251], v[120:123]
    v_mfma_f32_16x16x32_bf16 v[124:127], v[60:63], a[252:255], v[124:127]
    v_cvt_pk_bf16_f32 v192, v96, v100
    s_nop 0
    v_cvt_pk_bf16_f32 v193, v104, v108
    s_nop 2
    v_cvt_pk_bf16_f32 v194, v112, v116
    s_nop 0
    v_cvt_pk_bf16_f32 v195, v120, v124
    v_and_or_b32 v192, v192, -2, s13
    s_add_u32 s9, s74, 528384
    buffer_store_dwordx4 v[192:195], v6, s[60:63], s9 offen sc1
    v_cvt_pk_bf16_f32 v196, v97, v101
    v_cvt_pk_bf16_f32 v197, v105, v109
    v_cvt_pk_bf16_f32 v198, v113, v117
    v_cvt_pk_bf16_f32 v199, v121, v125
    v_and_or_b32 v196, v196, -2, s13
    s_add_u32 s9, s74, 561408
    buffer_store_dwordx4 v[196:199], v6, s[60:63], s9 offen sc1
    v_cvt_pk_bf16_f32 v200, v98, v102
    v_cvt_pk_bf16_f32 v201, v106, v110
    v_cvt_pk_bf16_f32 v202, v114, v118
    v_cvt_pk_bf16_f32 v203, v122, v126
    v_and_or_b32 v200, v200, -2, s13
    s_add_u32 s9, s74, 594432
    buffer_store_dwordx4 v[200:203], v6, s[60:63], s9 offen sc1
    v_cvt_pk_bf16_f32 v204, v99, v103
    v_cvt_pk_bf16_f32 v205, v107, v111
    v_cvt_pk_bf16_f32 v206, v115, v119
    v_cvt_pk_bf16_f32 v207, v123, v127
    v_and_or_b32 v204, v204, -2, s13
    s_add_u32 s9, s74, 627456
    buffer_store_dwordx4 v[204:207], v6, s[60:63], s9 offen sc1
    s_cmp_gt_u32 s69, 2
    s_cbranch_scc1 att_59
    s_waitcnt vmcnt(0)
    v_mov_b32 v28, s69
    s_mov_b64 exec, 1
    buffer_store_dword v28, off, s[60:63], s65 sc1
    s_mov_b64 exec, -1
wf_60:
    buffer_load_dwordx2 v[28:29], v16, s[60:63], 0 offen sc1
    s_waitcnt vmcnt(0)
    v_min_u32 v28, v28, v29
    v_cmp_gt_u32 vcc, s69, v28
    s_cbranch_vccz wfd_61
    s_sub_u32 s8, s8, 1
    s_cbranch_scc0 wf_60
    s_mov_b32 s8, 0
wfd_61:
att_59:
    s_waitcnt vmcnt(0)
rs_62:
    s_add_u32 s9, s74, 0
    buffer_load_dwordx4 v[32:35], v7, s[60:63], s9 offen sc1
    s_add_u32 s9, s74, 4096
    buffer_load_dwordx4 v[36:39], v7, s[60:63], s9 offen sc1
    s_add_u32 s9, s74, 8192
    buffer_load_dwordx4 v[40:43], v7, s[60:63], s9 offen sc1
    s_add_u32 s9, s74, 12288
    buffer_load_dwordx4 v[44:47], v7, s[60:63], s9 offen sc1
    s_add_u32 s9, s74, 16384
    buffer_load_dwordx4 v[48:51], v7, s[60:63], s9 offen sc1
    s_add_u32 s9, s74, 20480
    buffer_load_dwordx4 v[52:55], v7, s[60:63], s9 offen sc1
    s_add_u32 s9, s74, 24576
    buffer_load_dwordx4 v[56:59], v7, s[60:63], s9 offen sc1
    s_add_u32 s9, s74, 28672
    buffer_load_dwordx4 v[60:63], v7, s[60:63], s9 offen sc1
    s_mov_b64 exec, -1
    s_waitcnt vmcnt(7)
    v_mfma_f32_16x16x32_bf16 v[64:67], v[24:27], v[32:35], 0
    v_xor_b32 v28, s13, v32
    s_waitcnt vmcnt(6)
    v_mfma_f32_16x16x32_bf16 v[64:67], v[24:27], v[36:39], v[64:67]
    v_bitop3_b32 v28, v28, v36, s13 bitop3:0xf6
    s_waitcnt vmcnt(5)
    v_mfma_f32_16x16x32_bf16 v[64:67], v[24:27], v[40:43], v[64:67]
    v_bitop3_b32 v28, v28, v40, s13 bitop3:0xf6
    s_waitcnt vmcnt(4)
    v_mfma_f32_16x16x32_bf16 v[64:67], v[24:27], v[44:47], v[64:67]
    v_bitop3_b32 v28, v28, v44, s13 bitop3:0xf6
    s_waitcnt vmcnt(3)
    v_mfma_f32_16x16x32_bf16 v[64:67], v[24:27], v[48:51], v[64:67]
    v_bitop3_b32 v28, v28, v48, s13 bitop3:0xf6
    s_waitcnt vmcnt(2)
    v_mfma_f32_16x16x32_bf16 v[64:67], v[24:27], v[52:55], v[64:67]
    v_bitop3_b32 v28, v28, v52, s13 bitop3:0xf6
    s_waitcnt vmcnt(1)
    v_mfma_f32_16x16x32_bf16 v[64:67], v[24:27], v[56:59], v[64:67]
    v_bitop3_b32 v28, v28, v56, s13 bitop3:0xf6
    s_waitcnt vmcnt(0)
    v_mfma_f32_16x16x32_bf16 v[64:67], v[24:27], v[60:63], v[64:67]
    v_bitop3_b32 v28, v28, v60, s13 bitop3:0xf6
    v_and_b32 v28, 1, v28
    v_cmp_ne_u32 vcc, 0, v28
    s_cbranch_vccz rsd_63
    s_mov_b64 exec, vcc
    s_sub_u32 s8, s8, 1
    s_cbranch_scc0 rs_62
    s_mov_b32 s8, 0
    s_mov_b64 exec, -1
rsd_63:
    s_nop 3
    v_cvt_pk_bf16_f32 v68, v64, v65
    v_cvt_pk_bf16_f32 v69, v66, v67
    v_lshlrev_b32 v64, 16, v68
    v_and_b32 v65, 0xffff0000, v68
    v_lshlrev_b32 v66, 16, v69
    v_and_b32 v67, 0xffff0000, v69
    v_pk_add_f32 v[64:65], v[64:65], v[180:181]
    v_pk_add_f32 v[66:67], v[66:67], v[182:183]
    v_cvt_pk_bf16_f32 v68, v64, v65
    v_cvt_pk_bf16_f32 v69, v66, v67
    v_lshlrev_b32 v64, 16, v68
    v_and_b32 v65, 0xffff0000, v68
    v_lshlrev_b32 v66, 16, v69
    v_and_b32 v67, 0xffff0000, v69
    v_mov_b64 v[44:45], v[68:69]
    v_pk_add_f32 v[70:71], v[64:65], v[66:67]
    v_pk_mul_f32 v[72:73], v[64:65], v[64:65]
    v_pk_fma_f32 v[72:73], v[66:67], v[66:67], v[72:73]
    v_add_f32 v70, v70, v71
    v_add_f32 v72, v72, v73
    s_nop 0
    v_add_f32_dpp v70, v70, v70 row_ror:8 row_mask:0xf bank_mask:0xf
    v_add_f32_dpp v72, v72, v72 row_ror:8 row_mask:0xf bank_mask:0xf
    s_nop 0
    v_add_f32_dpp v70, v70, v70 row_ror:4 row_mask:0xf bank_mask:0xf
    v_add_f32_dpp v72, v72, v72 row_ror:4 row_mask:0xf bank_mask:0xf
    s_nop 0
    v_add_f32_dpp v70, v70, v70 row_ror:2 row_mask:0xf bank_mask:0xf
    v_add_f32_dpp v72, v72, v72 row_ror:2 row_mask:0xf bank_mask:0xf
    s_nop 0
    v_add_f32_dpp v70, v70, v70 row_ror:1 row_mask:0xf bank_mask:0xf
    v_add_f32_dpp v72, v72, v72 row_ror:1 row_mask:0xf bank_mask:0xf
    v_mov_b32 v71, v72
    s_mov_b64 exec, 0x10001
    ds_write_b64 v20, v[70:71]
    s_mov_b64 exec, -1
    v_mov_b32 v28, 0
    s_add_u32 s9, s75, 4194304
    v_mov_b32 v46, v44
    v_mov_b32 v47, v45
    s_nop 0
    v_permlane16_swap_b32 v44, v46
    v_permlane16_swap_b32 v45, v47
    s_mov_b64 exec, 0xffff
    buffer_store_dwordx4 v[44:47], v8, s[60:63], s9 offen sc1
    s_mov_b64 exec, -1
    s_waitcnt lgkmcnt(0)
    s_barrier
    ds_read_b128 v[32:35], v28 offset:49152
    ds_read_b128 v[36:39], v28 offset:49168
    ds_read_b128 v[40:43], v28 offset:49184
    ds_read_b128 v[44:47], v28 offset:49200
    s_waitcnt lgkmcnt(2)
    v_pk_add_f32 v[32:33], v[32:33], v[34:35]
    v_pk_add_f32 v[36:37], v[36:37], v[38:39]
    s_waitcnt lgkmcnt(0)
    v_pk_add_f32 v[40:41], v[40:41], v[42:43]
    v_pk_add_f32 v[44:45], v[44:45], v[46:47]
    v_pk_add_f32 v[32:33], v[32:33], v[36:37]
    v_pk_add_f32 v[40:41], v[40:41], v[44:45]
    v_pk_add_f32 v[32:33], v[32:33], v[40:41]
    v_mul_f32 v72, 0x3b000000, v32
    v_mul_f32 v74, 0x3b000000, v33
    v_fma_f32 v74, -v72, v72, v74
    v_max_f32 v74, 0, v74
    v_cvt_pk_bf16_f32 v74, v74, v74
    v_lshlrev_b32 v74, 16, v74
    v_add_f32 v74, 0x3727c5ac, v74
    v_cvt_pk_bf16_f32 v72, v72, v72
    v_lshlrev_b32 v72, 16, v72
    v_cvt_pk_bf16_f32 v74, v74, v74
    v_lshlrev_b32 v74, 16, v74
    v_sqrt_f32 v74, v74
    v_pk_add_f32 v[64:65], v[64:65], v[72:73] op_sel_hi:[1,0] neg_lo:[0,1] neg_hi:[0,1]
    v_pk_add_f32 v[66:67], v[66:67], v[72:73] op_sel_hi:[1,0] neg_lo:[0,1] neg_hi:[0,1]
    v_cvt_pk_bf16_f32 v74, v74, v74
    v_lshlrev_b32 v74, 16, v74
    v_rcp_f32 v74, v74
    v_cvt_pk_bf16_f32 v70, v64, v65
    v_cvt_pk_bf16_f32 v71, v66, v67
    v_lshlrev_b32 v64, 16, v70
    v_and_b32 v65, 0xffff0000, v70
    v_lshlrev_b32 v66, 16, v71
    v_and_b32 v67, 0xffff0000, v71
    v_pk_mul_f32 v[64:65], v[64:65], v[74:75] op_sel_hi:[1,0]
    v_pk_mul_f32 v[66:67], v[66:67], v[74:75] op_sel_hi:[1,0]
    v_cvt_pk_bf16_f32 v68, v64, v65
    v_cvt_pk_bf16_f32 v69, v66, v67
    s_lshr_b32 s9, s75, 10
    s_mul_i32 s9, s9, 1024
    s_add_u32 s9, s9, 54525952
    v_mov_b32 v70, v68
    v_mov_b32 v71, v69
    s_nop 0
    v_permlane16_swap_b32 v68, v70
    v_permlane16_swap_b32 v69, v71
    s_mov_b64 exec, 0xffff
    buffer_store_dwordx4 v[68:71], v8, s[60:63], s9 offen sc1
    s_mov_b64 exec, -1
    s_add_u32 s9, s68, 66
    s_cmp_lg_u32 s69, 1
    s_cbranch_scc1 atl_64
    s_add_u32 s10, s70, 3145728
    buffer_store_dwordx4 v[188:191], v4, s[60:63], s10 offen sc1
    s_add_u32 s10, s10, 0x60000
    buffer_store_dwordx4 v[188:191], v4, s[60:63], s10 offen sc1
    s_add_u32 s10, s10, 0x60000
    buffer_store_dwordx4 v[188:191], v4, s[60:63], s10 offen sc1
    s_add_u32 s10, s10, 0x60000
    buffer_store_dwordx4 v[188:191], v4, s[60:63], s10 offen sc1
    s_add_u32 s10, s10, 0x60000
    s_mul_i32 s10, s3, 96
    s_add_u32 s10, s10, s15
    s_add_u32 s10, s10, 768
    s_cmp_ge_u32 s10, 2048
    s_cbranch_scc1 atc_65
    s_lshl_b32 s11, s10, 10
    s_add_u32 s9, s11, 54525952
    buffer_store_dwordx4 v[188:191], v4, s[60:63], s9 offen sc1
    s_add_u32 s9, s11, 4194304
    buffer_store_dwordx4 v[188:191], v4, s[60:63], s9 offen sc1
atc_65:
    s_add_u32 s10, s10, 384
atl_64:
    s_cmp_lg_u32 s69, 2
    s_cbranch_scc1 atl_66
    s_add_u32 s10, s70, 4718592
    buffer_store_dwordx4 v[188:191], v4, s[60:63], s10 offen sc1
    s_add_u32 s10, s10, 0x60000
    buffer_store_dwordx4 v[188:191], v4, s[60:63], s10 offen sc1
    s_add_u32 s10, s10, 0x60000
    buffer_store_dwordx4 v[188:191], v4, s[60:63], s10 offen sc1
    s_add_u32 s10, s10, 0x60000
    buffer_store_dwordx4 v[188:191], v4, s[60:63], s10 offen sc1
    s_add_u32 s10, s10, 0x60000
    s_mul_i32 s10, s3, 96
    s_add_u32 s10, s10, s15
    s_add_u32 s10, s10, 1152
    s_cmp_ge_u32 s10, 2048
    s_cbranch_scc1 atc_67
    s_lshl_b32 s11, s10, 10
    s_add_u32 s9, s11, 54525952
    buffer_store_dwordx4 v[188:191], v4, s[60:63], s9 offen sc1
    s_add_u32 s9, s11, 4194304
    buffer_store_dwordx4 v[188:191], v4, s[60:63], s9 offen sc1
atc_67:
    s_add_u32 s10, s10, 384
atl_66:
    s_cmp_lg_u32 s69, 3
    s_cbranch_scc1 atl_68
    s_add_u32 s10, s70, 6291456
    buffer_store_dwordx4 v[188:191], v4, s[60:63], s10 offen sc1
    s_add_u32 s10, s10, 0x60000
    buffer_store_dwordx4 v[188:191], v4, s[60:63], s10 offen sc1
    s_add_u32 s10, s10, 0x60000
    buffer_store_dwordx4 v[188:191], v4, s[60:63], s10 offen sc1
    s_add_u32 s10, s10, 0x60000
    buffer_store_dwordx4 v[188:191], v4, s[60:63], s10 offen sc1
    s_add_u32 s10, s10, 0x60000
    s_mul_i32 s10, s3, 96
    s_add_u32 s10, s10, s15
    s_add_u32 s10, s10, 1536
    s_cmp_ge_u32 s10, 2048
    s_cbranch_scc1 atc_69
    s_lshl_b32 s11, s10, 10
    s_add_u32 s9, s11, 54525952
    buffer_store_dwordx4 v[188:191], v4, s[60:63], s9 offen sc1
    s_add_u32 s9, s11, 4194304
    buffer_store_dwordx4 v[188:191], v4, s[60:63], s9 offen sc1
atc_69:
    s_add_u32 s10, s10, 384
atl_68:
    s_cmp_lg_u32 s69, 4
    s_cbranch_scc1 atl_70
    s_add_u32 s10, s70, 7864320
    buffer_store_dwordx4 v[188:191], v4, s[60:63], s10 offen sc1
    s_add_u32 s10, s10, 0x60000
    buffer_store_dwordx4 v[188:191], v4, s[60:63], s10 offen sc1
    s_add_u32 s10, s10, 0x60000
    s_mul_i32 s10, s3, 96
    s_add_u32 s10, s10, s15
    s_add_u32 s10, s10, 1920
    s_cmp_ge_u32 s10, 2048
    s_cbranch_scc1 atc_71
    s_lshl_b32 s11, s10, 10
    s_add_u32 s9, s11, 54525952
    buffer_store_dwordx4 v[188:191], v4, s[60:63], s9 offen sc1
    s_add_u32 s9, s11, 4194304
    buffer_store_dwordx4 v[188:191], v4, s[60:63], s9 offen sc1
atc_71:
    s_add_u32 s10, s10, 384
atl_70:
    s_cmp_lg_u32 s69, 5
    s_cbranch_scc1 atl_72
    v_mov_b32 v28, 100
    s_mov_b64 exec, 1
    buffer_store_dword v28, off, s[60:63], s66 sc1
    s_mov_b64 exec, -1
atl_72:
    s_add_u32 s73, s73, 0x60000
    s_add_u32 s9, s70, 8650752
    s_cmp_ge_u32 s73, s9
    s_cselect_b32 s73, s70, s73
    s_add_u32 s68, s68, 3
    s_cmp_lt_u32 s68, 64
    s_cbranch_scc1 L_AT_far
    s_endpgm
L_AT_resc_far:
    v_mov_b32 v29, v28
    s_nop 1
    v_permlane16_swap_b32 v28, v29
    v_max_f32 v28, v28, v29
    v_mov_b32 v29, v28
    s_nop 1
    v_permlane32_swap_b32 v28, v29
    v_max_f32 v28, v28, v29
    v_max_f32 v28, 0, v28
    v_sub_f32 v124, v124, v28
    v_sub_f32 v125, v125, v28
    v_sub_f32 v29, 0, v28
    v_exp_f32 v29, v29
    s_nop 0
    v_mul_f32 v48, v48, v29
    v_mul_f32 v49, v49, v29
    v_mul_f32 v50, v50, v29
    v_mul_f32 v51, v51, v29
    v_mul_f32 v52, v52, v29
    v_mul_f32 v53, v53, v29
    v_mul_f32 v54, v54, v29
    v_mul_f32 v55, v55, v29
    v_mul_f32 v56, v56, v29
    v_mul_f32 v57, v57, v29
    v_mul_f32 v58, v58, v29
    v_mul_f32 v59, v59, v29
    v_mul_f32 v60, v60, v29
    v_mul_f32 v61, v61, v29
    v_mul_f32 v62, v62, v29
    v_mul_f32 v63, v63, v29
    v_mul_f32 v76, v76, v29
    v_mul_f32 v77, v77, v29
    v_mul_f32 v78, v78, v29
    v_mul_f32 v79, v79, v29
    s_branch L_AT_rescd_far
L_role_FF:
    s_sub_u32 s64, s4, 6
    s_lshl_b32 s65, s64, 9
    s_lshl_b32 s9, s5, 4
    s_add_u32 s65, s65, s9
    s_lshl_b32 s9, s3, 2
    s_add_u32 s65, s65, s9
    s_add_u32 s65, s65, 6897664
    v_mov_b32 v6, 0
    s_mov_b64 exec, 1
    buffer_store_dword v6, off, s[60:63], s65 sc1
    s_mov_b64 exec, -1
    s_waitcnt vmcnt(0)
    s_barrier
    s_cmp_lg_u32 s3, 0
    s_cbranch_scc1 pt_73
    s_or_b32 s9, s6, 192
    s_and_b32 s10, s5, 3
    s_lshl_b32 s10, s10, 3
    s_lshl_b32 s9, s9, s10
    v_mov_b32 v6, s9
    s_lshl_b32 s10, s4, 5
    s_and_b32 s11, s5, 0x1c
    s_add_u32 s10, s10, s11
    s_mov_b64 exec, 1
    buffer_atomic_or v6, off, s[56:59], s10 sc1
    s_mov_b64 exec, -1
pt_73:
L_FF_join:
    s_cmp_ge_u32 s5, 22
    s_cbranch_scc1 L_FF_noweights
    s_mov_b32 s9, 22016
    v_mul_lo_u32 v6, s9, v2
    v_lshl_add_u32 v6, v3, 2, v6
    s_lshl_b32 s9, s5, 7
    s_lshr_b32 s10, s3, 1
    s_lshl_b32 s10, s10, 6
    s_add_u32 s9, s9, s10
    v_add_u32 v6, s9, v6
    v_lshlrev_b32 v7, 13, v2
    v_lshl_add_u32 v7, v3, 4, v7
    s_lshl_b32 s9, s5, 16
    s_lshl_b32 s10, s3, 8
    s_add_u32 s9, s9, s10
    v_add_u32 v7, s9, v7
    s_mov_b32 s12, 84148480
    s_mov_b32 s13, 117834498
    s_mov_b32 s14, 0
    buffer_load_dword v16, v6, s[40:43], s14 offen
    s_mov_b32 s14, 2752
    buffer_load_dword v17, v6, s[40:43], s14 offen
    s_mov_b32 s14, 5504
    buffer_load_dword v18, v6, s[40:43], s14 offen
    s_mov_b32 s14, 8256
    buffer_load_dword v19, v6, s[40:43], s14 offen
    s_mov_b32 s14, 11008
    buffer_load_dword v20, v6, s[40:43], s14 offen
    s_mov_b32 s14, 13760
    buffer_load_dword v21, v6, s[40:43], s14 offen
    s_mov_b32 s14, 16512
    buffer_load_dword v22, v6, s[40:43], s14 offen
    s_mov_b32 s14, 19264
    buffer_load_dword v23, v6, s[40:43], s14 offen
    s_mov_b32 s14, 0
    buffer_load_dword v24, v6, s[44:47], s14 offen
    s_mov_b32 s14, 2752
    buffer_load_dword v25, v6, s[44:47], s14 offen
    s_mov_b32 s14, 5504
    buffer_load_dword v26, v6, s[44:47], s14 offen
    s_mov_b32 s14, 8256
    buffer_load_dword v27, v6, s[44:47], s14 offen
    s_mov_b32 s14, 11008
    buffer_load_dword v28, v6, s[44:47], s14 offen
    s_mov_b32 s14, 13760
    buffer_load_dword v29, v6, s[44:47], s14 offen
    s_mov_b32 s14, 16512
    buffer_load_dword v30, v6, s[44:47], s14 offen
    s_mov_b32 s14, 19264
    buffer_load_dword v31, v6, s[44:47], s14 offen
    s_mov_b32 s14, 88064
    buffer_load_dword v32, v6, s[40:43], s14 offen
    s_mov_b32 s14, 90816
    buffer_load_dword v33, v6, s[40:43], s14 offen
    s_mov_b32 s14, 93568
    buffer_load_dword v34, v6, s[40:43], s14 offen
    s_mov_b32 s14, 96320
    buffer_load_dword v35, v6, s[40:43], s14 offen
    s_mov_b32 s14, 99072
    buffer_load_dword v36, v6, s[40:43], s14 offen
    s_mov_b32 s14, 101824
    buffer_load_dword v37, v6, s[40:43], s14 offen
    s_mov_b32 s14, 104576
    buffer_load_dword v38, v6, s[40:43], s14 offen
    s_mov_b32 s14, 107328
    buffer_load_dword v39, v6, s[40:43], s14 offen
    s_mov_b32 s14, 88064
    buffer_load_dword v40, v6, s[44:47], s14 offen
    s_mov_b32 s14, 90816
    buffer_load_dword v41, v6, s[44:47], s14 offen
    s_mov_b32 s14, 93568
    buffer_load_dword v42, v6, s[44:47], s14 offen
    s_mov_b32 s14, 96320
    buffer_load_dword v43, v6, s[44:47], s14 offen
    s_mov_b32 s14, 99072
    buffer_load_dword v44, v6, s[44:47], s14 offen
    s_mov_b32 s14, 101824
    buffer_load_dword v45, v6, s[44:47], s14 offen
    s_mov_b32 s14, 104576
    buffer_load_dword v46, v6, s[44:47], s14 offen
    s_mov_b32 s14, 107328
    buffer_load_dword v47, v6, s[44:47], s14 offen
    s_mov_b32 s14, 176128
    buffer_load_dword v48, v6, s[40:43], s14 offen
    s_mov_b32 s14, 178880
    buffer_load_dword v49, v6, s[40:43], s14 offen
    s_mov_b32 s14, 181632
    buffer_load_dword v50, v6, s[40:43], s14 offen
    s_mov_b32 s14, 184384
    buffer_load_dword v51, v6, s[40:43], s14 offen
    s_mov_b32 s14, 187136
    buffer_load_dword v52, v6, s[40:43], s14 offen
    s_mov_b32 s14, 189888
    buffer_load_dword v53, v6, s[40:43], s14 offen
    s_mov_b32 s14, 192640
    buffer_load_dword v54, v6, s[40:43], s14 offen
    s_mov_b32 s14, 195392
    buffer_load_dword v55, v6, s[40:43], s14 offen
    s_mov_b32 s14, 176128
    buffer_load_dword v56, v6, s[44:47], s14 offen
    s_mov_b32 s14, 178880
    buffer_load_dword v57, v6, s[44:47], s14 offen
    s_mov_b32 s14, 181632
    buffer_load_dword v58, v6, s[44:47], s14 offen
    s_mov_b32 s14, 184384
    buffer_load_dword v59, v6, s[44:47], s14 offen
    s_mov_b32 s14, 187136
    buffer_load_dword v60, v6, s[44:47], s14 offen
    s_mov_b32 s14, 189888
    buffer_load_dword v61, v6, s[44:47], s14 offen
    s_mov_b32 s14, 192640
    buffer_load_dword v62, v6, s[44:47], s14 offen
    s_mov_b32 s14, 195392
    buffer_load_dword v63, v6, s[44:47], s14 offen
    s_mov_b32 s14, 264192
    buffer_load_dword v64, v6, s[40:43], s14 offen
    s_mov_b32 s14, 266944
    buffer_load_dword v65, v6, s[40:43], s14 offen
    s_mov_b32 s14, 269696
    buffer_load_dword v66, v6, s[40:43], s14 offen
    s_mov_b32 s14, 272448
    buffer_load_dword v67, v6, s[40:43], s14 offen
    s_mov_b32 s14, 275200
    buffer_load_dword v68, v6, s[40:43], s14 offen
    s_mov_b32 s14, 277952
    buffer_load_dword v69, v6, s[40:43], s14 offen
    s_mov_b32 s14, 280704
    buffer_load_dword v70, v6, s[40:43], s14 offen
    s_mov_b32 s14, 283456
    buffer_load_dword v71, v6, s[40:43], s14 offen
    s_mov_b32 s14, 264192
    buffer_load_dword v72, v6, s[44:47], s14 offen
    s_mov_b32 s14, 266944
    buffer_load_dword v73, v6, s[44:47], s14 offen
    s_mov_b32 s14, 269696
    buffer_load_dword v74, v6, s[44:47], s14 offen
    s_mov_b32 s14, 272448
    buffer_load_dword v75, v6, s[44:47], s14 offen
    s_mov_b32 s14, 275200
    buffer_load_dword v76, v6, s[44:47], s14 offen
    s_mov_b32 s14, 277952
    buffer_load_dword v77, v6, s[44:47], s14 offen
    s_mov_b32 s14, 280704
    buffer_load_dword v78, v6, s[44:47], s14 offen
    s_mov_b32 s14, 283456
    buffer_load_dword v79, v6, s[44:47], s14 offen
    s_waitcnt vmcnt(48)
    v_perm_b32 v80, v17, v16, s12
    v_accvgpr_write_b32 a0, v80
    v_perm_b32 v81, v19, v18, s12
    v_accvgpr_write_b32 a1, v81
    v_perm_b32 v80, v21, v20, s12
    v_accvgpr_write_b32 a2, v80
    v_perm_b32 v81, v23, v22, s12
    v_accvgpr_write_b32 a3, v81
    v_perm_b32 v80, v17, v16, s13
    v_accvgpr_write_b32 a4, v80
    v_perm_b32 v81, v19, v18, s13
    v_accvgpr_write_b32 a5, v81
    v_perm_b32 v80, v21, v20, s13
    v_accvgpr_write_b32 a6, v80
    v_perm_b32 v81, v23, v22, s13
    v_accvgpr_write_b32 a7, v81
    v_perm_b32 v80, v25, v24, s12
    v_accvgpr_write_b32 a8, v80
    v_perm_b32 v81, v27, v26, s12
    v_accvgpr_write_b32 a9, v81
    v_perm_b32 v80, v29, v28, s12
    v_accvgpr_write_b32 a10, v80
    v_perm_b32 v81, v31, v30, s12
    v_accvgpr_write_b32 a11, v81
    v_perm_b32 v80, v25, v24, s13
    v_accvgpr_write_b32 a12, v80
    v_perm_b32 v81, v27, v26, s13
    v_accvgpr_write_b32 a13, v81
    v_perm_b32 v80, v29, v28, s13
    v_accvgpr_write_b32 a14, v80
    v_perm_b32 v81, v31, v30, s13
    v_accvgpr_write_b32 a15, v81
    s_mov_b32 s14, 352256
    buffer_load_dword v16, v6, s[40:43], s14 offen
    s_mov_b32 s14, 355008
    buffer_load_dword v17, v6, s[40:43], s14 offen
    s_mov_b32 s14, 357760
    buffer_load_dword v18, v6, s[40:43], s14 offen
    s_mov_b32 s14, 360512
    buffer_load_dword v19, v6, s[40:43], s14 offen
    s_mov_b32 s14, 363264
    buffer_load_dword v20, v6, s[40:43], s14 offen
    s_mov_b32 s14, 366016
    buffer_load_dword v21, v6, s[40:43], s14 offen
    s_mov_b32 s14, 368768
    buffer_load_dword v22, v6, s[40:43], s14 offen
    s_mov_b32 s14, 371520
    buffer_load_dword v23, v6, s[40:43], s14 offen
    s_mov_b32 s14, 352256
    buffer_load_dword v24, v6, s[44:47], s14 offen
    s_mov_b32 s14, 355008
    buffer_load_dword v25, v6, s[44:47], s14 offen
    s_mov_b32 s14, 357760
    buffer_load_dword v26, v6, s[44:47], s14 offen
    s_mov_b32 s14, 360512
    buffer_load_dword v27, v6, s[44:47], s14 offen
    s_mov_b32 s14, 363264
    buffer_load_dword v28, v6, s[44:47], s14 offen
    s_mov_b32 s14, 366016
    buffer_load_dword v29, v6, s[44:47], s14 offen
    s_mov_b32 s14, 368768
    buffer_load_dword v30, v6, s[44:47], s14 offen
    s_mov_b32 s14, 371520
    buffer_load_dword v31, v6, s[44:47], s14 offen
    s_waitcnt vmcnt(48)
    v_perm_b32 v80, v33, v32, s12
    v_accvgpr_write_b32 a16, v80
    v_perm_b32 v81, v35, v34, s12
    v_accvgpr_write_b32 a17, v81
    v_perm_b32 v80, v37, v36, s12
    v_accvgpr_write_b32 a18, v80
    v_perm_b32 v81, v39, v38, s12
    v_accvgpr_write_b32 a19, v81
    v_perm_b32 v80, v33, v32, s13
    v_accvgpr_write_b32 a20, v80
    v_perm_b32 v81, v35, v34, s13
    v_accvgpr_write_b32 a21, v81
    v_perm_b32 v80, v37, v36, s13
    v_accvgpr_write_b32 a22, v80
    v_perm_b32 v81, v39, v38, s13
    v_accvgpr_write_b32 a23, v81
    v_perm_b32 v80, v41, v40, s12
    v_accvgpr_write_b32 a24, v80
    v_perm_b32 v81, v43, v42, s12
    v_accvgpr_write_b32 a25, v81
    v_perm_b32 v80, v45, v44, s12
    v_accvgpr_write_b32 a26, v80
    v_perm_b32 v81, v47, v46, s12
    v_accvgpr_write_b32 a27, v81
    v_perm_b32 v80, v41, v40, s13
    v_accvgpr_write_b32 a28, v80
    v_perm_b32 v81, v43, v42, s13
    v_accvgpr_write_b32 a29, v81
    v_perm_b32 v80, v45, v44, s13
    v_accvgpr_write_b32 a30, v80
    v_perm_b32 v81, v47, v46, s13
    v_accvgpr_write_b32 a31, v81
    s_mov_b32 s14, 440320
    buffer_load_dword v32, v6, s[40:43], s14 offen
    s_mov_b32 s14, 443072
    buffer_load_dword v33, v6, s[40:43], s14 offen
    s_mov_b32 s14, 445824
    buffer_load_dword v34, v6, s[40:43], s14 offen
    s_mov_b32 s14, 448576
    buffer_load_dword v35, v6, s[40:43], s14 offen
    s_mov_b32 s14, 451328
    buffer_load_dword v36, v6, s[40:43], s14 offen
    s_mov_b32 s14, 454080
    buffer_load_dword v37, v6, s[40:43], s14 offen
    s_mov_b32 s14, 456832
    buffer_load_dword v38, v6, s[40:43], s14 offen
    s_mov_b32 s14, 459584
    buffer_load_dword v39, v6, s[40:43], s14 offen
    s_mov_b32 s14, 440320
    buffer_load_dword v40, v6, s[44:47], s14 offen
    s_mov_b32 s14, 443072
    buffer_load_dword v41, v6, s[44:47], s14 offen
    s_mov_b32 s14, 445824
    buffer_load_dword v42, v6, s[44:47], s14 offen
    s_mov_b32 s14, 448576
    buffer_load_dword v43, v6, s[44:47], s14 offen
    s_mov_b32 s14, 451328
    buffer_load_dword v44, v6, s[44:47], s14 offen
    s_mov_b32 s14, 454080
    buffer_load_dword v45, v6, s[44:47], s14 offen
    s_mov_b32 s14, 456832
    buffer_load_dword v46, v6, s[44:47], s14 offen
    s_mov_b32 s14, 459584
    buffer_load_dword v47, v6, s[44:47], s14 offen
    s_waitcnt vmcnt(48)
    v_perm_b32 v80, v49, v48, s12
    v_accvgpr_write_b32 a32, v80
    v_perm_b32 v81, v51, v50, s12
    v_accvgpr_write_b32 a33, v81
    v_perm_b32 v80, v53, v52, s12
    v_accvgpr_write_b32 a34, v80
    v_perm_b32 v81, v55, v54, s12
    v_accvgpr_write_b32 a35, v81
    v_perm_b32 v80, v49, v48, s13
    v_accvgpr_write_b32 a36, v80
    v_perm_b32 v81, v51, v50, s13
    v_accvgpr_write_b32 a37, v81
    v_perm_b32 v80, v53, v52, s13
    v_accvgpr_write_b32 a38, v80
    v_perm_b32 v81, v55, v54, s13
    v_accvgpr_write_b32 a39, v81
    v_perm_b32 v80, v57, v56, s12
    v_accvgpr_write_b32 a40, v80
    v_perm_b32 v81, v59, v58, s12
    v_accvgpr_write_b32 a41, v81
    v_perm_b32 v80, v61, v60, s12
    v_accvgpr_write_b32 a42, v80
    v_perm_b32 v81, v63, v62, s12
    v_accvgpr_write_b32 a43, v81
    v_perm_b32 v80, v57, v56, s13
    v_accvgpr_write_b32 a44, v80
    v_perm_b32 v81, v59, v58, s13
    v_accvgpr_write_b32 a45, v81
    v_perm_b32 v80, v61, v60, s13
    v_accvgpr_write_b32 a46, v80
    v_perm_b32 v81, v63, v62, s13
    v_accvgpr_write_b32 a47, v81
    s_mov_b32 s14, 528384
    buffer_load_dword v48, v6, s[40:43], s14 offen
    s_mov_b32 s14, 531136
    buffer_load_dword v49, v6, s[40:43], s14 offen
    s_mov_b32 s14, 533888
    buffer_load_dword v50, v6, s[40:43], s14 offen
    s_mov_b32 s14, 536640
    buffer_load_dword v51, v6, s[40:43], s14 offen
    s_mov_b32 s14, 539392
    buffer_load_dword v52, v6, s[40:43], s14 offen
    s_mov_b32 s14, 542144
    buffer_load_dword v53, v6, s[40:43], s14 offen
    s_mov_b32 s14, 544896
    buffer_load_dword v54, v6, s[40:43], s14 offen
    s_mov_b32 s14, 547648
    buffer_load_dword v55, v6, s[40:43], s14 offen
    s_mov_b32 s14, 528384
    buffer_load_dword v56, v6, s[44:47], s14 offen
    s_mov_b32 s14, 531136
    buffer_load_dword v57, v6, s[44:47], s14 offen
    s_mov_b32 s14, 533888
    buffer_load_dword v58, v6, s[44:47], s14 offen
    s_mov_b32 s14, 536640
    buffer_load_dword v59, v6, s[44:47], s14 offen
    s_mov_b32 s14, 539392
    buffer_load_dword v60, v6, s[44:47], s14 offen
    s_mov_b32 s14, 542144
    buffer_load_dword v61, v6, s[44:47], s14 offen
    s_mov_b32 s14, 544896
    buffer_load_dword v62, v6, s[44:47], s14 offen
    s_mov_b32 s14, 547648
    buffer_load_dword v63, v6, s[44:47], s14 offen
    s_waitcnt vmcnt(48)
    v_perm_b32 v80, v65, v64, s12
    v_accvgpr_write_b32 a48, v80
    v_perm_b32 v81, v67, v66, s12
    v_accvgpr_write_b32 a49, v81
    v_perm_b32 v80, v69, v68, s12
    v_accvgpr_write_b32 a50, v80
    v_perm_b32 v81, v71, v70, s12
    v_accvgpr_write_b32 a51, v81
    v_perm_b32 v80, v65, v64, s13
    v_accvgpr_write_b32 a52, v80
    v_perm_b32 v81, v67, v66, s13
    v_accvgpr_write_b32 a53, v81
    v_perm_b32 v80, v69, v68, s13
    v_accvgpr_write_b32 a54, v80
    v_perm_b32 v81, v71, v70, s13
    v_accvgpr_write_b32 a55, v81
    v_perm_b32 v80, v73, v72, s12
    v_accvgpr_write_b32 a56, v80
    v_perm_b32 v81, v75, v74, s12
    v_accvgpr_write_b32 a57, v81
    v_perm_b32 v80, v77, v76, s12
    v_accvgpr_write_b32 a58, v80
    v_perm_b32 v81, v79, v78, s12
    v_accvgpr_write_b32 a59, v81
    v_perm_b32 v80, v73, v72, s13
    v_accvgpr_write_b32 a60, v80
    v_perm_b32 v81, v75, v74, s13
    v_accvgpr_write_b32 a61, v81
    v_perm_b32 v80, v77, v76, s13
    v_accvgpr_write_b32 a62, v80
    v_perm_b32 v81, v79, v78, s13
    v_accvgpr_write_b32 a63, v81
    s_mov_b32 s14, 616448
    buffer_load_dword v64, v6, s[40:43], s14 offen
    s_mov_b32 s14, 619200
    buffer_load_dword v65, v6, s[40:43], s14 offen
    s_mov_b32 s14, 621952
    buffer_load_dword v66, v6, s[40:43], s14 offen
    s_mov_b32 s14, 624704
    buffer_load_dword v67, v6, s[40:43], s14 offen
    s_mov_b32 s14, 627456
    buffer_load_dword v68, v6, s[40:43], s14 offen
    s_mov_b32 s14, 630208
    buffer_load_dword v69, v6, s[40:43], s14 offen
    s_mov_b32 s14, 632960
    buffer_load_dword v70, v6, s[40:43], s14 offen
    s_mov_b32 s14, 635712
    buffer_load_dword v71, v6, s[40:43], s14 offen
    s_mov_b32 s14, 616448
    buffer_load_dword v72, v6, s[44:47], s14 offen
    s_mov_b32 s14, 619200
    buffer_load_dword v73, v6, s[44:47], s14 offen
    s_mov_b32 s14, 621952
    buffer_load_dword v74, v6, s[44:47], s14 offen
    s_mov_b32 s14, 624704
    buffer_load_dword v75, v6, s[44:47], s14 offen
    s_mov_b32 s14, 627456
    buffer_load_dword v76, v6, s[44:47], s14 offen
    s_mov_b32 s14, 630208
    buffer_load_dword v77, v6, s[44:47], s14 offen
    s_mov_b32 s14, 632960
    buffer_load_dword v78, v6, s[44:47], s14 offen
    s_mov_b32 s14, 635712
    buffer_load_dword v79, v6, s[44:47], s14 offen
    s_waitcnt vmcnt(48)
    v_perm_b32 v80, v17, v16, s12
    v_accvgpr_write_b32 a64, v80
    v_perm_b32 v81, v19, v18, s12
    v_accvgpr_write_b32 a65, v81
    v_perm_b32 v80, v21, v20, s12
    v_accvgpr_write_b32 a66, v80
    v_perm_b32 v81, v23, v22, s12
    v_accvgpr_write_b32 a67, v81
    v_perm_b32 v80, v17, v16, s13
    v_accvgpr_write_b32 a68, v80
    v_perm_b32 v81, v19, v18, s13
    v_accvgpr_write_b32 a69, v81
    v_perm_b32 v80, v21, v20, s13
    v_accvgpr_write_b32 a70, v80
    v_perm_b32 v81, v23, v22, s13
    v_accvgpr_write_b32 a71, v81
    v_perm_b32 v80, v25, v24, s12
    v_accvgpr_write_b32 a72, v80
    v_perm_b32 v81, v27, v26, s12
    v_accvgpr_write_b32 a73, v81
    v_perm_b32 v80, v29, v28, s12
    v_accvgpr_write_b32 a74, v80
    v_perm_b32 v81, v31, v30, s12
    v_accvgpr_write_b32 a75, v81
    v_perm_b32 v80, v25, v24, s13
    v_accvgpr_write_b32 a76, v80
    v_perm_b32 v81, v27, v26, s13
    v_accvgpr_write_b32 a77, v81
    v_perm_b32 v80, v29, v28, s13
    v_accvgpr_write_b32 a78, v80
    v_perm_b32 v81, v31, v30, s13
    v_accvgpr_write_b32 a79, v81
    s_mov_b32 s14, 704512
    buffer_load_dword v16, v6, s[40:43], s14 offen
    s_mov_b32 s14, 707264
    buffer_load_dword v17, v6, s[40:43], s14 offen
    s_mov_b32 s14, 710016
    buffer_load_dword v18, v6, s[40:43], s14 offen
    s_mov_b32 s14, 712768
    buffer_load_dword v19, v6, s[40:43], s14 offen
    s_mov_b32 s14, 715520
    buffer_load_dword v20, v6, s[40:43], s14 offen
    s_mov_b32 s14, 718272
    buffer_load_dword v21, v6, s[40:43], s14 offen
    s_mov_b32 s14, 721024
    buffer_load_dword v22, v6, s[40:43], s14 offen
    s_mov_b32 s14, 723776
    buffer_load_dword v23, v6, s[40:43], s14 offen
    s_mov_b32 s14, 704512
    buffer_load_dword v24, v6, s[44:47], s14 offen
    s_mov_b32 s14, 707264
    buffer_load_dword v25, v6, s[44:47], s14 offen
    s_mov_b32 s14, 710016
    buffer_load_dword v26, v6, s[44:47], s14 offen
    s_mov_b32 s14, 712768
    buffer_load_dword v27, v6, s[44:47], s14 offen
    s_mov_b32 s14, 715520
    buffer_load_dword v28, v6, s[44:47], s14 offen
    s_mov_b32 s14, 718272
    buffer_load_dword v29, v6, s[44:47], s14 offen
    s_mov_b32 s14, 721024
    buffer_load_dword v30, v6, s[44:47], s14 offen
    s_mov_b32 s14, 723776
    buffer_load_dword v31, v6, s[44:47], s14 offen
    s_waitcnt vmcnt(48)
    v_perm_b32 v80, v33, v32, s12
    v_accvgpr_write_b32 a80, v80
    v_perm_b32 v81, v35, v34, s12
    v_accvgpr_write_b32 a81, v81
    v_perm_b32 v80, v37, v36, s12
    v_accvgpr_write_b32 a82, v80
    v_perm_b32 v81, v39, v38, s12
    v_accvgpr_write_b32 a83, v81
    v_perm_b32 v80, v33, v32, s13
    v_accvgpr_write_b32 a84, v80
    v_perm_b32 v81, v35, v34, s13
    v_accvgpr_write_b32 a85, v81
    v_perm_b32 v80, v37, v36, s13
    v_accvgpr_write_b32 a86, v80
    v_perm_b32 v81, v39, v38, s13
    v_accvgpr_write_b32 a87, v81
    v_perm_b32 v80, v41, v40, s12
    v_accvgpr_write_b32 a88, v80
    v_perm_b32 v81, v43, v42, s12
    v_accvgpr_write_b32 a89, v81
    v_perm_b32 v80, v45, v44, s12
    v_accvgpr_write_b32 a90, v80
    v_perm_b32 v81, v47, v46, s12
    v_accvgpr_write_b32 a91, v81
    v_perm_b32 v80, v41, v40, s13
    v_accvgpr_write_b32 a92, v80
    v_perm_b32 v81, v43, v42, s13
    v_accvgpr_write_b32 a93, v81
    v_perm_b32 v80, v45, v44, s13
    v_accvgpr_write_b32 a94, v80
    v_perm_b32 v81, v47, v46, s13
    v_accvgpr_write_b32 a95, v81
    s_mov_b32 s14, 792576
    buffer_load_dword v32, v6, s[40:43], s14 offen
    s_mov_b32 s14, 795328
    buffer_load_dword v33, v6, s[40:43], s14 offen
    s_mov_b32 s14, 798080
    buffer_load_dword v34, v6, s[40:43], s14 offen
    s_mov_b32 s14, 800832
    buffer_load_dword v35, v6, s[40:43], s14 offen
    s_mov_b32 s14, 803584
    buffer_load_dword v36, v6, s[40:43], s14 offen
    s_mov_b32 s14, 806336
    buffer_load_dword v37, v6, s[40:43], s14 offen
    s_mov_b32 s14, 809088
    buffer_load_dword v38, v6, s[40:43], s14 offen
    s_mov_b32 s14, 811840
    buffer_load_dword v39, v6, s[40:43], s14 offen
    s_mov_b32 s14, 792576
    buffer_load_dword v40, v6, s[44:47], s14 offen
    s_mov_b32 s14, 795328
    buffer_load_dword v41, v6, s[44:47], s14 offen
    s_mov_b32 s14, 798080
    buffer_load_dword v42, v6, s[44:47], s14 offen
    s_mov_b32 s14, 800832
    buffer_load_dword v43, v6, s[44:47], s14 offen
    s_mov_b32 s14, 803584
    buffer_load_dword v44, v6, s[44:47], s14 offen
    s_mov_b32 s14, 806336
    buffer_load_dword v45, v6, s[44:47], s14 offen
    s_mov_b32 s14, 809088
    buffer_load_dword v46, v6, s[44:47], s14 offen
    s_mov_b32 s14, 811840
    buffer_load_dword v47, v6, s[44:47], s14 offen
    s_waitcnt vmcnt(48)
    v_perm_b32 v80, v49, v48, s12
    v_accvgpr_write_b32 a96, v80
    v_perm_b32 v81, v51, v50, s12
    v_accvgpr_write_b32 a97, v81
    v_perm_b32 v80, v53, v52, s12
    v_accvgpr_write_b32 a98, v80
    v_perm_b32 v81, v55, v54, s12
    v_accvgpr_write_b32 a99, v81
    v_perm_b32 v80, v49, v48, s13
    v_accvgpr_write_b32 a100, v80
    v_perm_b32 v81, v51, v50, s13
    v_accvgpr_write_b32 a101, v81
    v_perm_b32 v80, v53, v52, s13
    v_accvgpr_write_b32 a102, v80
    v_perm_b32 v81, v55, v54, s13
    v_accvgpr_write_b32 a103, v81
    v_perm_b32 v80, v57, v56, s12
    v_accvgpr_write_b32 a104, v80
    v_perm_b32 v81, v59, v58, s12
    v_accvgpr_write_b32 a105, v81
    v_perm_b32 v80, v61, v60, s12
    v_accvgpr_write_b32 a106, v80
    v_perm_b32 v81, v63, v62, s12
    v_accvgpr_write_b32 a107, v81
    v_perm_b32 v80, v57, v56, s13
    v_accvgpr_write_b32 a108, v80
    v_perm_b32 v81, v59, v58, s13
    v_accvgpr_write_b32 a109, v81
    v_perm_b32 v80, v61, v60, s13
    v_accvgpr_write_b32 a110, v80
    v_perm_b32 v81, v63, v62, s13
    v_accvgpr_write_b32 a111, v81
    s_mov_b32 s14, 880640
    buffer_load_dword v48, v6, s[40:43], s14 offen
    s_mov_b32 s14, 883392
    buffer_load_dword v49, v6, s[40:43], s14 offen
    s_mov_b32 s14, 886144
    buffer_load_dword v50, v6, s[40:43], s14 offen
    s_mov_b32 s14, 888896
    buffer_load_dword v51, v6, s[40:43], s14 offen
    s_mov_b32 s14, 891648
    buffer_load_dword v52, v6, s[40:43], s14 offen
    s_mov_b32 s14, 894400
    buffer_load_dword v53, v6, s[40:43], s14 offen
    s_mov_b32 s14, 897152
    buffer_load_dword v54, v6, s[40:43], s14 offen
    s_mov_b32 s14, 899904
    buffer_load_dword v55, v6, s[40:43], s14 offen
    s_mov_b32 s14, 880640
    buffer_load_dword v56, v6, s[44:47], s14 offen
    s_mov_b32 s14, 883392
    buffer_load_dword v57, v6, s[44:47], s14 offen
    s_mov_b32 s14, 886144
    buffer_load_dword v58, v6, s[44:47], s14 offen
    s_mov_b32 s14, 888896
    buffer_load_dword v59, v6, s[44:47], s14 offen
    s_mov_b32 s14, 891648
    buffer_load_dword v60, v6, s[44:47], s14 offen
    s_mov_b32 s14, 894400
    buffer_load_dword v61, v6, s[44:47], s14 offen
    s_mov_b32 s14, 897152
    buffer_load_dword v62, v6, s[44:47], s14 offen
    s_mov_b32 s14, 899904
    buffer_load_dword v63, v6, s[44:47], s14 offen
    s_waitcnt vmcnt(48)
    v_perm_b32 v80, v65, v64, s12
    v_accvgpr_write_b32 a112, v80
    v_perm_b32 v81, v67, v66, s12
    v_accvgpr_write_b32 a113, v81
    v_perm_b32 v80, v69, v68, s12
    v_accvgpr_write_b32 a114, v80
    v_perm_b32 v81, v71, v70, s12
    v_accvgpr_write_b32 a115, v81
    v_perm_b32 v80, v65, v64, s13
    v_accvgpr_write_b32 a116, v80
    v_perm_b32 v81, v67, v66, s13
    v_accvgpr_write_b32 a117, v81
    v_perm_b32 v80, v69, v68, s13
    v_accvgpr_write_b32 a118, v80
    v_perm_b32 v81, v71, v70, s13
    v_accvgpr_write_b32 a119, v81
    v_perm_b32 v80, v73, v72, s12
    v_accvgpr_write_b32 a120, v80
    v_perm_b32 v81, v75, v74, s12
    v_accvgpr_write_b32 a121, v81
    v_perm_b32 v80, v77, v76, s12
    v_accvgpr_write_b32 a122, v80
    v_perm_b32 v81, v79, v78, s12
    v_accvgpr_write_b32 a123, v81
    v_perm_b32 v80, v73, v72, s13
    v_accvgpr_write_b32 a124, v80
    v_perm_b32 v81, v75, v74, s13
    v_accvgpr_write_b32 a125, v81
    v_perm_b32 v80, v77, v76, s13
    v_accvgpr_write_b32 a126, v80
    v_perm_b32 v81, v79, v78, s13
    v_accvgpr_write_b32 a127, v81
    s_mov_b32 s14, 968704
    buffer_load_dword v64, v6, s[40:43], s14 offen
    s_mov_b32 s14, 971456
    buffer_load_dword v65, v6, s[40:43], s14 offen
    s_mov_b32 s14, 974208
    buffer_load_dword v66, v6, s[40:43], s14 offen
    s_mov_b32 s14, 976960
    buffer_load_dword v67, v6, s[40:43], s14 offen
    s_mov_b32 s14, 979712
    buffer_load_dword v68, v6, s[40:43], s14 offen
    s_mov_b32 s14, 982464
    buffer_load_dword v69, v6, s[40:43], s14 offen
    s_mov_b32 s14, 985216
    buffer_load_dword v70, v6, s[40:43], s14 offen
    s_mov_b32 s14, 987968
    buffer_load_dword v71, v6, s[40:43], s14 offen
    s_mov_b32 s14, 968704
    buffer_load_dword v72, v6, s[44:47], s14 offen
    s_mov_b32 s14, 971456
    buffer_load_dword v73, v6, s[44:47], s14 offen
    s_mov_b32 s14, 974208
    buffer_load_dword v74, v6, s[44:47], s14 offen
    s_mov_b32 s14, 976960
    buffer_load_dword v75, v6, s[44:47], s14 offen
    s_mov_b32 s14, 979712
    buffer_load_dword v76, v6, s[44:47], s14 offen
    s_mov_b32 s14, 982464
    buffer_load_dword v77, v6, s[44:47], s14 offen
    s_mov_b32 s14, 985216
    buffer_load_dword v78, v6, s[44:47], s14 offen
    s_mov_b32 s14, 987968
    buffer_load_dword v79, v6, s[44:47], s14 offen
    s_waitcnt vmcnt(48)
    v_perm_b32 v80, v17, v16, s12
    v_accvgpr_write_b32 a128, v80
    v_perm_b32 v81, v19, v18, s12
    v_accvgpr_write_b32 a129, v81
    v_perm_b32 v80, v21, v20, s12
    v_accvgpr_write_b32 a130, v80
    v_perm_b32 v81, v23, v22, s12
    v_accvgpr_write_b32 a131, v81
    v_perm_b32 v80, v17, v16, s13
    v_accvgpr_write_b32 a132, v80
    v_perm_b32 v81, v19, v18, s13
    v_accvgpr_write_b32 a133, v81
    v_perm_b32 v80, v21, v20, s13
    v_accvgpr_write_b32 a134, v80
    v_perm_b32 v81, v23, v22, s13
    v_accvgpr_write_b32 a135, v81
    v_perm_b32 v80, v25, v24, s12
    v_accvgpr_write_b32 a136, v80
    v_perm_b32 v81, v27, v26, s12
    v_accvgpr_write_b32 a137, v81
    v_perm_b32 v80, v29, v28, s12
    v_accvgpr_write_b32 a138, v80
    v_perm_b32 v81, v31, v30, s12
    v_accvgpr_write_b32 a139, v81
    v_perm_b32 v80, v25, v24, s13
    v_accvgpr_write_b32 a140, v80
    v_perm_b32 v81, v27, v26, s13
    v_accvgpr_write_b32 a141, v81
    v_perm_b32 v80, v29, v28, s13
    v_accvgpr_write_b32 a142, v80
    v_perm_b32 v81, v31, v30, s13
    v_accvgpr_write_b32 a143, v81
    s_mov_b32 s14, 1056768
    buffer_load_dword v16, v6, s[40:43], s14 offen
    s_mov_b32 s14, 1059520
    buffer_load_dword v17, v6, s[40:43], s14 offen
    s_mov_b32 s14, 1062272
    buffer_load_dword v18, v6, s[40:43], s14 offen
    s_mov_b32 s14, 1065024
    buffer_load_dword v19, v6, s[40:43], s14 offen
    s_mov_b32 s14, 1067776
    buffer_load_dword v20, v6, s[40:43], s14 offen
    s_mov_b32 s14, 1070528
    buffer_load_dword v21, v6, s[40:43], s14 offen
    s_mov_b32 s14, 1073280
    buffer_load_dword v22, v6, s[40:43], s14 offen
    s_mov_b32 s14, 1076032
    buffer_load_dword v23, v6, s[40:43], s14 offen
    s_mov_b32 s14, 1056768
    buffer_load_dword v24, v6, s[44:47], s14 offen
    s_mov_b32 s14, 1059520
    buffer_load_dword v25, v6, s[44:47], s14 offen
    s_mov_b32 s14, 1062272
    buffer_load_dword v26, v6, s[44:47], s14 offen
    s_mov_b32 s14, 1065024
    buffer_load_dword v27, v6, s[44:47], s14 offen
    s_mov_b32 s14, 1067776
    buffer_load_dword v28, v6, s[44:47], s14 offen
    s_mov_b32 s14, 1070528
    buffer_load_dword v29, v6, s[44:47], s14 offen
    s_mov_b32 s14, 1073280
    buffer_load_dword v30, v6, s[44:47], s14 offen
    s_mov_b32 s14, 1076032
    buffer_load_dword v31, v6, s[44:47], s14 offen
    s_waitcnt vmcnt(48)
    v_perm_b32 v80, v33, v32, s12
    v_accvgpr_write_b32 a144, v80
    v_perm_b32 v81, v35, v34, s12
    v_accvgpr_write_b32 a145, v81
    v_perm_b32 v80, v37, v36, s12
    v_accvgpr_write_b32 a146, v80
    v_perm_b32 v81, v39, v38, s12
    v_accvgpr_write_b32 a147, v81
    v_perm_b32 v80, v33, v32, s13
    v_accvgpr_write_b32 a148, v80
    v_perm_b32 v81, v35, v34, s13
    v_accvgpr_write_b32 a149, v81
    v_perm_b32 v80, v37, v36, s13
    v_accvgpr_write_b32 a150, v80
    v_perm_b32 v81, v39, v38, s13
    v_accvgpr_write_b32 a151, v81
    v_perm_b32 v80, v41, v40, s12
    v_accvgpr_write_b32 a152, v80
    v_perm_b32 v81, v43, v42, s12
    v_accvgpr_write_b32 a153, v81
    v_perm_b32 v80, v45, v44, s12
    v_accvgpr_write_b32 a154, v80
    v_perm_b32 v81, v47, v46, s12
    v_accvgpr_write_b32 a155, v81
    v_perm_b32 v80, v41, v40, s13
    v_accvgpr_write_b32 a156, v80
    v_perm_b32 v81, v43, v42, s13
    v_accvgpr_write_b32 a157, v81
    v_perm_b32 v80, v45, v44, s13
    v_accvgpr_write_b32 a158, v80
    v_perm_b32 v81, v47, v46, s13
    v_accvgpr_write_b32 a159, v81
    s_mov_b32 s14, 1144832
    buffer_load_dword v32, v6, s[40:43], s14 offen
    s_mov_b32 s14, 1147584
    buffer_load_dword v33, v6, s[40:43], s14 offen
    s_mov_b32 s14, 1150336
    buffer_load_dword v34, v6, s[40:43], s14 offen
    s_mov_b32 s14, 1153088
    buffer_load_dword v35, v6, s[40:43], s14 offen
    s_mov_b32 s14, 1155840
    buffer_load_dword v36, v6, s[40:43], s14 offen
    s_mov_b32 s14, 1158592
    buffer_load_dword v37, v6, s[40:43], s14 offen
    s_mov_b32 s14, 1161344
    buffer_load_dword v38, v6, s[40:43], s14 offen
    s_mov_b32 s14, 1164096
    buffer_load_dword v39, v6, s[40:43], s14 offen
    s_mov_b32 s14, 1144832
    buffer_load_dword v40, v6, s[44:47], s14 offen
    s_mov_b32 s14, 1147584
    buffer_load_dword v41, v6, s[44:47], s14 offen
    s_mov_b32 s14, 1150336
    buffer_load_dword v42, v6, s[44:47], s14 offen
    s_mov_b32 s14, 1153088
    buffer_load_dword v43, v6, s[44:47], s14 offen
    s_mov_b32 s14, 1155840
    buffer_load_dword v44, v6, s[44:47], s14 offen
    s_mov_b32 s14, 1158592
    buffer_load_dword v45, v6, s[44:47], s14 offen
    s_mov_b32 s14, 1161344
    buffer_load_dword v46, v6, s[44:47], s14 offen
    s_mov_b32 s14, 1164096
    buffer_load_dword v47, v6, s[44:47], s14 offen
    s_waitcnt vmcnt(48)
    v_perm_b32 v80, v49, v48, s12
    v_accvgpr_write_b32 a160, v80
    v_perm_b32 v81, v51, v50, s12
    v_accvgpr_write_b32 a161, v81
    v_perm_b32 v80, v53, v52, s12
    v_accvgpr_write_b32 a162, v80
    v_perm_b32 v81, v55, v54, s12
    v_accvgpr_write_b32 a163, v81
    v_perm_b32 v80, v49, v48, s13
    v_accvgpr_write_b32 a164, v80
    v_perm_b32 v81, v51, v50, s13
    v_accvgpr_write_b32 a165, v81
    v_perm_b32 v80, v53, v52, s13
    v_accvgpr_write_b32 a166, v80
    v_perm_b32 v81, v55, v54, s13
    v_accvgpr_write_b32 a167, v81
    v_perm_b32 v80, v57, v56, s12
    v_accvgpr_write_b32 a168, v80
    v_perm_b32 v81, v59, v58, s12
    v_accvgpr_write_b32 a169, v81
    v_perm_b32 v80, v61, v60, s12
    v_accvgpr_write_b32 a170, v80
    v_perm_b32 v81, v63, v62, s12
    v_accvgpr_write_b32 a171, v81
    v_perm_b32 v80, v57, v56, s13
    v_accvgpr_write_b32 a172, v80
    v_perm_b32 v81, v59, v58, s13
    v_accvgpr_write_b32 a173, v81
    v_perm_b32 v80, v61, v60, s13
    v_accvgpr_write_b32 a174, v80
    v_perm_b32 v81, v63, v62, s13
    v_accvgpr_write_b32 a175, v81
    s_mov_b32 s14, 1232896
    buffer_load_dword v48, v6, s[40:43], s14 offen
    s_mov_b32 s14, 1235648
    buffer_load_dword v49, v6, s[40:43], s14 offen
    s_mov_b32 s14, 1238400
    buffer_load_dword v50, v6, s[40:43], s14 offen
    s_mov_b32 s14, 1241152
    buffer_load_dword v51, v6, s[40:43], s14 offen
    s_mov_b32 s14, 1243904
    buffer_load_dword v52, v6, s[40:43], s14 offen
    s_mov_b32 s14, 1246656
    buffer_load_dword v53, v6, s[40:43], s14 offen
    s_mov_b32 s14, 1249408
    buffer_load_dword v54, v6, s[40:43], s14 offen
    s_mov_b32 s14, 1252160
    buffer_load_dword v55, v6, s[40:43], s14 offen
    s_mov_b32 s14, 1232896
    buffer_load_dword v56, v6, s[44:47], s14 offen
    s_mov_b32 s14, 1235648
    buffer_load_dword v57, v6, s[44:47], s14 offen
    s_mov_b32 s14, 1238400
    buffer_load_dword v58, v6, s[44:47], s14 offen
    s_mov_b32 s14, 1241152
    buffer_load_dword v59, v6, s[44:47], s14 offen
    s_mov_b32 s14, 1243904
    buffer_load_dword v60, v6, s[44:47], s14 offen
    s_mov_b32 s14, 1246656
    buffer_load_dword v61, v6, s[44:47], s14 offen
    s_mov_b32 s14, 1249408
    buffer_load_dword v62, v6, s[44:47], s14 offen
    s_mov_b32 s14, 1252160
    buffer_load_dword v63, v6, s[44:47], s14 offen
    s_waitcnt vmcnt(48)
    v_perm_b32 v80, v65, v64, s12
    v_accvgpr_write_b32 a176, v80
    v_perm_b32 v81, v67, v66, s12
    v_accvgpr_write_b32 a177, v81
    v_perm_b32 v80, v69, v68, s12
    v_accvgpr_write_b32 a178, v80
    v_perm_b32 v81, v71, v70, s12
    v_accvgpr_write_b32 a179, v81
    v_perm_b32 v80, v65, v64, s13
    v_accvgpr_write_b32 a180, v80
    v_perm_b32 v81, v67, v66, s13
    v_accvgpr_write_b32 a181, v81
    v_perm_b32 v80, v69, v68, s13
    v_accvgpr_write_b32 a182, v80
    v_perm_b32 v81, v71, v70, s13
    v_accvgpr_write_b32 a183, v81
    v_perm_b32 v80, v73, v72, s12
    v_accvgpr_write_b32 a184, v80
    v_perm_b32 v81, v75, v74, s12
    v_accvgpr_write_b32 a185, v81
    v_perm_b32 v80, v77, v76, s12
    v_accvgpr_write_b32 a186, v80
    v_perm_b32 v81, v79, v78, s12
    v_accvgpr_write_b32 a187, v81
    v_perm_b32 v80, v73, v72, s13
    v_accvgpr_write_b32 a188, v80
    v_perm_b32 v81, v75, v74, s13
    v_accvgpr_write_b32 a189, v81
    v_perm_b32 v80, v77, v76, s13
    v_accvgpr_write_b32 a190, v80
    v_perm_b32 v81, v79, v78, s13
    v_accvgpr_write_b32 a191, v81
    s_mov_b32 s14, 1320960
    buffer_load_dword v64, v6, s[40:43], s14 offen
    s_mov_b32 s14, 1323712
    buffer_load_dword v65, v6, s[40:43], s14 offen
    s_mov_b32 s14, 1326464
    buffer_load_dword v66, v6, s[40:43], s14 offen
    s_mov_b32 s14, 1329216
    buffer_load_dword v67, v6, s[40:43], s14 offen
    s_mov_b32 s14, 1331968
    buffer_load_dword v68, v6, s[40:43], s14 offen
    s_mov_b32 s14, 1334720
    buffer_load_dword v69, v6, s[40:43], s14 offen
    s_mov_b32 s14, 1337472
    buffer_load_dword v70, v6, s[40:43], s14 offen
    s_mov_b32 s14, 1340224
    buffer_load_dword v71, v6, s[40:43], s14 offen
    s_mov_b32 s14, 1320960
    buffer_load_dword v72, v6, s[44:47], s14 offen
    s_mov_b32 s14, 1323712
    buffer_load_dword v73, v6, s[44:47], s14 offen
    s_mov_b32 s14, 1326464
    buffer_load_dword v74, v6, s[44:47], s14 offen
    s_mov_b32 s14, 1329216
    buffer_load_dword v75, v6, s[44:47], s14 offen
    s_mov_b32 s14, 1331968
    buffer_load_dword v76, v6, s[44:47], s14 offen
    s_mov_b32 s14, 1334720
    buffer_load_dword v77, v6, s[44:47], s14 offen
    s_mov_b32 s14, 1337472
    buffer_load_dword v78, v6, s[44:47], s14 offen
    s_mov_b32 s14, 1340224
    buffer_load_dword v79, v6, s[44:47], s14 offen
    s_waitcnt vmcnt(48)
    v_perm_b32 v80, v17, v16, s12
    v_accvgpr_write_b32 a192, v80
    v_perm_b32 v81, v19, v18, s12
    v_accvgpr_write_b32 a193, v81
    v_perm_b32 v80, v21, v20, s12
    v_accvgpr_write_b32 a194, v80
    v_perm_b32 v81, v23, v22, s12
    v_accvgpr_write_b32 a195, v81
    v_perm_b32 v80, v17, v16, s13
    v_accvgpr_write_b32 a196, v80
    v_perm_b32 v81, v19, v18, s13
    v_accvgpr_write_b32 a197, v81
    v_perm_b32 v80, v21, v20, s13
    v_accvgpr_write_b32 a198, v80
    v_perm_b32 v81, v23, v22, s13
    v_accvgpr_write_b32 a199, v81
    v_perm_b32 v80, v25, v24, s12
    v_accvgpr_write_b32 a200, v80
    v_perm_b32 v81, v27, v26, s12
    v_accvgpr_write_b32 a201, v81
    v_perm_b32 v80, v29, v28, s12
    v_accvgpr_write_b32 a202, v80
    v_perm_b32 v81, v31, v30, s12
    v_accvgpr_write_b32 a203, v81
    v_perm_b32 v80, v25, v24, s13
    v_accvgpr_write_b32 a204, v80
    v_perm_b32 v81, v27, v26, s13
    v_accvgpr_write_b32 a205, v81
    v_perm_b32 v80, v29, v28, s13
    v_accvgpr_write_b32 a206, v80
    v_perm_b32 v81, v31, v30, s13
    v_accvgpr_write_b32 a207, v81
    s_waitcnt vmcnt(32)
    v_perm_b32 v80, v33, v32, s12
    v_accvgpr_write_b32 a208, v80
    v_perm_b32 v81, v35, v34, s12
    v_accvgpr_write_b32 a209, v81
    v_perm_b32 v80, v37, v36, s12
    v_accvgpr_write_b32 a210, v80
    v_perm_b32 v81, v39, v38, s12
    v_accvgpr_write_b32 a211, v81
    v_perm_b32 v80, v33, v32, s13
    v_accvgpr_write_b32 a212, v80
    v_perm_b32 v81, v35, v34, s13
    v_accvgpr_write_b32 a213, v81
    v_perm_b32 v80, v37, v36, s13
    v_accvgpr_write_b32 a214, v80
    v_perm_b32 v81, v39, v38, s13
    v_accvgpr_write_b32 a215, v81
    v_perm_b32 v80, v41, v40, s12
    v_accvgpr_write_b32 a216, v80
    v_perm_b32 v81, v43, v42, s12
    v_accvgpr_write_b32 a217, v81
    v_perm_b32 v80, v45, v44, s12
    v_accvgpr_write_b32 a218, v80
    v_perm_b32 v81, v47, v46, s12
    v_accvgpr_write_b32 a219, v81
    v_perm_b32 v80, v41, v40, s13
    v_accvgpr_write_b32 a220, v80
    v_perm_b32 v81, v43, v42, s13
    v_accvgpr_write_b32 a221, v81
    v_perm_b32 v80, v45, v44, s13
    v_accvgpr_write_b32 a222, v80
    v_perm_b32 v81, v47, v46, s13
    v_accvgpr_write_b32 a223, v81
    s_waitcnt vmcnt(16)
    v_perm_b32 v80, v49, v48, s12
    v_accvgpr_write_b32 a224, v80
    v_perm_b32 v81, v51, v50, s12
    v_accvgpr_write_b32 a225, v81
    v_perm_b32 v80, v53, v52, s12
    v_accvgpr_write_b32 a226, v80
    v_perm_b32 v81, v55, v54, s12
    v_accvgpr_write_b32 a227, v81
    v_perm_b32 v80, v49, v48, s13
    v_accvgpr_write_b32 a228, v80
    v_perm_b32 v81, v51, v50, s13
    v_accvgpr_write_b32 a229, v81
    v_perm_b32 v80, v53, v52, s13
    v_accvgpr_write_b32 a230, v80
    v_perm_b32 v81, v55, v54, s13
    v_accvgpr_write_b32 a231, v81
    v_perm_b32 v80, v57, v56, s12
    v_accvgpr_write_b32 a232, v80
    v_perm_b32 v81, v59, v58, s12
    v_accvgpr_write_b32 a233, v81
    v_perm_b32 v80, v61, v60, s12
    v_accvgpr_write_b32 a234, v80
    v_perm_b32 v81, v63, v62, s12
    v_accvgpr_write_b32 a235, v81
    v_perm_b32 v80, v57, v56, s13
    v_accvgpr_write_b32 a236, v80
    v_perm_b32 v81, v59, v58, s13
    v_accvgpr_write_b32 a237, v81
    v_perm_b32 v80, v61, v60, s13
    v_accvgpr_write_b32 a238, v80
    v_perm_b32 v81, v63, v62, s13
    v_accvgpr_write_b32 a239, v81
    s_waitcnt vmcnt(0)
    v_perm_b32 v80, v65, v64, s12
    v_accvgpr_write_b32 a240, v80
    v_perm_b32 v81, v67, v66, s12
    v_accvgpr_write_b32 a241, v81
    v_perm_b32 v80, v69, v68, s12
    v_accvgpr_write_b32 a242, v80
    v_perm_b32 v81, v71, v70, s12
    v_accvgpr_write_b32 a243, v81
    v_perm_b32 v80, v65, v64, s13
    v_accvgpr_write_b32 a244, v80
    v_perm_b32 v81, v67, v66, s13
    v_accvgpr_write_b32 a245, v81
    v_perm_b32 v80, v69, v68, s13
    v_accvgpr_write_b32 a246, v80
    v_perm_b32 v81, v71, v70, s13
    v_accvgpr_write_b32 a247, v81
    v_perm_b32 v80, v73, v72, s12
    v_accvgpr_write_b32 a248, v80
    v_perm_b32 v81, v75, v74, s12
    v_accvgpr_write_b32 a249, v81
    v_perm_b32 v80, v77, v76, s12
    v_accvgpr_write_b32 a250, v80
    v_perm_b32 v81, v79, v78, s12
    v_accvgpr_write_b32 a251, v81
    v_perm_b32 v80, v73, v72, s13
    v_accvgpr_write_b32 a252, v80
    v_perm_b32 v81, v75, v74, s13
    v_accvgpr_write_b32 a253, v81
    v_perm_b32 v80, v77, v76, s13
    v_accvgpr_write_b32 a254, v80
    v_perm_b32 v81, v79, v78, s13
    v_accvgpr_write_b32 a255, v81
    s_mov_b32 s12, 84148480
    s_mov_b32 s13, 117834498
    s_mov_b32 s14, 0
    buffer_load_dwordx4 v[16:19], v7, s[48:51], s14 offen
    s_mov_b32 s14, 1024
    buffer_load_dwordx4 v[20:23], v7, s[48:51], s14 offen
    s_mov_b32 s14, 2048
    buffer_load_dwordx4 v[24:27], v7, s[48:51], s14 offen
    s_mov_b32 s14, 3072
    buffer_load_dwordx4 v[28:31], v7, s[48:51], s14 offen
    s_mov_b32 s14, 4096
    buffer_load_dwordx4 v[32:35], v7, s[48:51], s14 offen
    s_mov_b32 s14, 5120
    buffer_load_dwordx4 v[36:39], v7, s[48:51], s14 offen
    s_mov_b32 s14, 6144
    buffer_load_dwordx4 v[40:43], v7, s[48:51], s14 offen
    s_mov_b32 s14, 7168
    buffer_load_dwordx4 v[44:47], v7, s[48:51], s14 offen
    s_mov_b32 s14, 32768
    buffer_load_dwordx4 v[48:51], v7, s[48:51], s14 offen
    s_mov_b32 s14, 33792
    buffer_load_dwordx4 v[52:55], v7, s[48:51], s14 offen
    s_mov_b32 s14, 34816
    buffer_load_dwordx4 v[56:59], v7, s[48:51], s14 offen
    s_mov_b32 s14, 35840
    buffer_load_dwordx4 v[60:63], v7, s[48:51], s14 offen
    s_mov_b32 s14, 36864
    buffer_load_dwordx4 v[64:67], v7, s[48:51], s14 offen
    s_mov_b32 s14, 37888
    buffer_load_dwordx4 v[68:71], v7, s[48:51], s14 offen
    s_mov_b32 s14, 38912
    buffer_load_dwordx4 v[72:75], v7, s[48:51], s14 offen
    s_mov_b32 s14, 39936
    buffer_load_dwordx4 v[76:79], v7, s[48:51], s14 offen
    s_waitcnt vmcnt(8)
    v_perm_b32 v192, v20, v16, s12
    v_perm_b32 v193, v28, v24, s12
    v_perm_b32 v194, v36, v32, s12
    v_perm_b32 v195, v44, v40, s12
    v_perm_b32 v196, v20, v16, s13
    v_perm_b32 v197, v28, v24, s13
    v_perm_b32 v198, v36, v32, s13
    v_perm_b32 v199, v44, v40, s13
    v_perm_b32 v200, v21, v17, s12
    v_perm_b32 v201, v29, v25, s12
    v_perm_b32 v202, v37, v33, s12
    v_perm_b32 v203, v45, v41, s12
    v_perm_b32 v204, v21, v17, s13
    v_perm_b32 v205, v29, v25, s13
    v_perm_b32 v206, v37, v33, s13
    v_perm_b32 v207, v45, v41, s13
    v_perm_b32 v208, v22, v18, s12
    v_perm_b32 v209, v30, v26, s12
    v_perm_b32 v210, v38, v34, s12
    v_perm_b32 v211, v46, v42, s12
    v_perm_b32 v212, v22, v18, s13
    v_perm_b32 v213, v30, v26, s13
    v_perm_b32 v214, v38, v34, s13
    v_perm_b32 v215, v46, v42, s13
    v_perm_b32 v216, v23, v19, s12
    v_perm_b32 v217, v31, v27, s12
    v_perm_b32 v218, v39, v35, s12
    v_perm_b32 v219, v47, v43, s12
    v_perm_b32 v220, v23, v19, s13
    v_perm_b32 v221, v31, v27, s13
    v_perm_b32 v222, v39, v35, s13
    v_perm_b32 v223, v47, v43, s13
    s_waitcnt vmcnt(0)
    v_perm_b32 v224, v52, v48, s12
    v_perm_b32 v225, v60, v56, s12
    v_perm_b32 v226, v68, v64, s12
    v_perm_b32 v227, v76, v72, s12
    v_perm_b32 v228, v52, v48, s13
    v_perm_b32 v229, v60, v56, s13
    v_perm_b32 v230, v68, v64, s13
    v_perm_b32 v231, v76, v72, s13
    v_perm_b32 v232, v53, v49, s12
    v_perm_b32 v233, v61, v57, s12
    v_perm_b32 v234, v69, v65, s12
    v_perm_b32 v235, v77, v73, s12
    v_perm_b32 v236, v53, v49, s13
    v_perm_b32 v237, v61, v57, s13
    v_perm_b32 v238, v69, v65, s13
    v_perm_b32 v239, v77, v73, s13
    v_perm_b32 v240, v54, v50, s12
    v_perm_b32 v241, v62, v58, s12
    v_perm_b32 v242, v70, v66, s12
    v_perm_b32 v243, v78, v74, s12
    v_perm_b32 v244, v54, v50, s13
    v_perm_b32 v245, v62, v58, s13
    v_perm_b32 v246, v70, v66, s13
    v_perm_b32 v247, v78, v74, s13
    v_perm_b32 v248, v55, v51, s12
    v_perm_b32 v249, v63, v59, s12
    v_perm_b32 v250, v71, v67, s12
    v_perm_b32 v251, v79, v75, s12
    v_perm_b32 v252, v55, v51, s13
    v_perm_b32 v253, v63, v59, s13
    v_perm_b32 v254, v71, v67, s13
    v_perm_b32 v255, v79, v75, s13
L_FF_noweights:
    v_mul_u32_u24 v28, 132096, v2
    v_lshl_add_u32 v28, v3, 4, v28
    s_lshl_b32 s9, s5, 10
    s_lshl_b32 s10, s3, 8
    s_add_u32 s9, s9, s10
    v_add_u32 v6, s9, v28
    v_lshlrev_b32 v28, 10, v2
    v_lshl_add_u32 v28, v3, 4, v28
    s_mul_i32 s9, s5, 33024
    s_add_u32 s9, s9, s10
    v_add_u32 v7, s9, v28
    v_lshlrev_b32 v28, 4, v3
    v_and_b32 v29, 1, v2
    v_lshl_add_u32 v28, v29, 3, v28
    v_add_u32 v8, s10, v28
    v_mov_b32 v28, 0x3f80
    v_mov_b32 v29, 0x3f800000
    v_cmp_eq_u32 vcc, 0, v3
    s_nop 1
    v_cndmask_b32 v24, 0, v28, vcc
    v_cmp_eq_u32 vcc, 1, v3
    s_nop 1
    v_cndmask_b32 v24, v24, v29, vcc
    v_mov_b32 v28, 0x3f80
    v_mov_b32 v29, 0x3f800000
    v_cmp_eq_u32 vcc, 2, v3
    s_nop 1
    v_cndmask_b32 v25, 0, v28, vcc
    v_cmp_eq_u32 vcc, 3, v3
    s_nop 1
    v_cndmask_b32 v25, v25, v29, vcc
    v_mov_b32 v28, 0x3f80
    v_mov_b32 v29, 0x3f800000
    v_cmp_eq_u32 vcc, 4, v3
    s_nop 1
    v_cndmask_b32 v26, 0, v28, vcc
    v_cmp_eq_u32 vcc, 5, v3
    s_nop 1
    v_cndmask_b32 v26, v26, v29, vcc
    v_mov_b32 v28, 0x3f80
    v_mov_b32 v29, 0x3f800000
    v_cmp_eq_u32 vcc, 6, v3
    s_nop 1
    v_cndmask_b32 v27, 0, v28, vcc
    v_cmp_eq_u32 vcc, 7, v3
    s_nop 1
    v_cndmask_b32 v27, v27, v29, vcc
    s_lshl_b32 s9, s64, 9
    s_add_u32 s9, s9, 6897664
    v_lshlrev_b32 v28, 3, v1
    v_add_u32 v9, s9, v28
    s_and_b32 s9, s3, 1
    s_lshl_b32 s10, s9, 11
    s_lshr_b32 s11, s3, 1
    s_lshl_b32 s11, s11, 10
    s_add_u32 s10, s10, s11
    v_add_u32 v10, s10, v4
    s_mul_i32 s9, s9, 16640
    s_add_u32 s9, s9, 4096
    v_mul_u32_u24 v28, 1040, v3
    v_add_u32 v28, s9, v28
    v_lshl_add_u32 v11, v2, 4, v28
    s_mul_i32 s9, s3, 8320
    s_add_u32 s9, s9, 4096
    v_add_u32 v14, s9, v4
    v_lshlrev_b32 v13, 7, v1
    v_mov_b32 v28, 0x7ffffff0
    v_cmp_gt_u32 vcc, 2, v2
    s_nop 1
    v_cndmask_b32 v12, v28, v7, vcc
    s_mov_b32 s66, -1
    s_mov_b32 s67, 0
wt_74:
    buffer_load_dword v28, v5, s[56:59], 0 offen sc1
    s_waitcnt vmcnt(0)
    s_mov_b32 s9, 3233857728
    v_and_b32 v29, s9, v28
    v_cmp_ne_u32 vcc, s9, v29
    s_and_b32 vcc_lo, vcc_lo, 4294967040
    s_and_b32 vcc_hi, vcc_hi, 4294967295
    s_cmp_eq_u64 vcc, 0
    s_cbranch_scc1 wtd_75
    s_sleep 100
    s_sub_u32 s8, s8, 1
    s_cbranch_scc0 wt_74
    s_mov_b32 s8, 0
wtd_75:
    s_mul_i32 s9, s6, 0x01010101
    v_and_b32 v28, 0x0f0f0f0f, v28
    v_cmp_ne_u32 vcc, s9, v28
    s_lshl_b32 s10, s4, 3
    s_lshr_b64 s[10:11], vcc, s10
    s_and_b32 s10, s10, 0xff
    s_cmp_lg_u32 s10, 0
    s_cselect_b32 s7, 1, 0
    s_add_u32 s9, s64, 52
    s_cmp_ge_u32 s64, 2
    s_cselect_b32 s68, s9, s64
    s_cmp_lt_u32 s64, 2
    s_cbranch_scc1 fj_77
    s_mov_b32 s10, 55279616
fj_78:
    buffer_load_dword v28, off, s[60:63], s10 sc1
    s_waitcnt vmcnt(0)
    v_cmp_eq_u32 vcc, -1, v28
    s_cbranch_vccz fjd_79
    s_sleep 32
    s_sub_u32 s8, s8, 1
    s_cbranch_scc0 fj_78
    s_mov_b32 s8, 0
fjd_79:
    s_mov_b32 s10, 56164352
fj_80:
    buffer_load_dword v28, off, s[60:63], s10 sc1
    s_waitcnt vmcnt(0)
    v_cmp_eq_u32 vcc, -1, v28
    s_cbranch_vccz fj_77
    s_sleep 48
    s_sub_u32 s8, s8, 1
    s_cbranch_scc0 fj_80
    s_mov_b32 s8, 0
fj_77:
    s_mov_b32 s69, 0
    s_mov_b32 s70, 0xbfb8aa3b
    s_mov_b32 s71, 0xbfb8aa3b
    s_cmp_lg_u32 s7, 0
    s_cbranch_scc1 L_FF_far
L_FF_near:
    s_and_b32 s74, s69, 1
    s_lshl_b32 s9, s64, 1
    s_add_u32 s74, s74, s9
    s_mul_i32 s74, s74, 1310720
    s_add_u32 s74, s74, 125829120
    s_bfe_u32 s13, s69, 0x10001
    v_mov_b32 v15, s13
    s_lshl_b32 s9, s69, 1
    s_sub_u32 s9, s9, 2
    s_max_i32 s9, s9, 0
wf_81:
    buffer_load_dwordx2 v[28:29], v9, s[60:63], 0 offen sc1
    s_waitcnt vmcnt(0)
    v_min_u32 v28, v28, v29
    v_cmp_gt_u32 vcc, s9, v28
    s_cbranch_vccz wfd_82
    s_sleep 1
    s_sub_u32 s8, s8, 1
    s_cbranch_scc0 wf_81
    s_mov_b32 s8, 0
wfd_82:
    s_add_u32 s69, s69, 1
    s_lshl_b32 s75, s68, 5
    s_add_u32 s75, s75, s5
    s_lshl_b32 s75, s75, 10
    s_add_u32 s73, s75, 4194304
    s_cmp_ge_u32 s5, 22
    s_cbranch_scc1 L_FF_flag_near
    s_lshl_b32 s72, s68, 15
    s_lshl_b32 s9, s3, 13
    s_add_u32 s72, s72, s9
    s_add_u32 s72, s72, 54525952
    s_add_u32 s15, s72, 4096
hp_83:
    buffer_load_dword v28, v13, s[60:63], s72 offen sc1
    s_waitcnt vmcnt(0)
    v_cmp_eq_u32 vcc, -1, v28
    s_cbranch_vccz hpd_84
    s_sleep 1
    s_sub_u32 s8, s8, 1
    s_cbranch_scc0 hp_83
    s_mov_b32 s8, 0
hpd_84:
    buffer_load_dwordx4 v[32:35], v4, s[60:63], s72 offen offset:0 sc1
    buffer_load_dwordx4 v[36:39], v4, s[60:63], s72 offen offset:1024 sc1
    buffer_load_dwordx4 v[40:43], v4, s[60:63], s72 offen offset:2048 sc1
    buffer_load_dwordx4 v[44:47], v4, s[60:63], s72 offen offset:3072 sc1
    buffer_load_dwordx4 v[48:51], v4, s[60:63], s15 offen offset:0 sc1
    buffer_load_dwordx4 v[52:55], v4, s[60:63], s15 offen offset:1024 sc1
    buffer_load_dwordx4 v[56:59], v4, s[60:63], s15 offen offset:2048 sc1
    buffer_load_dwordx4 v[60:63], v4, s[60:63], s15 offen offset:3072 sc1
    v_mov_b32 v28, 0
    s_waitcnt vmcnt(7)
    ds_write_b128 v14, v[32:35] offset:0
    v_max3_u32 v28, v28, v32, v33
    v_max3_u32 v28, v28, v34, v35
    s_waitcnt vmcnt(6)
    ds_write_b128 v14, v[36:39] offset:1040
    v_max3_u32 v28, v28, v36, v37
    v_max3_u32 v28, v28, v38, v39
    s_waitcnt vmcnt(5)
    ds_write_b128 v14, v[40:43] offset:2080
    v_max3_u32 v28, v28, v40, v41
    v_max3_u32 v28, v28, v42, v43
    s_waitcnt vmcnt(4)
    ds_write_b128 v14, v[44:47] offset:3120
    v_max3_u32 v28, v28, v44, v45
    v_max3_u32 v28, v28, v46, v47
    s_waitcnt vmcnt(3)
    ds_write_b128 v14, v[48:51] offset:4160
    v_max3_u32 v28, v28, v48, v49
    v_max3_u32 v28, v28, v50, v51
    s_waitcnt vmcnt(2)
    ds_write_b128 v14, v[52:55] offset:5200
    v_max3_u32 v28, v28, v52, v53
    v_max3_u32 v28, v28, v54, v55
    s_waitcnt vmcnt(1)
    ds_write_b128 v14, v[56:59] offset:6240
    v_max3_u32 v28, v28, v56, v57
    v_max3_u32 v28, v28, v58, v59
    s_waitcnt vmcnt(0)
    ds_write_b128 v14, v[60:63] offset:7280
    v_max3_u32 v28, v28, v60, v61
    v_max3_u32 v28, v28, v62, v63
    v_cmp_eq_u32 vcc, -1, v28
    s_cbranch_vccz hv_85
    s_sub_u32 s8, s8, 1
    s_cbranch_scc0 hpd_84
    s_mov_b32 s8, 0
hv_85:
    buffer_load_dwordx2 v[30:31], v8, s[60:63], s73 offen sc1
    s_waitcnt lgkmcnt(0)
    s_barrier
    ds_read_b128 v[32:35], v11 offset:0
    ds_read_b128 v[36:39], v11 offset:64
    ds_read_b128 v[40:43], v11 offset:128
    ds_read_b128 v[44:47], v11 offset:192
    ds_read_b128 v[48:51], v11 offset:256
    s_waitcnt lgkmcnt(4)
    v_mfma_f32_16x16x32_bf16 v[96:99], a[0:3], v[32:35], 0
    v_mfma_f32_16x16x32_bf16 v[100:103], a[4:7], v[32:35], 0
    v_mfma_f32_16x16x32_bf16 v[104:107], a[8:11], v[32:35], 0
    v_mfma_f32_16x16x32_bf16 v[108:111], a[12:15], v[32:35], 0
    ds_read_b128 v[52:55], v11 offset:320
    s_waitcnt lgkmcnt(4)
    v_mfma_f32_16x16x32_bf16 v[96:99], a[16:19], v[36:39], v[96:99]
    v_mfma_f32_16x16x32_bf16 v[100:103], a[20:23], v[36:39], v[100:103]
    v_mfma_f32_16x16x32_bf16 v[104:107], a[24:27], v[36:39], v[104:107]
    v_mfma_f32_16x16x32_bf16 v[108:111], a[28:31], v[36:39], v[108:111]
    ds_read_b128 v[56:59], v11 offset:384
    s_waitcnt lgkmcnt(4)
    v_mfma_f32_16x16x32_bf16 v[96:99], a[32:35], v[40:43], v[96:99]
    v_mfma_f32_16x16x32_bf16 v[100:103], a[36:39], v[40:43], v[100:103]
    v_mfma_f32_16x16x32_bf16 v[104:107], a[40:43], v[40:43], v[104:107]
    v_mfma_f32_16x16x32_bf16 v[108:111], a[44:47], v[40:43], v[108:111]
    ds_read_b128 v[60:63], v11 offset:448
    s_waitcnt lgkmcnt(4)
    v_mfma_f32_16x16x32_bf16 v[96:99], a[48:51], v[44:47], v[96:99]
    v_mfma_f32_16x16x32_bf16 v[100:103], a[52:55], v[44:47], v[100:103]
    v_mfma_f32_16x16x32_bf16 v[104:107], a[56:59], v[44:47], v[104:107]
    v_mfma_f32_16x16x32_bf16 v[108:111], a[60:63], v[44:47], v[108:111]
    ds_read_b128 v[64:67], v11 offset:512
    s_waitcnt lgkmcnt(4)
    v_mfma_f32_16x16x32_bf16 v[96:99], a[64:67], v[48:51], v[96:99]
    v_mfma_f32_16x16x32_bf16 v[100:103], a[68:71], v[48:51], v[100:103]
    v_mfma_f32_16x16x32_bf16 v[104:107], a[72:75], v[48:51], v[104:107]
    v_mfma_f32_16x16x32_bf16 v[108:111], a[76:79], v[48:51], v[108:111]
    ds_read_b128 v[68:71], v11 offset:576
    s_waitcnt lgkmcnt(4)
    v_mfma_f32_16x16x32_bf16 v[96:99], a[80:83], v[52:55], v[96:99]
    v_mfma_f32_16x16x32_bf16 v[100:103], a[84:87], v[52:55], v[100:103]
    v_mfma_f32_16x16x32_bf16 v[104:107], a[88:91], v[52:55], v[104:107]
    v_mfma_f32_16x16x32_bf16 v[108:111], a[92:95], v[52:55], v[108:111]
    ds_read_b128 v[72:75], v11 offset:640
    s_waitcnt lgkmcnt(4)
    v_mfma_f32_16x16x32_bf16 v[96:99], a[96:99], v[56:59], v[96:99]
    v_mfma_f32_16x16x32_bf16 v[100:103], a[100:103], v[56:59], v[100:103]
    v_mfma_f32_16x16x32_bf16 v[104:107], a[104:107], v[56:59], v[104:107]
    v_mfma_f32_16x16x32_bf16 v[108:111], a[108:111], v[56:59], v[108:111]
    ds_read_b128 v[76:79], v11 offset:704
    s_waitcnt lgkmcnt(4)
    v_mfma_f32_16x16x32_bf16 v[96:99], a[112:115], v[60:63], v[96:99]
    v_mfma_f32_16x16x32_bf16 v[100:103], a[116:119], v[60:63], v[100:103]
    v_mfma_f32_16x16x32_bf16 v[104:107], a[120:123], v[60:63], v[104:107]
    v_mfma_f32_16x16x32_bf16 v[108:111], a[124:127], v[60:63], v[108:111]
    ds_read_b128 v[80:83], v11 offset:768
    s_waitcnt lgkmcnt(4)
    v_mfma_f32_16x16x32_bf16 v[96:99], a[128:131], v[64:67], v[96:99]
    v_mfma_f32_16x16x32_bf16 v[100:103], a[132:135], v[64:67], v[100:103]
    v_mfma_f32_16x16x32_bf16 v[104:107], a[136:139], v[64:67], v[104:107]
    v_mfma_f32_16x16x32_bf16 v[108:111], a[140:143], v[64:67], v[108:111]
    ds_read_b128 v[84:87], v11 offset:832
    s_waitcnt lgkmcnt(4)
    v_mfma_f32_16x16x32_bf16 v[96:99], a[144:147], v[68:71], v[96:99]
    v_mfma_f32_16x16x32_bf16 v[100:103], a[148:151], v[68:71], v[100:103]
    v_mfma_f32_16x16x32_bf16 v[104:107], a[152:155], v[68:71], v[104:107]
    v_mfma_f32_16x16x32_bf16 v[108:111], a[156:159], v[68:71], v[108:111]
    ds_read_b128 v[88:91], v11 offset:896
    s_waitcnt lgkmcnt(4)
    v_mfma_f32_16x16x32_bf16 v[96:99], a[160:163], v[72:75], v[96:99]
    v_mfma_f32_16x16x32_bf16 v[100:103], a[164:167], v[72:75], v[100:103]
    v_mfma_f32_16x16x32_bf16 v[104:107], a[168:171], v[72:75], v[104:107]
    v_mfma_f32_16x16x32_bf16 v[108:111], a[172:175], v[72:75], v[108:111]
    ds_read_b128 v[92:95], v11 offset:960
    s_waitcnt lgkmcnt(4)
    v_mfma_f32_16x16x32_bf16 v[96:99], a[176:179], v[76:79], v[96:99]
    v_mfma_f32_16x16x32_bf16 v[100:103], a[180:183], v[76:79], v[100:103]
    v_mfma_f32_16x16x32_bf16 v[104:107], a[184:187], v[76:79], v[104:107]
    v_mfma_f32_16x16x32_bf16 v[108:111], a[188:191], v[76:79], v[108:111]
    s_waitcnt lgkmcnt(3)
    v_mfma_f32_16x16x32_bf16 v[96:99], a[192:195], v[80:83], v[96:99]
    v_mfma_f32_16x16x32_bf16 v[100:103], a[196:199], v[80:83], v[100:103]
    v_mfma_f32_16x16x32_bf16 v[104:107], a[200:203], v[80:83], v[104:107]
    v_mfma_f32_16x16x32_bf16 v[108:111], a[204:207], v[80:83], v[108:111]
    s_waitcnt lgkmcnt(2)
    v_mfma_f32_16x16x32_bf16 v[96:99], a[208:211], v[84:87], v[96:99]
    v_mfma_f32_16x16x32_bf16 v[100:103], a[212:215], v[84:87], v[100:103]
    v_mfma_f32_16x16x32_bf16 v[104:107], a[216:219], v[84:87], v[104:107]
    v_mfma_f32_16x16x32_bf16 v[108:111], a[220:223], v[84:87], v[108:111]
    s_waitcnt lgkmcnt(1)
    v_mfma_f32_16x16x32_bf16 v[96:99], a[224:227], v[88:91], v[96:99]
    v_mfma_f32_16x16x32_bf16 v[100:103], a[228:231], v[88:91], v[100:103]
    v_mfma_f32_16x16x32_bf16 v[104:107], a[232:235], v[88:91], v[104:107]
    v_mfma_f32_16x16x32_bf16 v[108:111], a[236:239], v[88:91], v[108:111]
    s_waitcnt lgkmcnt(0)
    v_mfma_f32_16x16x32_bf16 v[96:99], a[240:243], v[92:95], v[96:99]
    v_mfma_f32_16x16x32_bf16 v[100:103], a[244:247], v[92:95], v[100:103]
    v_mfma_f32_16x16x32_bf16 v[104:107], a[248:251], v[92:95], v[104:107]
    v_mfma_f32_16x16x32_bf16 v[108:111], a[252:255], v[92:95], v[108:111]
    s_nop 4
    v_cvt_pk_bf16_f32 v40, v96, v97
    v_cvt_pk_bf16_f32 v41, v98, v99
    v_cvt_pk_bf16_f32 v42, v100, v101
    v_cvt_pk_bf16_f32 v43, v102, v103
    v_lshlrev_b32 v96, 16, v40
    v_and_b32 v97, 0xffff0000, v40
    v_lshlrev_b32 v98, 16, v41
    v_and_b32 v99, 0xffff0000, v41
    v_lshlrev_b32 v100, 16, v42
    v_and_b32 v101, 0xffff0000, v42
    v_lshlrev_b32 v102, 16, v43
    v_and_b32 v103, 0xffff0000, v43
    v_pk_mul_f32 v[32:33], v[96:97], s[70:71]
    v_pk_mul_f32 v[34:35], v[98:99], s[70:71]
    v_pk_mul_f32 v[36:37], v[100:101], s[70:71]
    v_pk_mul_f32 v[38:39], v[102:103], s[70:71]
    v_exp_f32 v32, v32
    v_exp_f32 v33, v33
    v_exp_f32 v34, v34
    v_exp_f32 v35, v35
    v_exp_f32 v36, v36
    v_exp_f32 v37, v37
    v_exp_f32 v38, v38
    v_exp_f32 v39, v39
    v_cvt_pk_bf16_f32 v40, v104, v105
    v_cvt_pk_bf16_f32 v41, v106, v107
    v_cvt_pk_bf16_f32 v42, v108, v109
    v_cvt_pk_bf16_f32 v43, v110, v111
    v_pk_add_f32 v[32:33], v[32:33], 1.0 op_sel_hi:[1,0]
    v_pk_add_f32 v[34:35], v[34:35], 1.0 op_sel_hi:[1,0]
    v_pk_add_f32 v[36:37], v[36:37], 1.0 op_sel_hi:[1,0]
    v_pk_add_f32 v[38:39], v[38:39], 1.0 op_sel_hi:[1,0]
    v_rcp_f32 v32, v32
    v_rcp_f32 v33, v33
    v_rcp_f32 v34, v34
    v_rcp_f32 v35, v35
    v_rcp_f32 v36, v36
    v_rcp_f32 v37, v37
    v_rcp_f32 v38, v38
    v_rcp_f32 v39, v39
    v_lshlrev_b32 v104, 16, v40
    v_and_b32 v105, 0xffff0000, v40
    v_lshlrev_b32 v106, 16, v41
    v_and_b32 v107, 0xffff0000, v41
    v_lshlrev_b32 v108, 16, v42
    v_and_b32 v109, 0xffff0000, v42
    v_lshlrev_b32 v110, 16, v43
    v_and_b32 v111, 0xffff0000, v43
    v_pk_mul_f32 v[32:33], v[32:33], v[96:97]
    v_pk_mul_f32 v[34:35], v[34:35], v[98:99]
    v_pk_mul_f32 v[36:37], v[36:37], v[100:101]
    v_pk_mul_f32 v[38:39], v[38:39], v[102:103]
    v_cvt_pk_bf16_f32 v40, v32, v33
    v_cvt_pk_bf16_f32 v41, v34, v35
    v_cvt_pk_bf16_f32 v42, v36, v37
    v_cvt_pk_bf16_f32 v43, v38, v39
    v_lshlrev_b32 v32, 16, v40
    v_and_b32 v33, 0xffff0000, v40
    v_lshlrev_b32 v34, 16, v41
    v_and_b32 v35, 0xffff0000, v41
    v_lshlrev_b32 v36, 16, v42
    v_and_b32 v37, 0xffff0000, v42
    v_lshlrev_b32 v38, 16, v43
    v_and_b32 v39, 0xffff0000, v43
    v_pk_mul_f32 v[32:33], v[32:33], v[104:105]
    v_pk_mul_f32 v[34:35], v[34:35], v[106:107]
    v_pk_mul_f32 v[36:37], v[36:37], v[108:109]
    v_pk_mul_f32 v[38:39], v[38:39], v[110:111]
    v_cvt_pk_bf16_f32 v40, v32, v36
    v_cvt_pk_bf16_f32 v41, v33, v37
    v_cvt_pk_bf16_f32 v42, v34, v38
    v_cvt_pk_bf16_f32 v43, v35, v39
    ds_write_b128 v10, v[40:43]
    s_waitcnt lgkmcnt(0)
    s_barrier
    ds_read_b128 v[32:35], v4 offset:0
    ds_read_b128 v[36:39], v4 offset:1024
    ds_read_b128 v[40:43], v4 offset:2048
    ds_read_b128 v[44:47], v4 offset:3072
    s_waitcnt lgkmcnt(3)
    v_mfma_f32_16x16x32_bf16 v[64:67], v[32:35], v[192:195], 0
    v_mfma_f32_16x16x32_bf16 v[68:71], v[32:35], v[196:199], 0
    v_mfma_f32_16x16x32_bf16 v[72:75], v[32:35], v[200:203], 0
    v_mfma_f32_16x16x32_bf16 v[76:79], v[32:35], v[204:207], 0
    v_mfma_f32_16x16x32_bf16 v[80:83], v[32:35], v[208:211], 0
    v_mfma_f32_16x16x32_bf16 v[84:87], v[32:35], v[212:215], 0
    v_mfma_f32_16x16x32_bf16 v[88:91], v[32:35], v[216:219], 0
    v_mfma_f32_16x16x32_bf16 v[92:95], v[32:35], v[220:223], 0
    s_waitcnt lgkmcnt(2)
    v_mfma_f32_16x16x32_bf16 v[64:67], v[36:39], v[224:227], v[64:67]
    v_mfma_f32_16x16x32_bf16 v[68:71], v[36:39], v[228:231], v[68:71]
    v_mfma_f32_16x16x32_bf16 v[72:75], v[36:39], v[232:235], v[72:75]
    v_mfma_f32_16x16x32_bf16 v[76:79], v[36:39], v[236:239], v[76:79]
    v_mfma_f32_16x16x32_bf16 v[80:83], v[36:39], v[240:243], v[80:83]
    v_mfma_f32_16x16x32_bf16 v[84:87], v[36:39], v[244:247], v[84:87]
    v_mfma_f32_16x16x32_bf16 v[88:91], v[36:39], v[248:251], v[88:91]
    v_mfma_f32_16x16x32_bf16 v[92:95], v[36:39], v[252:255], v[92:95]
    s_waitcnt lgkmcnt(0)
    v_mfma_f32_16x16x32_bf16 v[96:99], v[40:43], v[192:195], 0
    v_mfma_f32_16x16x32_bf16 v[100:103], v[40:43], v[196:199], 0
    v_mfma_f32_16x16x32_bf16 v[104:107], v[40:43], v[200:203], 0
    v_mfma_f32_16x16x32_bf16 v[108:111], v[40:43], v[204:207], 0
    v_mfma_f32_16x16x32_bf16 v[112:115], v[40:43], v[208:211], 0
    v_cvt_pk_bf16_f32 v48, v64, v68
    v_cvt_pk_bf16_f32 v49, v72, v76
    v_mfma_f32_16x16x32_bf16 v[116:119], v[40:43], v[212:215], 0
    v_cvt_pk_bf16_f32 v50, v80, v84
    v_cvt_pk_bf16_f32 v51, v88, v92
    v_mfma_f32_16x16x32_bf16 v[120:123], v[40:43], v[216:219], 0
    v_and_or_b32 v48, v48, -2, s13
    s_add_u32 s9, s74, 0
    buffer_store_dwordx4 v[48:51], v6, s[60:63], s9 offen
    v_mfma_f32_16x16x32_bf16 v[124:127], v[40:43], v[220:223], 0
    v_cvt_pk_bf16_f32 v52, v65, v69
    v_cvt_pk_bf16_f32 v53, v73, v77
    v_mfma_f32_16x16x32_bf16 v[96:99], v[44:47], v[224:227], v[96:99]
    v_cvt_pk_bf16_f32 v54, v81, v85
    v_cvt_pk_bf16_f32 v55, v89, v93
    v_mfma_f32_16x16x32_bf16 v[100:103], v[44:47], v[228:231], v[100:103]
    v_and_or_b32 v52, v52, -2, s13
    s_add_u32 s9, s74, 33024
    buffer_store_dwordx4 v[52:55], v6, s[60:63], s9 offen
    v_mfma_f32_16x16x32_bf16 v[104:107], v[44:47], v[232:235], v[104:107]
    v_cvt_pk_bf16_f32 v56, v66, v70
    v_cvt_pk_bf16_f32 v57, v74, v78
    v_mfma_f32_16x16x32_bf16 v[108:111], v[44:47], v[236:239], v[108:111]
    v_cvt_pk_bf16_f32 v58, v82, v86
    v_cvt_pk_bf16_f32 v59, v90, v94
    v_mfma_f32_16x16x32_bf16 v[112:115], v[44:47], v[240:243], v[112:115]
    v_and_or_b32 v56, v56, -2, s13
    s_add_u32 s9, s74, 66048
    buffer_store_dwordx4 v[56:59], v6, s[60:63], s9 offen
    v_mfma_f32_16x16x32_bf16 v[116:119], v[44:47], v[244:247], v[116:119]
    v_cvt_pk_bf16_f32 v60, v67, v71
    v_cvt_pk_bf16_f32 v61, v75, v79
    v_mfma_f32_16x16x32_bf16 v[120:123], v[44:47], v[248:251], v[120:123]
    v_cvt_pk_bf16_f32 v62, v83, v87
    v_cvt_pk_bf16_f32 v63, v91, v95
    v_mfma_f32_16x16x32_bf16 v[124:127], v[44:47], v[252:255], v[124:127]
    v_and_or_b32 v60, v60, -2, s13
    s_add_u32 s9, s74, 99072
    buffer_store_dwordx4 v[60:63], v6, s[60:63], s9 offen
    v_cvt_pk_bf16_f32 v48, v96, v100
    v_cvt_pk_bf16_f32 v49, v104, v108
    v_cvt_pk_bf16_f32 v50, v112, v116
    s_nop 1
    v_cvt_pk_bf16_f32 v51, v120, v124
    v_and_or_b32 v48, v48, -2, s13
    s_add_u32 s9, s74, 528384
    buffer_store_dwordx4 v[48:51], v6, s[60:63], s9 offen
    v_cvt_pk_bf16_f32 v52, v97, v101
    v_cvt_pk_bf16_f32 v53, v105, v109
    v_cvt_pk_bf16_f32 v54, v113, v117
    v_cvt_pk_bf16_f32 v55, v121, v125
    v_and_or_b32 v52, v52, -2, s13
    s_add_u32 s9, s74, 561408
    buffer_store_dwordx4 v[52:55], v6, s[60:63], s9 offen
    v_cvt_pk_bf16_f32 v56, v98, v102
    v_cvt_pk_bf16_f32 v57, v106, v110
    v_cvt_pk_bf16_f32 v58, v114, v118
    v_cvt_pk_bf16_f32 v59, v122, v126
    v_and_or_b32 v56, v56, -2, s13
    s_add_u32 s9, s74, 594432
    buffer_store_dwordx4 v[56:59], v6, s[60:63], s9 offen
    v_cvt_pk_bf16_f32 v60, v99, v103
    v_cvt_pk_bf16_f32 v61, v107, v111
    v_cvt_pk_bf16_f32 v62, v115, v119
    v_cvt_pk_bf16_f32 v63, v123, v127
    v_and_or_b32 v60, v60, -2, s13
    s_add_u32 s9, s74, 627456
    buffer_store_dwordx4 v[60:63], v6, s[60:63], s9 offen
    s_branch L_FF_flag2_near
L_FF_flag_near:
ro_86:
    buffer_load_dwordx2 v[30:31], v8, s[60:63], s73 offen sc1
    s_waitcnt vmcnt(0)
    v_max_u32 v28, v30, v31
    v_cmp_eq_u32 vcc, -1, v28
    s_cbranch_vccz rod_87
    s_sleep 4
    s_sub_u32 s8, s8, 1
    s_cbranch_scc0 ro_86
    s_mov_b32 s8, 0
rod_87:
    s_cmp_le_u32 s69, 2
    s_cbranch_scc1 L_FF_flag2_near
ro_88:
    buffer_load_dword v28, v7, s[60:63], s74 offen sc1
    s_waitcnt vmcnt(0)
    v_bitop3_b32 v28, v28, s13, 1 bitop3:0x28
    v_cmp_ne_u32 vcc, 0, v28
    s_cbranch_vccz rod_89
    s_sleep 1
    s_sub_u32 s8, s8, 1
    s_cbranch_scc0 ro_88
    s_mov_b32 s8, 0
rod_89:
L_FF_flag2_near:
    s_cmp_gt_u32 s69, 2
    s_cbranch_scc1 fft_90
    s_waitcnt vmcnt(0)
    s_lshl_b32 s10, s69, 1
    s_sub_u32 s10, s10, 1
    v_mov_b32 v28, s10
    s_mov_b64 exec, 1
    buffer_store_dword v28, off, s[60:63], s65
    s_mov_b64 exec, -1
wf_91:
    buffer_load_dwordx2 v[28:29], v9, s[60:63], 0 offen sc1
    s_waitcnt vmcnt(0)
    v_min_u32 v28, v28, v29
    v_cmp_gt_u32 vcc, s10, v28
    s_cbranch_vccz wfd_92
    s_sub_u32 s8, s8, 1
    s_cbranch_scc0 wf_91
    s_mov_b32 s8, 0
wfd_92:
fft_90:
    s_waitcnt vmcnt(0)
rs_93:
    s_add_u32 s9, s74, 0
    buffer_load_dwordx4 v[32:35], v7, s[60:63], s9 offen sc1
    s_add_u32 s9, s74, 4096
    buffer_load_dwordx4 v[36:39], v7, s[60:63], s9 offen sc1
    s_add_u32 s9, s74, 8192
    buffer_load_dwordx4 v[40:43], v7, s[60:63], s9 offen sc1
    s_add_u32 s9, s74, 12288
    buffer_load_dwordx4 v[44:47], v7, s[60:63], s9 offen sc1
    s_add_u32 s9, s74, 16384
    buffer_load_dwordx4 v[48:51], v7, s[60:63], s9 offen sc1
    s_add_u32 s9, s74, 20480
    buffer_load_dwordx4 v[52:55], v12, s[60:63], s9 offen sc1
    s_mov_b64 exec, -1
    s_waitcnt vmcnt(5)
    v_mfma_f32_16x16x32_bf16 v[64:67], v[24:27], v[32:35], 0
    v_xor_b32 v28, s13, v32
    s_waitcnt vmcnt(4)
    v_mfma_f32_16x16x32_bf16 v[64:67], v[24:27], v[36:39], v[64:67]
    v_bitop3_b32 v28, v28, v36, s13 bitop3:0xf6
    s_waitcnt vmcnt(3)
    v_mfma_f32_16x16x32_bf16 v[64:67], v[24:27], v[40:43], v[64:67]
    v_bitop3_b32 v28, v28, v40, s13 bitop3:0xf6
    s_waitcnt vmcnt(2)
    v_mfma_f32_16x16x32_bf16 v[64:67], v[24:27], v[44:47], v[64:67]
    v_bitop3_b32 v28, v28, v44, s13 bitop3:0xf6
    s_waitcnt vmcnt(1)
    v_mfma_f32_16x16x32_bf16 v[64:67], v[24:27], v[48:51], v[64:67]
    v_bitop3_b32 v28, v28, v48, s13 bitop3:0xf6
    s_waitcnt vmcnt(0)
    v_mfma_f32_16x16x32_bf16 v[64:67], v[24:27], v[52:55], v[64:67]
    v_cndmask_b32 v29, v15, v52, s[66:67]
    v_bitop3_b32 v28, v28, v29, s13 bitop3:0xf6
    v_and_b32 v28, 1, v28
    v_cmp_ne_u32 vcc, 0, v28
    s_cbranch_vccz rsd_94
    s_mov_b64 exec, vcc
    s_sub_u32 s8, s8, 1
    s_cbranch_scc0 rs_93
    s_mov_b32 s8, 0
    s_mov_b64 exec, -1
rsd_94:
    s_lshl_b32 s10, s69, 1
    v_mov_b32 v28, s10
    s_mov_b64 exec, 1
    buffer_store_dword v28, off, s[60:63], s65
    s_mov_b64 exec, -1
hh_95:
    v_max_u32 v28, v30, v31
    v_cmp_eq_u32 vcc, -1, v28
    s_cbranch_vccz hhd_96
    buffer_load_dwordx2 v[30:31], v8, s[60:63], s73 offen sc1
    s_waitcnt vmcnt(0)
    s_sub_u32 s8, s8, 1
    s_cbranch_scc0 hh_95
    s_mov_b32 s8, 0
hhd_96:
    v_lshlrev_b32 v72, 16, v30
    v_and_b32 v73, 0xffff0000, v30
    v_lshlrev_b32 v74, 16, v31
    v_and_b32 v75, 0xffff0000, v31
    v_cvt_pk_bf16_f32 v68, v64, v65
    v_cvt_pk_bf16_f32 v69, v66, v67
    v_lshlrev_b32 v64, 16, v68
    v_and_b32 v65, 0xffff0000, v68
    v_lshlrev_b32 v66, 16, v69
    v_and_b32 v67, 0xffff0000, v69
    v_pk_add_f32 v[64:65], v[64:65], v[72:73]
    v_pk_add_f32 v[66:67], v[66:67], v[74:75]
    v_cvt_pk_bf16_f32 v68, v64, v65
    v_cvt_pk_bf16_f32 v69, v66, v67
    v_mov_b32 v70, v68
    v_mov_b32 v71, v69
    s_nop 0
    v_permlane16_swap_b32 v68, v70
    v_permlane16_swap_b32 v69, v71
    s_mov_b64 exec, 0xffff
    buffer_store_dwordx4 v[68:71], v8, s[52:55], s75 offen
    s_mov_b64 exec, -1
    s_cmp_lt_u32 s68, 56
    s_cbranch_scc1 fw_97
    s_cmp_ge_u32 s68, 62
    s_cbranch_scc1 fw_97
fw_97:
    s_cmp_ge_u32 s68, 52
    s_cselect_b32 s9, 4, 2
    s_add_u32 s68, s68, s9
    s_cmp_lt_u32 s68, 64
    s_cbranch_scc1 L_FF_near
    s_endpgm
L_FF_far:
    s_and_b32 s74, s69, 1
    s_lshl_b32 s9, s64, 1
    s_add_u32 s74, s74, s9
    s_mul_i32 s74, s74, 1310720
    s_add_u32 s74, s74, 125829120
    s_bfe_u32 s13, s69, 0x10001
    v_mov_b32 v15, s13
    s_lshl_b32 s9, s69, 1
    s_sub_u32 s9, s9, 2
    s_max_i32 s9, s9, 0
wf_98:
    buffer_load_dwordx2 v[28:29], v9, s[60:63], 0 offen sc1
    s_waitcnt vmcnt(0)
    v_min_u32 v28, v28, v29
    v_cmp_gt_u32 vcc, s9, v28
    s_cbranch_vccz wfd_99
    s_sleep 1
    s_sub_u32 s8, s8, 1
    s_cbranch_scc0 wf_98
    s_mov_b32 s8, 0
wfd_99:
    s_add_u32 s69, s69, 1
    s_lshl_b32 s75, s68, 5
    s_add_u32 s75, s75, s5
    s_lshl_b32 s75, s75, 10
    s_add_u32 s73, s75, 4194304
    s_cmp_ge_u32 s5, 22
    s_cbranch_scc1 L_FF_flag_far
    s_lshl_b32 s72, s68, 15
    s_lshl_b32 s9, s3, 13
    s_add_u32 s72, s72, s9
    s_add_u32 s72, s72, 54525952
    s_add_u32 s15, s72, 4096
hp_100:
    buffer_load_dword v28, v13, s[60:63], s72 offen sc1
    s_waitcnt vmcnt(0)
    v_cmp_eq_u32 vcc, -1, v28
    s_cbranch_vccz hpd_101
    s_sleep 1
    s_sub_u32 s8, s8, 1
    s_cbranch_scc0 hp_100
    s_mov_b32 s8, 0
hpd_101:
    buffer_load_dwordx4 v[32:35], v4, s[60:63], s72 offen offset:0 sc1
    buffer_load_dwordx4 v[36:39], v4, s[60:63], s72 offen offset:1024 sc1
    buffer_load_dwordx4 v[40:43], v4, s[60:63], s72 offen offset:2048 sc1
    buffer_load_dwordx4 v[44:47], v4, s[60:63], s72 offen offset:3072 sc1
    buffer_load_dwordx4 v[48:51], v4, s[60:63], s15 offen offset:0 sc1
    buffer_load_dwordx4 v[52:55], v4, s[60:63], s15 offen offset:1024 sc1
    buffer_load_dwordx4 v[56:59], v4, s[60:63], s15 offen offset:2048 sc1
    buffer_load_dwordx4 v[60:63], v4, s[60:63], s15 offen offset:3072 sc1
    v_mov_b32 v28, 0
    s_waitcnt vmcnt(7)
    ds_write_b128 v14, v[32:35] offset:0
    v_max3_u32 v28, v28, v32, v33
    v_max3_u32 v28, v28, v34, v35
    s_waitcnt vmcnt(6)
    ds_write_b128 v14, v[36:39] offset:1040
    v_max3_u32 v28, v28, v36, v37
    v_max3_u32 v28, v28, v38, v39
    s_waitcnt vmcnt(5)
    ds_write_b128 v14, v[40:43] offset:2080
    v_max3_u32 v28, v28, v40, v41
    v_max3_u32 v28, v28, v42, v43
    s_waitcnt vmcnt(4)
    ds_write_b128 v14, v[44:47] offset:3120
    v_max3_u32 v28, v28, v44, v45
    v_max3_u32 v28, v28, v46, v47
    s_waitcnt vmcnt(3)
    ds_write_b128 v14, v[48:51] offset:4160
    v_max3_u32 v28, v28, v48, v49
    v_max3_u32 v28, v28, v50, v51
    s_waitcnt vmcnt(2)
    ds_write_b128 v14, v[52:55] offset:5200
    v_max3_u32 v28, v28, v52, v53
    v_max3_u32 v28, v28, v54, v55
    s_waitcnt vmcnt(1)
    ds_write_b128 v14, v[56:59] offset:6240
    v_max3_u32 v28, v28, v56, v57
    v_max3_u32 v28, v28, v58, v59
    s_waitcnt vmcnt(0)
    ds_write_b128 v14, v[60:63] offset:7280
    v_max3_u32 v28, v28, v60, v61
    v_max3_u32 v28, v28, v62, v63
    v_cmp_eq_u32 vcc, -1, v28
    s_cbranch_vccz hv_102
    s_sub_u32 s8, s8, 1
    s_cbranch_scc0 hpd_101
    s_mov_b32 s8, 0
hv_102:
    buffer_load_dwordx2 v[30:31], v8, s[60:63], s73 offen sc1
    s_waitcnt lgkmcnt(0)
    s_barrier
    ds_read_b128 v[32:35], v11 offset:0
    ds_read_b128 v[36:39], v11 offset:64
    ds_read_b128 v[40:43], v11 offset:128
    ds_read_b128 v[44:47], v11 offset:192
    ds_read_b128 v[48:51], v11 offset:256
    s_waitcnt lgkmcnt(4)
    v_mfma_f32_16x16x32_bf16 v[96:99], a[0:3], v[32:35], 0
    v_mfma_f32_16x16x32_bf16 v[100:103], a[4:7], v[32:35], 0
    v_mfma_f32_16x16x32_bf16 v[104:107], a[8:11], v[32:35], 0
    v_mfma_f32_16x16x32_bf16 v[108:111], a[12:15], v[32:35], 0
    ds_read_b128 v[52:55], v11 offset:320
    s_waitcnt lgkmcnt(4)
    v_mfma_f32_16x16x32_bf16 v[96:99], a[16:19], v[36:39], v[96:99]
    v_mfma_f32_16x16x32_bf16 v[100:103], a[20:23], v[36:39], v[100:103]
    v_mfma_f32_16x16x32_bf16 v[104:107], a[24:27], v[36:39], v[104:107]
    v_mfma_f32_16x16x32_bf16 v[108:111], a[28:31], v[36:39], v[108:111]
    ds_read_b128 v[56:59], v11 offset:384
    s_waitcnt lgkmcnt(4)
    v_mfma_f32_16x16x32_bf16 v[96:99], a[32:35], v[40:43], v[96:99]
    v_mfma_f32_16x16x32_bf16 v[100:103], a[36:39], v[40:43], v[100:103]
    v_mfma_f32_16x16x32_bf16 v[104:107], a[40:43], v[40:43], v[104:107]
    v_mfma_f32_16x16x32_bf16 v[108:111], a[44:47], v[40:43], v[108:111]
    ds_read_b128 v[60:63], v11 offset:448
    s_waitcnt lgkmcnt(4)
    v_mfma_f32_16x16x32_bf16 v[96:99], a[48:51], v[44:47], v[96:99]
    v_mfma_f32_16x16x32_bf16 v[100:103], a[52:55], v[44:47], v[100:103]
    v_mfma_f32_16x16x32_bf16 v[104:107], a[56:59], v[44:47], v[104:107]
    v_mfma_f32_16x16x32_bf16 v[108:111], a[60:63], v[44:47], v[108:111]
    ds_read_b128 v[64:67], v11 offset:512
    s_waitcnt lgkmcnt(4)
    v_mfma_f32_16x16x32_bf16 v[96:99], a[64:67], v[48:51], v[96:99]
    v_mfma_f32_16x16x32_bf16 v[100:103], a[68:71], v[48:51], v[100:103]
    v_mfma_f32_16x16x32_bf16 v[104:107], a[72:75], v[48:51], v[104:107]
    v_mfma_f32_16x16x32_bf16 v[108:111], a[76:79], v[48:51], v[108:111]
    ds_read_b128 v[68:71], v11 offset:576
    s_waitcnt lgkmcnt(4)
    v_mfma_f32_16x16x32_bf16 v[96:99], a[80:83], v[52:55], v[96:99]
    v_mfma_f32_16x16x32_bf16 v[100:103], a[84:87], v[52:55], v[100:103]
    v_mfma_f32_16x16x32_bf16 v[104:107], a[88:91], v[52:55], v[104:107]
    v_mfma_f32_16x16x32_bf16 v[108:111], a[92:95], v[52:55], v[108:111]
    ds_read_b128 v[72:75], v11 offset:640
    s_waitcnt lgkmcnt(4)
    v_mfma_f32_16x16x32_bf16 v[96:99], a[96:99], v[56:59], v[96:99]
    v_mfma_f32_16x16x32_bf16 v[100:103], a[100:103], v[56:59], v[100:103]
    v_mfma_f32_16x16x32_bf16 v[104:107], a[104:107], v[56:59], v[104:107]
    v_mfma_f32_16x16x32_bf16 v[108:111], a[108:111], v[56:59], v[108:111]
    ds_read_b128 v[76:79], v11 offset:704
    s_waitcnt lgkmcnt(4)
    v_mfma_f32_16x16x32_bf16 v[96:99], a[112:115], v[60:63], v[96:99]
    v_mfma_f32_16x16x32_bf16 v[100:103], a[116:119], v[60:63], v[100:103]
    v_mfma_f32_16x16x32_bf16 v[104:107], a[120:123], v[60:63], v[104:107]
    v_mfma_f32_16x16x32_bf16 v[108:111], a[124:127], v[60:63], v[108:111]
    ds_read_b128 v[80:83], v11 offset:768
    s_waitcnt lgkmcnt(4)
    v_mfma_f32_16x16x32_bf16 v[96:99], a[128:131], v[64:67], v[96:99]
    v_mfma_f32_16x16x32_bf16 v[100:103], a[132:135], v[64:67], v[100:103]
    v_mfma_f32_16x16x32_bf16 v[104:107], a[136:139], v[64:67], v[104:107]
    v_mfma_f32_16x16x32_bf16 v[108:111], a[140:143], v[64:67], v[108:111]
    ds_read_b128 v[84:87], v11 offset:832
    s_waitcnt lgkmcnt(4)
    v_mfma_f32_16x16x32_bf16 v[96:99], a[144:147], v[68:71], v[96:99]
    v_mfma_f32_16x16x32_bf16 v[100:103], a[148:151], v[68:71], v[100:103]
    v_mfma_f32_16x16x32_bf16 v[104:107], a[152:155], v[68:71], v[104:107]
    v_mfma_f32_16x16x32_bf16 v[108:111], a[156:159], v[68:71], v[108:111]
    ds_read_b128 v[88:91], v11 offset:896
    s_waitcnt lgkmcnt(4)
    v_mfma_f32_16x16x32_bf16 v[96:99], a[160:163], v[72:75], v[96:99]
    v_mfma_f32_16x16x32_bf16 v[100:103], a[164:167], v[72:75], v[100:103]
    v_mfma_f32_16x16x32_bf16 v[104:107], a[168:171], v[72:75], v[104:107]
    v_mfma_f32_16x16x32_bf16 v[108:111], a[172:175], v[72:75], v[108:111]
    ds_read_b128 v[92:95], v11 offset:960
    s_waitcnt lgkmcnt(4)
    v_mfma_f32_16x16x32_bf16 v[96:99], a[176:179], v[76:79], v[96:99]
    v_mfma_f32_16x16x32_bf16 v[100:103], a[180:183], v[76:79], v[100:103]
    v_mfma_f32_16x16x32_bf16 v[104:107], a[184:187], v[76:79], v[104:107]
    v_mfma_f32_16x16x32_bf16 v[108:111], a[188:191], v[76:79], v[108:111]
    s_waitcnt lgkmcnt(3)
    v_mfma_f32_16x16x32_bf16 v[96:99], a[192:195], v[80:83], v[96:99]
    v_mfma_f32_16x16x32_bf16 v[100:103], a[196:199], v[80:83], v[100:103]
    v_mfma_f32_16x16x32_bf16 v[104:107], a[200:203], v[80:83], v[104:107]
    v_mfma_f32_16x16x32_bf16 v[108:111], a[204:207], v[80:83], v[108:111]
    s_waitcnt lgkmcnt(2)
    v_mfma_f32_16x16x32_bf16 v[96:99], a[208:211], v[84:87], v[96:99]
    v_mfma_f32_16x16x32_bf16 v[100:103], a[212:215], v[84:87], v[100:103]
    v_mfma_f32_16x16x32_bf16 v[104:107], a[216:219], v[84:87], v[104:107]
    v_mfma_f32_16x16x32_bf16 v[108:111], a[220:223], v[84:87], v[108:111]
    s_waitcnt lgkmcnt(1)
    v_mfma_f32_16x16x32_bf16 v[96:99], a[224:227], v[88:91], v[96:99]
    v_mfma_f32_16x16x32_bf16 v[100:103], a[228:231], v[88:91], v[100:103]
    v_mfma_f32_16x16x32_bf16 v[104:107], a[232:235], v[88:91], v[104:107]
    v_mfma_f32_16x16x32_bf16 v[108:111], a[236:239], v[88:91], v[108:111]
    s_waitcnt lgkmcnt(0)
    v_mfma_f32_16x16x32_bf16 v[96:99], a[240:243], v[92:95], v[96:99]
    v_mfma_f32_16x16x32_bf16 v[100:103], a[244:247], v[92:95], v[100:103]
    v_mfma_f32_16x16x32_bf16 v[104:107], a[248:251], v[92:95], v[104:107]
    v_mfma_f32_16x16x32_bf16 v[108:111], a[252:255], v[92:95], v[108:111]
    s_nop 4
    v_cvt_pk_bf16_f32 v40, v96, v97
    v_cvt_pk_bf16_f32 v41, v98, v99
    v_cvt_pk_bf16_f32 v42, v100, v101
    v_cvt_pk_bf16_f32 v43, v102, v103
    v_lshlrev_b32 v96, 16, v40
    v_and_b32 v97, 0xffff0000, v40
    v_lshlrev_b32 v98, 16, v41
    v_and_b32 v99, 0xffff0000, v41
    v_lshlrev_b32 v100, 16, v42
    v_and_b32 v101, 0xffff0000, v42
    v_lshlrev_b32 v102, 16, v43
    v_and_b32 v103, 0xffff0000, v43
    v_pk_mul_f32 v[32:33], v[96:97], s[70:71]
    v_pk_mul_f32 v[34:35], v[98:99], s[70:71]
    v_pk_mul_f32 v[36:37], v[100:101], s[70:71]
    v_pk_mul_f32 v[38:39], v[102:103], s[70:71]
    v_exp_f32 v32, v32
    v_exp_f32 v33, v33
    v_exp_f32 v34, v34
    v_exp_f32 v35, v35
    v_exp_f32 v36, v36
    v_exp_f32 v37, v37
    v_exp_f32 v38, v38
    v_exp_f32 v39, v39
    v_cvt_pk_bf16_f32 v40, v104, v105
    v_cvt_pk_bf16_f32 v41, v106, v107
    v_cvt_pk_bf16_f32 v42, v108, v109
    v_cvt_pk_bf16_f32 v43, v110, v111
    v_pk_add_f32 v[32:33], v[32:33], 1.0 op_sel_hi:[1,0]
    v_pk_add_f32 v[34:35], v[34:35], 1.0 op_sel_hi:[1,0]
    v_pk_add_f32 v[36:37], v[36:37], 1.0 op_sel_hi:[1,0]
    v_pk_add_f32 v[38:39], v[38:39], 1.0 op_sel_hi:[1,0]
    v_rcp_f32 v32, v32
    v_rcp_f32 v33, v33
    v_rcp_f32 v34, v34
    v_rcp_f32 v35, v35
    v_rcp_f32 v36, v36
    v_rcp_f32 v37, v37
    v_rcp_f32 v38, v38
    v_rcp_f32 v39, v39
    v_lshlrev_b32 v104, 16, v40
    v_and_b32 v105, 0xffff0000, v40
    v_lshlrev_b32 v106, 16, v41
    v_and_b32 v107, 0xffff0000, v41
    v_lshlrev_b32 v108, 16, v42
    v_and_b32 v109, 0xffff0000, v42
    v_lshlrev_b32 v110, 16, v43
    v_and_b32 v111, 0xffff0000, v43
    v_pk_mul_f32 v[32:33], v[32:33], v[96:97]
    v_pk_mul_f32 v[34:35], v[34:35], v[98:99]
    v_pk_mul_f32 v[36:37], v[36:37], v[100:101]
    v_pk_mul_f32 v[38:39], v[38:39], v[102:103]
    v_cvt_pk_bf16_f32 v40, v32, v33
    v_cvt_pk_bf16_f32 v41, v34, v35
    v_cvt_pk_bf16_f32 v42, v36, v37
    v_cvt_pk_bf16_f32 v43, v38, v39
    v_lshlrev_b32 v32, 16, v40
    v_and_b32 v33, 0xffff0000, v40
    v_lshlrev_b32 v34, 16, v41
    v_and_b32 v35, 0xffff0000, v41
    v_lshlrev_b32 v36, 16, v42
    v_and_b32 v37, 0xffff0000, v42
    v_lshlrev_b32 v38, 16, v43
    v_and_b32 v39, 0xffff0000, v43
    v_pk_mul_f32 v[32:33], v[32:33], v[104:105]
    v_pk_mul_f32 v[34:35], v[34:35], v[106:107]
    v_pk_mul_f32 v[36:37], v[36:37], v[108:109]
    v_pk_mul_f32 v[38:39], v[38:39], v[110:111]
    v_cvt_pk_bf16_f32 v40, v32, v36
    v_cvt_pk_bf16_f32 v41, v33, v37
    v_cvt_pk_bf16_f32 v42, v34, v38
    v_cvt_pk_bf16_f32 v43, v35, v39
    ds_write_b128 v10, v[40:43]
    s_waitcnt lgkmcnt(0)
    s_barrier
    ds_read_b128 v[32:35], v4 offset:0
    ds_read_b128 v[36:39], v4 offset:1024
    ds_read_b128 v[40:43], v4 offset:2048
    ds_read_b128 v[44:47], v4 offset:3072
    s_waitcnt lgkmcnt(3)
    v_mfma_f32_16x16x32_bf16 v[64:67], v[32:35], v[192:195], 0
    v_mfma_f32_16x16x32_bf16 v[68:71], v[32:35], v[196:199], 0
    v_mfma_f32_16x16x32_bf16 v[72:75], v[32:35], v[200:203], 0
    v_mfma_f32_16x16x32_bf16 v[76:79], v[32:35], v[204:207], 0
    v_mfma_f32_16x16x32_bf16 v[80:83], v[32:35], v[208:211], 0
    v_mfma_f32_16x16x32_bf16 v[84:87], v[32:35], v[212:215], 0
    v_mfma_f32_16x16x32_bf16 v[88:91], v[32:35], v[216:219], 0
    v_mfma_f32_16x16x32_bf16 v[92:95], v[32:35], v[220:223], 0
    s_waitcnt lgkmcnt(2)
    v_mfma_f32_16x16x32_bf16 v[64:67], v[36:39], v[224:227], v[64:67]
    v_mfma_f32_16x16x32_bf16 v[68:71], v[36:39], v[228:231], v[68:71]
    v_mfma_f32_16x16x32_bf16 v[72:75], v[36:39], v[232:235], v[72:75]
    v_mfma_f32_16x16x32_bf16 v[76:79], v[36:39], v[236:239], v[76:79]
    v_mfma_f32_16x16x32_bf16 v[80:83], v[36:39], v[240:243], v[80:83]
    v_mfma_f32_16x16x32_bf16 v[84:87], v[36:39], v[244:247], v[84:87]
    v_mfma_f32_16x16x32_bf16 v[88:91], v[36:39], v[248:251], v[88:91]
    v_mfma_f32_16x16x32_bf16 v[92:95], v[36:39], v[252:255], v[92:95]
    s_waitcnt lgkmcnt(0)
    v_mfma_f32_16x16x32_bf16 v[96:99], v[40:43], v[192:195], 0
    v_mfma_f32_16x16x32_bf16 v[100:103], v[40:43], v[196:199], 0
    v_mfma_f32_16x16x32_bf16 v[104:107], v[40:43], v[200:203], 0
    v_mfma_f32_16x16x32_bf16 v[108:111], v[40:43], v[204:207], 0
    v_mfma_f32_16x16x32_bf16 v[112:115], v[40:43], v[208:211], 0
    v_cvt_pk_bf16_f32 v48, v64, v68
    v_cvt_pk_bf16_f32 v49, v72, v76
    v_mfma_f32_16x16x32_bf16 v[116:119], v[40:43], v[212:215], 0
    v_cvt_pk_bf16_f32 v50, v80, v84
    v_cvt_pk_bf16_f32 v51, v88, v92
    v_mfma_f32_16x16x32_bf16 v[120:123], v[40:43], v[216:219], 0
    v_and_or_b32 v48, v48, -2, s13
    s_add_u32 s9, s74, 0
    buffer_store_dwordx4 v[48:51], v6, s[60:63], s9 offen sc1
    v_mfma_f32_16x16x32_bf16 v[124:127], v[40:43], v[220:223], 0
    v_cvt_pk_bf16_f32 v52, v65, v69
    v_cvt_pk_bf16_f32 v53, v73, v77
    v_mfma_f32_16x16x32_bf16 v[96:99], v[44:47], v[224:227], v[96:99]
    v_cvt_pk_bf16_f32 v54, v81, v85
    v_cvt_pk_bf16_f32 v55, v89, v93
    v_mfma_f32_16x16x32_bf16 v[100:103], v[44:47], v[228:231], v[100:103]
    v_and_or_b32 v52, v52, -2, s13
    s_add_u32 s9, s74, 33024
    buffer_store_dwordx4 v[52:55], v6, s[60:63], s9 offen sc1
    v_mfma_f32_16x16x32_bf16 v[104:107], v[44:47], v[232:235], v[104:107]
    v_cvt_pk_bf16_f32 v56, v66, v70
    v_cvt_pk_bf16_f32 v57, v74, v78
    v_mfma_f32_16x16x32_bf16 v[108:111], v[44:47], v[236:239], v[108:111]
    v_cvt_pk_bf16_f32 v58, v82, v86
    v_cvt_pk_bf16_f32 v59, v90, v94
    v_mfma_f32_16x16x32_bf16 v[112:115], v[44:47], v[240:243], v[112:115]
    v_and_or_b32 v56, v56, -2, s13
    s_add_u32 s9, s74, 66048
    buffer_store_dwordx4 v[56:59], v6, s[60:63], s9 offen sc1
    v_mfma_f32_16x16x32_bf16 v[116:119], v[44:47], v[244:247], v[116:119]
    v_cvt_pk_bf16_f32 v60, v67, v71
    v_cvt_pk_bf16_f32 v61, v75, v79
    v_mfma_f32_16x16x32_bf16 v[120:123], v[44:47], v[248:251], v[120:123]
    v_cvt_pk_bf16_f32 v62, v83, v87
    v_cvt_pk_bf16_f32 v63, v91, v95
    v_mfma_f32_16x16x32_bf16 v[124:127], v[44:47], v[252:255], v[124:127]
    v_and_or_b32 v60, v60, -2, s13
    s_add_u32 s9, s74, 99072
    buffer_store_dwordx4 v[60:63], v6, s[60:63], s9 offen sc1
    v_cvt_pk_bf16_f32 v48, v96, v100
    v_cvt_pk_bf16_f32 v49, v104, v108
    v_cvt_pk_bf16_f32 v50, v112, v116
    s_nop 1
    v_cvt_pk_bf16_f32 v51, v120, v124
    v_and_or_b32 v48, v48, -2, s13
    s_add_u32 s9, s74, 528384
    buffer_store_dwordx4 v[48:51], v6, s[60:63], s9 offen sc1
    v_cvt_pk_bf16_f32 v52, v97, v101
    v_cvt_pk_bf16_f32 v53, v105, v109
    v_cvt_pk_bf16_f32 v54, v113, v117
    v_cvt_pk_bf16_f32 v55, v121, v125
    v_and_or_b32 v52, v52, -2, s13
    s_add_u32 s9, s74, 561408
    buffer_store_dwordx4 v[52:55], v6, s[60:63], s9 offen sc1
    v_cvt_pk_bf16_f32 v56, v98, v102
    v_cvt_pk_bf16_f32 v57, v106, v110
    v_cvt_pk_bf16_f32 v58, v114, v118
    v_cvt_pk_bf16_f32 v59, v122, v126
    v_and_or_b32 v56, v56, -2, s13
    s_add_u32 s9, s74, 594432
    buffer_store_dwordx4 v[56:59], v6, s[60:63], s9 offen sc1
    v_cvt_pk_bf16_f32 v60, v99, v103
    v_cvt_pk_bf16_f32 v61, v107, v111
    v_cvt_pk_bf16_f32 v62, v115, v119
    v_cvt_pk_bf16_f32 v63, v123, v127
    v_and_or_b32 v60, v60, -2, s13
    s_add_u32 s9, s74, 627456
    buffer_store_dwordx4 v[60:63], v6, s[60:63], s9 offen sc1
    s_branch L_FF_flag2_far
L_FF_flag_far:
ro_103:
    buffer_load_dwordx2 v[30:31], v8, s[60:63], s73 offen sc1
    s_waitcnt vmcnt(0)
    v_max_u32 v28, v30, v31
    v_cmp_eq_u32 vcc, -1, v28
    s_cbranch_vccz rod_104
    s_sleep 4
    s_sub_u32 s8, s8, 1
    s_cbranch_scc0 ro_103
    s_mov_b32 s8, 0
rod_104:
    s_cmp_le_u32 s69, 2
    s_cbranch_scc1 L_FF_flag2_far
ro_105:
    buffer_load_dword v28, v7, s[60:63], s74 offen sc1
    s_waitcnt vmcnt(0)
    v_bitop3_b32 v28, v28, s13, 1 bitop3:0x28
    v_cmp_ne_u32 vcc, 0, v28
    s_cbranch_vccz rod_106
    s_sleep 1
    s_sub_u32 s8, s8, 1
    s_cbranch_scc0 ro_105
    s_mov_b32 s8, 0
rod_106:
L_FF_flag2_far:
    s_cmp_gt_u32 s69, 2
    s_cbranch_scc1 fft_107
    s_waitcnt vmcnt(0)
    s_lshl_b32 s10, s69, 1
    s_sub_u32 s10, s10, 1
    v_mov_b32 v28, s10
    s_mov_b64 exec, 1
    buffer_store_dword v28, off, s[60:63], s65 sc1
    s_mov_b64 exec, -1
wf_108:
    buffer_load_dwordx2 v[28:29], v9, s[60:63], 0 offen sc1
    s_waitcnt vmcnt(0)
    v_min_u32 v28, v28, v29
    v_cmp_gt_u32 vcc, s10, v28
    s_cbranch_vccz wfd_109
    s_sub_u32 s8, s8, 1
    s_cbranch_scc0 wf_108
    s_mov_b32 s8, 0
wfd_109:
fft_107:
    s_waitcnt vmcnt(0)
rs_110:
    s_add_u32 s9, s74, 0
    buffer_load_dwordx4 v[32:35], v7, s[60:63], s9 offen sc1
    s_add_u32 s9, s74, 4096
    buffer_load_dwordx4 v[36:39], v7, s[60:63], s9 offen sc1
    s_add_u32 s9, s74, 8192
    buffer_load_dwordx4 v[40:43], v7, s[60:63], s9 offen sc1
    s_add_u32 s9, s74, 12288
    buffer_load_dwordx4 v[44:47], v7, s[60:63], s9 offen sc1
    s_add_u32 s9, s74, 16384
    buffer_load_dwordx4 v[48:51], v7, s[60:63], s9 offen sc1
    s_add_u32 s9, s74, 20480
    buffer_load_dwordx4 v[52:55], v12, s[60:63], s9 offen sc1
    s_mov_b64 exec, -1
    s_waitcnt vmcnt(5)
    v_mfma_f32_16x16x32_bf16 v[64:67], v[24:27], v[32:35], 0
    v_xor_b32 v28, s13, v32
    s_waitcnt vmcnt(4)
    v_mfma_f32_16x16x32_bf16 v[64:67], v[24:27], v[36:39], v[64:67]
    v_bitop3_b32 v28, v28, v36, s13 bitop3:0xf6
    s_waitcnt vmcnt(3)
    v_mfma_f32_16x16x32_bf16 v[64:67], v[24:27], v[40:43], v[64:67]
    v_bitop3_b32 v28, v28, v40, s13 bitop3:0xf6
    s_waitcnt vmcnt(2)
    v_mfma_f32_16x16x32_bf16 v[64:67], v[24:27], v[44:47], v[64:67]
    v_bitop3_b32 v28, v28, v44, s13 bitop3:0xf6
    s_waitcnt vmcnt(1)
    v_mfma_f32_16x16x32_bf16 v[64:67], v[24:27], v[48:51], v[64:67]
    v_bitop3_b32 v28, v28, v48, s13 bitop3:0xf6
    s_waitcnt vmcnt(0)
    v_mfma_f32_16x16x32_bf16 v[64:67], v[24:27], v[52:55], v[64:67]
    v_cndmask_b32 v29, v15, v52, s[66:67]
    v_bitop3_b32 v28, v28, v29, s13 bitop3:0xf6
    v_and_b32 v28, 1, v28
    v_cmp_ne_u32 vcc, 0, v28
    s_cbranch_vccz rsd_111
    s_mov_b64 exec, vcc
    s_sub_u32 s8, s8, 1
    s_cbranch_scc0 rs_110
    s_mov_b32 s8, 0
    s_mov_b64 exec, -1
rsd_111:
    s_lshl_b32 s10, s69, 1
    v_mov_b32 v28, s10
    s_mov_b64 exec, 1
    buffer_store_dword v28, off, s[60:63], s65 sc1
    s_mov_b64 exec, -1
hh_112:
    v_max_u32 v28, v30, v31
    v_cmp_eq_u32 vcc, -1, v28
    s_cbranch_vccz hhd_113
    buffer_load_dwordx2 v[30:31], v8, s[60:63], s73 offen sc1
    s_waitcnt vmcnt(0)
    s_sub_u32 s8, s8, 1
    s_cbranch_scc0 hh_112
    s_mov_b32 s8, 0
hhd_113:
    v_lshlrev_b32 v72, 16, v30
    v_and_b32 v73, 0xffff0000, v30
    v_lshlrev_b32 v74, 16, v31
    v_and_b32 v75, 0xffff0000, v31
    v_cvt_pk_bf16_f32 v68, v64, v65
    v_cvt_pk_bf16_f32 v69, v66, v67
    v_lshlrev_b32 v64, 16, v68
    v_and_b32 v65, 0xffff0000, v68
    v_lshlrev_b32 v66, 16, v69
    v_and_b32 v67, 0xffff0000, v69
    v_pk_add_f32 v[64:65], v[64:65], v[72:73]
    v_pk_add_f32 v[66:67], v[66:67], v[74:75]
    v_cvt_pk_bf16_f32 v68, v64, v65
    v_cvt_pk_bf16_f32 v69, v66, v67
    v_mov_b32 v70, v68
    v_mov_b32 v71, v69
    s_nop 0
    v_permlane16_swap_b32 v68, v70
    v_permlane16_swap_b32 v69, v71
    s_mov_b64 exec, 0xffff
    buffer_store_dwordx4 v[68:71], v8, s[52:55], s75 offen
    s_mov_b64 exec, -1
    s_cmp_lt_u32 s68, 56
    s_cbranch_scc1 fw_114
    s_cmp_ge_u32 s68, 62
    s_cbranch_scc1 fw_114
fw_114:
    s_cmp_ge_u32 s68, 52
    s_cselect_b32 s9, 4, 2
    s_add_u32 s68, s68, s9
    s_cmp_lt_u32 s68, 64
    s_cbranch_scc1 L_FF_far
    s_endpgm
L_exit:
    s_endpgm
.section .rodata,"a"
.p2align 6
.amdhsa_kernel sequential_preLN__memory_aug_recurrent_mem_tr__glu_gated_swiglu__prompt_kernel
  .amdhsa_next_free_vgpr 512
  .amdhsa_next_free_sgpr 102
  .amdhsa_accum_offset 256
  .amdhsa_group_segment_fixed_size 0
  .amdhsa_kernarg_size 112
  .amdhsa_user_sgpr_count 2
  .amdhsa_user_sgpr_kernarg_segment_ptr 1
  .amdhsa_system_sgpr_workgroup_id_x 1
  .amdhsa_float_denorm_mode_32 3
.end_amdhsa_kernel
```
